```python
import torch

def _softmax(x, axis=-1):
    return torch.softmax(x, dim=axis)
def _gelu(x):
    return torch.nn.functional.gelu(x, approximate="tanh")
def _silu(x):
    return torch.nn.functional.silu(x)
def _sigmoid(x):
    return torch.sigmoid(x)
def _layernorm(x, axis=-1, eps=1e-5):
    m = x.mean(dim=axis, keepdim=True)
    v = x.var(dim=axis, keepdim=True, unbiased=False)
    return (x - m) / torch.sqrt(v + eps)
def _scatter_add(tgt, idx, src, axis=0):
    return tgt.clone().index_add_(axis, idx, src)
def _segment_sum(src, seg, n):
    out = torch.zeros((n,) + src.shape[1:], dtype=src.dtype)
    return out.index_add_(0, seg, src)
def _pad(x, pw):
    flat = tuple(v for pair in reversed(pw) for v in pair)
    return torch.nn.functional.pad(x, flat)

kernel_name = 'concat_heads__spectral_fnet__sliding_block__prompt'

def setup_inputs():

    _w = (lambda a: (lambda t: t.to(torch.bfloat16) if t.is_floating_point() else t)(torch.as_tensor(a)))
    def _A_setup():
        B, S, D = 1, 2048, 640
        ns = torch.arange(S)[:, None] * torch.arange(S)[None, :]
        nd = torch.arange(D)[:, None] * torch.arange(D)[None, :]
        Ws_re = torch.cos(-2.0 * torch.pi * ns / S).to(float)
        Ws_im = torch.sin(-2.0 * torch.pi * ns / S).to(float)
        Wd_re = torch.cos(-2.0 * torch.pi * nd / D).to(float)
        Wd_im = torch.sin(-2.0 * torch.pi * nd / D).to(float)
        return {
            "x": _w((lambda *s: torch.randn(*s, dtype=torch.bfloat16) * 0.05)(B, S, D)),
            "dft_seq_re": _w(Ws_re),
            "dft_seq_im": _w(Ws_im),
            "dft_hid_re": _w(Wd_re),
            "dft_hid_im": _w(Wd_im),
        }
    _A_in = _A_setup()

    def _B_setup():
        B, S, D = 1, 2048, 640
        return {
            "x": _w((lambda *s: torch.randn(*s, dtype=torch.bfloat16) * 0.2)(B, S, D)),
            "wqkv": _w((lambda *s: torch.randn(*s, dtype=torch.bfloat16) * 0.8)(D, 3 * D)),
            "wo": _w((lambda *s: torch.randn(*s, dtype=torch.bfloat16) * 0.2)(D, D)),
        }
    _B_in = _B_setup()

    return {
        "A_x": _A_in["x"],
        "A_dft_seq_re": _A_in["dft_seq_re"],
        "A_dft_seq_im": _A_in["dft_seq_im"],
        "A_dft_hid_re": _A_in["dft_hid_re"],
        "A_dft_hid_im": _A_in["dft_hid_im"],
        "B_x": _B_in["x"],
        "B_wqkv": _B_in["wqkv"],
        "B_wo": _B_in["wo"],
    }

def reference(A_x, A_dft_seq_re, A_dft_seq_im, A_dft_hid_re, A_dft_hid_im, B_x, B_wqkv, B_wo):
    def _A_ref(x, dft_seq_re, dft_seq_im, dft_hid_re, dft_hid_im):
        a = torch.einsum("bsd,ed->bse", x, dft_hid_re)
        b = torch.einsum("bsd,ed->bse", x, dft_hid_im)
        y = torch.einsum("ts,bse->bte", dft_seq_re, a) - torch.einsum("ts,bse->bte", dft_seq_im, b)
        return y

    def _B_ref(x, wqkv, wo):
        B, S, D = x.shape
        H = 32; Dh = D // H; W = 256
        qkv = (lambda x, *d: x.permute(*d))((x @ wqkv).reshape(B, S, 3, H, Dh), 2, 0, 3, 1, 4)
        q, k, v = qkv[0], qkv[1], qkv[2]
        scores = torch.einsum("bhqd,bhkd->bhqk", q, k) * (Dh ** -0.5)
        idx = torch.arange(S)
        mask = (idx[:, None] - idx[None, :] >= 0) & (idx[:, None] - idx[None, :] < W)
        scores = torch.where(mask[None, None], scores, -1e9)
        p = _softmax(scores, axis=-1)
        o = torch.einsum("bhqk,bhkd->bhqd", p, v)
        return (lambda x, *d: x.permute(*d))(o, 0, 2, 1, 3).reshape(B, S, D) @ wo

    a = _A_ref(A_x, A_dft_seq_re, A_dft_seq_im, A_dft_hid_re, A_dft_hid_im)
    b = _B_ref(B_x, B_wqkv, B_wo)
    return torch.concatenate([a, b], axis=-1)
```

```asm
; @launch grid=(256,1,1) block=(512,1,1) lds=163328
.amdgcn_target "amdgcn-amd-amdhsa--gfx950"
.text
.globl concat_heads__spectral_fnet__sliding_block__prompt_kernel
.p2align 8
.type concat_heads__spectral_fnet__sliding_block__prompt_kernel,@function
concat_heads__spectral_fnet__sliding_block__prompt_kernel:
    s_cmp_ge_u32 s2, 256
    s_cbranch_scc1 END
    s_load_dwordx8 s[12:19], s[0:1], 40
    s_load_dwordx4 s[20:23], s[0:1], 72
    s_load_dwordx2 s[8:9], s[0:1], 0
    s_lshr_b32 s4, s2, 3
    s_getpc_b64 s[34:35]
PCREF:
    v_lshl_add_u32 v2, v0, 5, s4
    v_lshlrev_b32 v2, 7, v2
    v_cmp_gt_u32 vcc, TABEND-PCREF, v2
    s_nop 0
    s_and_saveexec_b64 s[36:37], vcc
    s_cbranch_execz NOPF
    global_load_dword v254, v2, s[34:35]
NOPF:
    s_mov_b64 exec, -1
    s_add_u32 s0, s34, TAB-PCREF
    s_addc_u32 s1, s35, 0
    v_lshrrev_b32 v1, 6, v0
    s_and_b32 s3, s2, 7
    v_readfirstlane_b32 s6, v1
    s_lshl_b32 s5, s3, 5
    s_add_u32 s5, s5, s4
    v_and_b32 v0, 63, v0
    s_and_b32 s7, s6, 3
    s_and_b32 s10, s4, 1
    s_lshr_b32 s11, s4, 1
    s_cmp_lt_u32 s6, 4
    s_cbranch_scc1 C_ROLE
    v_and_b32 v11, 15, v0
    v_lshrrev_b32 v12, 4, v0
    s_lshl_b32 s48, s3, 4
    s_add_u32 s48, s48, s11
    s_lshl_b32 s49, s7, 9
    s_add_u32 s48, s48, s49
    v_lshl_add_u32 v10, v12, 7, s48
    s_movk_i32 s48, 1280
    v_mul_u32_u24 v10, s48, v10
    v_lshl_add_u32 v10, v11, 4, v10
    s_setprio 2
    s_waitcnt lgkmcnt(0)
    global_load_dwordx4 v[96:99], v10, s[8:9] offset:0
    global_load_dwordx4 v[100:103], v10, s[8:9] offset:256
    global_load_dwordx4 v[104:107], v10, s[8:9] offset:512
    global_load_dwordx4 v[108:111], v10, s[8:9] offset:768
    global_load_dwordx4 v[112:115], v10, s[8:9] offset:1024
    s_branch L_ROLE2
C_ROLE:
    s_setprio 1
    v_and_b32 v11, 15, v0
    v_lshrrev_b32 v12, 4, v0
    s_mul_i32 s48, s10, 160
    s_add_u32 s49, s48, s7
    s_add_u32 s49, s49, 1
    v_mad_u32_u24 v13, v11, 5, s49
    v_cvt_f32_u32 v202, v13
    s_mul_i32 s49, s7, 40
    s_add_u32 s48, s48, s49
    s_add_u32 s48, s48, 5
    v_and_b32 v14, 7, v11
    v_mad_u32_u24 v14, v14, 5, s48
    v_cvt_f32_u32 v204, v14
    v_cmp_le_u32 vcc, 8, v11
    v_mov_b32 v208, 0x80008000
    v_mov_b32 v209, 0xbe800000
    v_cndmask_b32 v162, 0, v208, vcc
    v_cndmask_b32 v207, 0, v209, vcc
    v_cmp_ne_u32 vcc, 239, v13
    v_lshlrev_b32 v208, 3, v12
    v_cvt_f32_u32 v208, v208
    v_cndmask_b32 v204, 0, v204, vcc
    v_cndmask_b32 v207, 0, v207, vcc
    v_mul_f32 v202, 0x3acccccd, v202
    v_mul_f32 v204, 0x3acccccd, v204
    v_mul_f32 v205, v208, v202
    v_fmac_f32 v207, v208, v204
    v_mul_f32 v208, 0x42000000, v202
    v_mul_f32 v209, 0x42000000, v204
    v_cos_f32 v208, v208
    v_cos_f32 v209, v209
    v_add_f32 v228, v208, v208
    v_add_f32 v230, v209, v209
    v_mov_b32 v229, v228
    v_mov_b32 v231, v230
    v_fmamk_f32 v209, v202, 0x3f800000, v205
    v_fmamk_f32 v208, v202, 0x0, v205
    v_fmamk_f32 v210, v204, 0x0, v207
    v_fmamk_f32 v211, v204, 0x3f800000, v207
    v_cos_f32 v213, v209
    v_sin_f32 v215, v209
    v_cos_f32 v212, v208
    v_sin_f32 v214, v208
    v_cos_f32 v218, v210
    v_cos_f32 v219, v211
    v_mul_f32 v217, 0x3f3504f3, v213
    v_fmamk_f32 v216, v215, 0xbf3504f3, v217
    v_fmac_f32 v217, 0x3f3504f3, v215
    v_cvt_pk_bf16_f32 v44, v212, v213
    v_cvt_pk_bf16_f32 v48, v214, v215
    v_cvt_pk_bf16_f32 v52, v212, v216
    v_cvt_pk_bf16_f32 v56, v214, v217
    v_cvt_pk_bf16_f32 v60, v218, v219
    v_fmamk_f32 v209, v202, 0x42040000, v205
    v_fmamk_f32 v208, v202, 0x42000000, v205
    v_fmamk_f32 v210, v204, 0x42000000, v207
    v_fmamk_f32 v211, v204, 0x42040000, v207
    v_cos_f32 v221, v209
    v_sin_f32 v223, v209
    v_cos_f32 v220, v208
    v_sin_f32 v222, v208
    v_cos_f32 v226, v210
    v_cos_f32 v227, v211
    v_mul_f32 v225, 0x3f3504f3, v221
    v_fmamk_f32 v224, v223, 0xbf3504f3, v225
    v_fmac_f32 v225, 0x3f3504f3, v223
    v_cvt_pk_bf16_f32 v64, v220, v221
    v_cvt_pk_bf16_f32 v68, v222, v223
    v_cvt_pk_bf16_f32 v72, v220, v224
    v_cvt_pk_bf16_f32 v76, v222, v225
    v_cvt_pk_bf16_f32 v80, v226, v227
    v_pk_fma_f32 v[212:213], v[220:221], v[228:229], v[212:213] neg_lo:[0,0,1] neg_hi:[0,0,1]
    v_pk_fma_f32 v[214:215], v[222:223], v[228:229], v[214:215] neg_lo:[0,0,1] neg_hi:[0,0,1]
    v_pk_fma_f32 v[216:217], v[224:225], v[228:229], v[216:217] neg_lo:[0,0,1] neg_hi:[0,0,1]
    v_pk_fma_f32 v[218:219], v[226:227], v[230:231], v[218:219] neg_lo:[0,0,1] neg_hi:[0,0,1]
    v_cvt_pk_bf16_f32 v84, v212, v213
    v_cvt_pk_bf16_f32 v88, v214, v215
    v_cvt_pk_bf16_f32 v92, v212, v216
    v_cvt_pk_bf16_f32 v96, v214, v217
    v_cvt_pk_bf16_f32 v100, v218, v219
    v_pk_fma_f32 v[220:221], v[212:213], v[228:229], v[220:221] neg_lo:[0,0,1] neg_hi:[0,0,1]
    v_pk_fma_f32 v[222:223], v[214:215], v[228:229], v[222:223] neg_lo:[0,0,1] neg_hi:[0,0,1]
    v_pk_fma_f32 v[224:225], v[216:217], v[228:229], v[224:225] neg_lo:[0,0,1] neg_hi:[0,0,1]
    v_pk_fma_f32 v[226:227], v[218:219], v[230:231], v[226:227] neg_lo:[0,0,1] neg_hi:[0,0,1]
    v_cvt_pk_bf16_f32 v104, v220, v221
    v_cvt_pk_bf16_f32 v108, v222, v223
    v_cvt_pk_bf16_f32 v112, v220, v224
    v_cvt_pk_bf16_f32 v116, v222, v225
    v_cvt_pk_bf16_f32 v120, v226, v227
    v_fmamk_f32 v209, v202, 0x40400000, v205
    v_fmamk_f32 v208, v202, 0x40000000, v205
    v_fmamk_f32 v210, v204, 0x40000000, v207
    v_fmamk_f32 v211, v204, 0x40400000, v207
    v_cos_f32 v213, v209
    v_sin_f32 v215, v209
    v_cos_f32 v212, v208
    v_sin_f32 v214, v208
    v_cos_f32 v218, v210
    v_cos_f32 v219, v211
    v_mul_f32 v217, 0x3f3504f3, v213
    v_fmamk_f32 v216, v215, 0xbf3504f3, v217
    v_fmac_f32 v217, 0x3f3504f3, v215
    v_cvt_pk_bf16_f32 v45, v212, v213
    v_cvt_pk_bf16_f32 v49, v214, v215
    v_cvt_pk_bf16_f32 v53, -v214, -v217
    v_cvt_pk_bf16_f32 v57, v212, v216
    v_cvt_pk_bf16_f32 v61, v218, v219
    v_fmamk_f32 v209, v202, 0x420c0000, v205
    v_fmamk_f32 v208, v202, 0x42080000, v205
    v_fmamk_f32 v210, v204, 0x42080000, v207
    v_fmamk_f32 v211, v204, 0x420c0000, v207
    v_cos_f32 v221, v209
    v_sin_f32 v223, v209
    v_cos_f32 v220, v208
    v_sin_f32 v222, v208
    v_cos_f32 v226, v210
    v_cos_f32 v227, v211
    v_mul_f32 v225, 0x3f3504f3, v221
    v_fmamk_f32 v224, v223, 0xbf3504f3, v225
    v_fmac_f32 v225, 0x3f3504f3, v223
    v_cvt_pk_bf16_f32 v65, v220, v221
    v_cvt_pk_bf16_f32 v69, v222, v223
    v_cvt_pk_bf16_f32 v73, -v222, -v225
    v_cvt_pk_bf16_f32 v77, v220, v224
    v_cvt_pk_bf16_f32 v81, v226, v227
    v_pk_fma_f32 v[212:213], v[220:221], v[228:229], v[212:213] neg_lo:[0,0,1] neg_hi:[0,0,1]
    v_pk_fma_f32 v[214:215], v[222:223], v[228:229], v[214:215] neg_lo:[0,0,1] neg_hi:[0,0,1]
    v_pk_fma_f32 v[216:217], v[224:225], v[228:229], v[216:217] neg_lo:[0,0,1] neg_hi:[0,0,1]
    v_pk_fma_f32 v[218:219], v[226:227], v[230:231], v[218:219] neg_lo:[0,0,1] neg_hi:[0,0,1]
    v_cvt_pk_bf16_f32 v85, v212, v213
    v_cvt_pk_bf16_f32 v89, v214, v215
    v_cvt_pk_bf16_f32 v93, -v214, -v217
    v_cvt_pk_bf16_f32 v97, v212, v216
    v_cvt_pk_bf16_f32 v101, v218, v219
    v_pk_fma_f32 v[220:221], v[212:213], v[228:229], v[220:221] neg_lo:[0,0,1] neg_hi:[0,0,1]
    v_pk_fma_f32 v[222:223], v[214:215], v[228:229], v[222:223] neg_lo:[0,0,1] neg_hi:[0,0,1]
    v_pk_fma_f32 v[224:225], v[216:217], v[228:229], v[224:225] neg_lo:[0,0,1] neg_hi:[0,0,1]
    v_pk_fma_f32 v[226:227], v[218:219], v[230:231], v[226:227] neg_lo:[0,0,1] neg_hi:[0,0,1]
    v_cvt_pk_bf16_f32 v105, v220, v221
    v_cvt_pk_bf16_f32 v109, v222, v223
    v_cvt_pk_bf16_f32 v113, -v222, -v225
    v_cvt_pk_bf16_f32 v117, v220, v224
    v_cvt_pk_bf16_f32 v121, v226, v227
    v_fmamk_f32 v209, v202, 0x40a00000, v205
    v_fmamk_f32 v208, v202, 0x40800000, v205
    v_fmamk_f32 v210, v204, 0x40800000, v207
    v_fmamk_f32 v211, v204, 0x40a00000, v207
    v_cos_f32 v213, v209
    v_sin_f32 v215, v209
    v_cos_f32 v212, v208
    v_sin_f32 v214, v208
    v_cos_f32 v218, v210
    v_cos_f32 v219, v211
    v_mul_f32 v217, 0x3f3504f3, v213
    v_fmamk_f32 v216, v215, 0xbf3504f3, v217
    v_fmac_f32 v217, 0x3f3504f3, v215
    v_cvt_pk_bf16_f32 v46, v212, v213
    v_cvt_pk_bf16_f32 v50, v214, v215
    v_cvt_pk_bf16_f32 v54, -v212, -v216
    v_cvt_pk_bf16_f32 v58, -v214, -v217
    v_cvt_pk_bf16_f32 v62, v218, v219
    v_fmamk_f32 v209, v202, 0x42140000, v205
    v_fmamk_f32 v208, v202, 0x42100000, v205
    v_fmamk_f32 v210, v204, 0x42100000, v207
    v_fmamk_f32 v211, v204, 0x42140000, v207
    v_cos_f32 v221, v209
    v_sin_f32 v223, v209
    v_cos_f32 v220, v208
    v_sin_f32 v222, v208
    v_cos_f32 v226, v210
    v_cos_f32 v227, v211
    v_mul_f32 v225, 0x3f3504f3, v221
    v_fmamk_f32 v224, v223, 0xbf3504f3, v225
    v_fmac_f32 v225, 0x3f3504f3, v223
    v_cvt_pk_bf16_f32 v66, v220, v221
    v_cvt_pk_bf16_f32 v70, v222, v223
    v_cvt_pk_bf16_f32 v74, -v220, -v224
    v_cvt_pk_bf16_f32 v78, -v222, -v225
    v_cvt_pk_bf16_f32 v82, v226, v227
    v_pk_fma_f32 v[212:213], v[220:221], v[228:229], v[212:213] neg_lo:[0,0,1] neg_hi:[0,0,1]
    v_pk_fma_f32 v[214:215], v[222:223], v[228:229], v[214:215] neg_lo:[0,0,1] neg_hi:[0,0,1]
    v_pk_fma_f32 v[216:217], v[224:225], v[228:229], v[216:217] neg_lo:[0,0,1] neg_hi:[0,0,1]
    v_pk_fma_f32 v[218:219], v[226:227], v[230:231], v[218:219] neg_lo:[0,0,1] neg_hi:[0,0,1]
    v_cvt_pk_bf16_f32 v86, v212, v213
    v_cvt_pk_bf16_f32 v90, v214, v215
    v_cvt_pk_bf16_f32 v94, -v212, -v216
    v_cvt_pk_bf16_f32 v98, -v214, -v217
    v_cvt_pk_bf16_f32 v102, v218, v219
    v_pk_fma_f32 v[220:221], v[212:213], v[228:229], v[220:221] neg_lo:[0,0,1] neg_hi:[0,0,1]
    v_pk_fma_f32 v[222:223], v[214:215], v[228:229], v[222:223] neg_lo:[0,0,1] neg_hi:[0,0,1]
    v_pk_fma_f32 v[224:225], v[216:217], v[228:229], v[224:225] neg_lo:[0,0,1] neg_hi:[0,0,1]
    v_pk_fma_f32 v[226:227], v[218:219], v[230:231], v[226:227] neg_lo:[0,0,1] neg_hi:[0,0,1]
    v_cvt_pk_bf16_f32 v106, v220, v221
    v_cvt_pk_bf16_f32 v110, v222, v223
    v_cvt_pk_bf16_f32 v114, -v220, -v224
    v_cvt_pk_bf16_f32 v118, -v222, -v225
    v_cvt_pk_bf16_f32 v122, v226, v227
    v_fmamk_f32 v209, v202, 0x40e00000, v205
    v_fmamk_f32 v208, v202, 0x40c00000, v205
    v_fmamk_f32 v210, v204, 0x40c00000, v207
    v_fmamk_f32 v211, v204, 0x40e00000, v207
    v_cos_f32 v213, v209
    v_sin_f32 v215, v209
    v_cos_f32 v212, v208
    v_sin_f32 v214, v208
    v_cos_f32 v218, v210
    v_cos_f32 v219, v211
    v_mul_f32 v217, 0x3f3504f3, v213
    v_fmamk_f32 v216, v215, 0xbf3504f3, v217
    v_fmac_f32 v217, 0x3f3504f3, v215
    v_cvt_pk_bf16_f32 v47, v212, v213
    v_cvt_pk_bf16_f32 v51, v214, v215
    v_cvt_pk_bf16_f32 v55, v214, v217
    v_cvt_pk_bf16_f32 v59, -v212, -v216
    v_cvt_pk_bf16_f32 v63, v218, v219
    v_fmamk_f32 v209, v202, 0x421c0000, v205
    v_fmamk_f32 v208, v202, 0x42180000, v205
    v_fmamk_f32 v210, v204, 0x42180000, v207
    v_fmamk_f32 v211, v204, 0x421c0000, v207
    v_cos_f32 v221, v209
    v_sin_f32 v223, v209
    v_cos_f32 v220, v208
    v_sin_f32 v222, v208
    v_cos_f32 v226, v210
    v_cos_f32 v227, v211
    v_mul_f32 v225, 0x3f3504f3, v221
    v_fmamk_f32 v224, v223, 0xbf3504f3, v225
    v_fmac_f32 v225, 0x3f3504f3, v223
    v_cvt_pk_bf16_f32 v67, v220, v221
    v_cvt_pk_bf16_f32 v71, v222, v223
    v_cvt_pk_bf16_f32 v75, v222, v225
    v_cvt_pk_bf16_f32 v79, -v220, -v224
    v_cvt_pk_bf16_f32 v83, v226, v227
    v_pk_fma_f32 v[212:213], v[220:221], v[228:229], v[212:213] neg_lo:[0,0,1] neg_hi:[0,0,1]
    v_pk_fma_f32 v[214:215], v[222:223], v[228:229], v[214:215] neg_lo:[0,0,1] neg_hi:[0,0,1]
    v_pk_fma_f32 v[216:217], v[224:225], v[228:229], v[216:217] neg_lo:[0,0,1] neg_hi:[0,0,1]
    v_pk_fma_f32 v[218:219], v[226:227], v[230:231], v[218:219] neg_lo:[0,0,1] neg_hi:[0,0,1]
    v_cvt_pk_bf16_f32 v87, v212, v213
    v_cvt_pk_bf16_f32 v91, v214, v215
    v_cvt_pk_bf16_f32 v95, v214, v217
    v_cvt_pk_bf16_f32 v99, -v212, -v216
    v_cvt_pk_bf16_f32 v103, v218, v219
    v_pk_fma_f32 v[220:221], v[212:213], v[228:229], v[220:221] neg_lo:[0,0,1] neg_hi:[0,0,1]
    v_pk_fma_f32 v[222:223], v[214:215], v[228:229], v[222:223] neg_lo:[0,0,1] neg_hi:[0,0,1]
    v_pk_fma_f32 v[224:225], v[216:217], v[228:229], v[224:225] neg_lo:[0,0,1] neg_hi:[0,0,1]
    v_pk_fma_f32 v[226:227], v[218:219], v[230:231], v[226:227] neg_lo:[0,0,1] neg_hi:[0,0,1]
    v_cvt_pk_bf16_f32 v107, v220, v221
    v_cvt_pk_bf16_f32 v111, v222, v223
    v_cvt_pk_bf16_f32 v115, v222, v225
    v_cvt_pk_bf16_f32 v119, -v220, -v224
    v_cvt_pk_bf16_f32 v123, v226, v227
    s_lshl_b32 s48, s3, 4
    s_add_u32 s48, s48, s11
    v_lshl_add_u32 v208, v12, 9, s48
    v_mul_u32_u24 v208, v208, v11
    v_cvt_f32_u32 v208, v208
    v_mul_f32 v208, 0x3a000000, v208
    v_cvt_f32_u32 v209, v11
    v_fmamk_f32 v210, v209, 0x0, v208
    v_fmamk_f32 v211, v209, 0x3d800000, v208
    v_cos_f32 v212, v210
    v_cos_f32 v213, v211
    v_sin_f32 v210, v210
    v_sin_f32 v211, v211
    v_cvt_pk_bf16_f32 v158, v212, v213
    v_cvt_pk_bf16_f32 v156, v210, v211
    v_fmamk_f32 v210, v209, 0x3e000000, v208
    v_fmamk_f32 v211, v209, 0x3e400000, v208
    v_cos_f32 v212, v210
    v_cos_f32 v213, v211
    v_sin_f32 v210, v210
    v_sin_f32 v211, v211
    v_cvt_pk_bf16_f32 v159, v212, v213
    v_cvt_pk_bf16_f32 v157, v210, v211
    v_xor_b32 v160, 0x80008000, v156
    v_xor_b32 v161, 0x80008000, v157
    s_waitcnt lgkmcnt(0)
    s_mov_b32 s24, s22
    s_mov_b32 s25, s23
    s_mov_b32 s26, 268435456
    s_mov_b32 s27, 0x00020000
    s_mov_b32 s28, s18
    s_mov_b32 s29, s19
    s_mov_b32 s30, 5242880
    s_mov_b32 s31, 0x00020000
    s_mov_b32 s18, 819200
    s_mov_b32 s19, 0x00020000
    s_load_dwordx16 s[64:79], s[0:1], 20480
    s_load_dwordx16 s[80:95], s[0:1], 20544
    v_xor_b32 v166, v12, v0
    v_lshlrev_b32 v166, 4, v166
    v_lshlrev_b32 v163, 4, v0
    s_add_u32 s98, s7, 1
    s_and_b32 s98, s98, 2
    s_lshl_b32 s98, s98, 11
    v_add_u32 v167, s98, v166
    s_lshl_b32 s98, s7, 12
    v_add_u32 v164, s98, v166
    s_sub_u32 s98, 12288, s98
    v_add_u32 v165, s98, v166
    s_movk_i32 s98, 2832
    v_mul_u32_u24 v170, s98, v12
    s_movk_i32 s98, 80
    v_mad_u32_u24 v168, v11, s98, v170
    s_mul_i32 s98, s7, 640
    v_add_u32 v169, s98, v168
    s_lshl_b32 s98, s7, 4
    v_add_u32 v168, s98, v168
    v_xor_b32 v28, 64, v164
    v_xor_b32 v29, 64, v165
    v_xor_b32 v30, 64, v166
    v_xor_b32 v31, 64, v167
    s_mul_i32 s98, s7, 2832
    v_lshl_add_u32 v252, v0, 6, s98
    s_lshl_b32 s99, s7, 9
    s_lshl_b32 s98, s3, 4
    s_add_u32 s99, s99, s98
    s_add_u32 s99, s99, s11
    s_mul_i32 s99, s99, 1408
    s_mul_i32 s98, s10, 640
    s_add_u32 s99, s99, s98
    s_add_u32 s99, s99, 7987200
    s_lshl_b32 s98, s10, 2
    s_add_u32 s98, s98, 40
    v_lshlrev_b32 v253, 4, v0
    v_cmp_le_u32 vcc, s98, v0
    s_nop 1
    v_cndmask_b32 v253, v253, 2.0, vcc
    v_mov_b32 v1, v11
    v_mov_b32 v2, v12
    s_mul_i32 s48, s3, 16384
    s_add_u32 s48, s48, 12587776
    v_and_b32 v11, 31, v0
    v_lshl_add_u32 v11, v11, 2, s48
    s_and_b32 s34, s3, 1
    s_mul_i32 s34, s34, 5
    s_add_u32 s34, s34, s11
    s_cmp_lt_u32 s11, 5
    s_cselect_b32 s45, 10, 15
    s_cmp_lt_u32 s11, 10
    s_cselect_b32 s45, s45, 0
    s_cselect_b32 s35, 0, 1
    s_add_u32 s45, s45, s34
    s_xor_b32 s35, s35, s3
    s_add_u32 s46, s34, 10
    s_cmp_lt_u32 s11, 10
    s_cselect_b32 s46, s11, s46
    v_lshrrev_b32 v3, 1, v1
    v_xor_b32 v3, v3, v2
    v_lshlrev_b32 v3, 4, v3
    v_lshl_add_u32 v3, v1, 7, v3
    s_lshl_b32 s33, s7, 12
    s_add_u32 s33, s33, 59904
    v_add_u32 v4, s33, v3
    v_xor_b32 v5, 64, v4
    v_lshrrev_b32 v3, 2, v1
    v_lshl_add_u32 v3, v2, 3, v3
    v_lshlrev_b32 v6, 7, v3
    v_bfe_u32 v7, v1, 3, 1
    v_lshl_or_b32 v6, v7, 5, v6
    v_and_b32 v7, 1, v2
    v_lshl_or_b32 v6, v7, 6, v6
    v_and_b32 v7, 3, v1
    v_lshl_or_b32 v6, v7, 3, v6
    v_add_u32 v6, 125440, v6
    v_xor_b32 v7, 32, v6
    v_xor_b32 v8, 64, v6
    v_xor_b32 v9, 0x60, v6
    s_lshl_b32 s33, s35, 11
    s_lshl_b32 s34, s10, 10
    s_add_u32 s33, s33, s34
    s_lshl_b32 s34, s7, 8
    s_add_u32 s33, s33, s34
    s_movk_i32 s34, 16640
    v_mul_u32_u24 v10, s34, v2
    v_lshl_add_u32 v10, v1, 4, v10
    v_add_u32 v10, s33, v10
    s_cmp_lt_u32 s45, 20
    s_cselect_b32 s56, 0x3ea52b5c, 1.0
    s_mul_i32 s45, s45, 266240
    s_cmp_lt_u32 s11, 10
    s_cselect_b32 s58, 1, 0
    s_mov_b32 s57, s56
    s_mul_i32 s46, s46, 266240
    s_mul_i32 s47, s5, 512
    s_lshl_b32 s33, s7, 2
    s_add_u32 s47, s47, s33
    s_add_u32 s47, s47, 12583040
    s_cmp_ge_u32 s4, 30
    s_cbranch_scc1 C_SPARE
    s_mul_i32 s48, s4, 5
    s_lshr_b32 s20, s48, 4
    s_add_u32 s48, s48, 4
    s_lshr_b32 s21, s48, 4
    s_mul_i32 s20, s20, 4096
    s_mul_i32 s21, s21, 4096
    s_lshl_b32 s48, s3, 5
    s_lshr_b32 s49, s6, 2
    s_add_u32 s48, s48, s49
    s_mul_i32 s48, s48, 2048
    s_lshl_b32 s49, s7, 9
    s_add_u32 s48, s48, s49
    s_add_u32 s48, s48, 12845056
    s_add_u32 s20, s20, s48
    s_add_u32 s21, s21, s48
    s_lshl_b32 s48, s3, 5
    s_add_u32 s48, s48, s6
    s_lshl_b32 s12, s48, 9
    s_lshl_b32 s49, s4, 2
    s_add_u32 s12, s12, s49
    s_add_u32 s12, s12, 12583168
    s_sub_u32 s13, 8, s6
    s_cmp_eq_u32 s3, 0
    s_cselect_b32 s13, s13, 0
    s_movk_i32 s14, 16640
    s_and_b32 s40, s4, 3
    s_lshl_b32 s43, s7, 10
    s_lshr_b32 s39, s4, 2
    s_mul_i32 s39, s39, 102400
    s_add_u32 s39, s39, s43
    s_add_u32 s39, s39, 11534336
    s_add_u32 s43, s43, 59904
    s_waitcnt lgkmcnt(0)
    s_barrier
    ds_read_b128 v[236:239], v167 offset:4096
    ds_read_b128 v[240:243], v165 offset:12288
    ds_read_b128 v[244:247], v164 offset:12288
    ds_read_b128 v[248:251], v166 offset:0
    s_waitcnt lgkmcnt(3)
    v_mfma_f32_16x16x32_bf16 v[124:127], v[236:239], v[44:47], 0
    ds_read_b128 v[12:15], v31 offset:5120
    v_mfma_f32_16x16x32_bf16 v[128:131], v[236:239], v[48:51], 0
    ds_read_b128 v[16:19], v29 offset:13312
    v_mfma_f32_16x16x32_bf16 v[132:135], v[236:239], v[52:55], 0
    ds_read_b128 v[20:23], v28 offset:13312
    v_mfma_f32_16x16x32_bf16 v[136:139], v[236:239], v[56:59], 0
    ds_read_b128 v[24:27], v30 offset:1024
    s_waitcnt lgkmcnt(6)
    v_mfma_f32_16x16x32_bf16 v[124:127], v[240:243], v[48:51], v[124:127]
    v_mfma_f32_16x16x32_bf16 v[132:135], v[240:243], v[56:59], v[132:135]
    s_waitcnt lgkmcnt(5)
    v_mfma_f32_16x16x32_bf16 v[128:131], v[244:247], v[44:47], v[128:131]
    v_mfma_f32_16x16x32_bf16 v[136:139], v[244:247], v[52:55], v[136:139]
    s_waitcnt lgkmcnt(4)
    v_mfma_f32_16x16x32_bf16 v[140:143], v[248:251], v[60:63], 0
    s_waitcnt lgkmcnt(3)
    v_mfma_f32_16x16x32_bf16 v[124:127], v[12:15], v[64:67], v[124:127]
    ds_read_b128 v[236:239], v167 offset:6144
    v_mfma_f32_16x16x32_bf16 v[128:131], v[12:15], v[68:71], v[128:131]
    ds_read_b128 v[240:243], v165 offset:14336
    v_mfma_f32_16x16x32_bf16 v[132:135], v[12:15], v[72:75], v[132:135]
    ds_read_b128 v[244:247], v164 offset:14336
    v_mfma_f32_16x16x32_bf16 v[136:139], v[12:15], v[76:79], v[136:139]
    ds_read_b128 v[248:251], v166 offset:2048
    s_waitcnt lgkmcnt(6)
    v_mfma_f32_16x16x32_bf16 v[124:127], v[16:19], v[68:71], v[124:127]
    v_mfma_f32_16x16x32_bf16 v[132:135], v[16:19], v[76:79], v[132:135]
    s_waitcnt lgkmcnt(5)
    v_mfma_f32_16x16x32_bf16 v[128:131], v[20:23], v[64:67], v[128:131]
    v_mfma_f32_16x16x32_bf16 v[136:139], v[20:23], v[72:75], v[136:139]
    s_waitcnt lgkmcnt(4)
    v_mfma_f32_16x16x32_bf16 v[140:143], v[24:27], v[80:83], v[140:143]
    s_waitcnt lgkmcnt(3)
    v_mfma_f32_16x16x32_bf16 v[124:127], v[236:239], v[84:87], v[124:127]
    ds_read_b128 v[12:15], v31 offset:7168
    v_mfma_f32_16x16x32_bf16 v[128:131], v[236:239], v[88:91], v[128:131]
    ds_read_b128 v[16:19], v29 offset:15360
    v_mfma_f32_16x16x32_bf16 v[132:135], v[236:239], v[92:95], v[132:135]
    ds_read_b128 v[20:23], v28 offset:15360
    v_mfma_f32_16x16x32_bf16 v[136:139], v[236:239], v[96:99], v[136:139]
    ds_read_b128 v[24:27], v30 offset:3072
    s_waitcnt lgkmcnt(6)
    v_mfma_f32_16x16x32_bf16 v[124:127], v[240:243], v[88:91], v[124:127]
    v_mfma_f32_16x16x32_bf16 v[132:135], v[240:243], v[96:99], v[132:135]
    s_waitcnt lgkmcnt(5)
    v_mfma_f32_16x16x32_bf16 v[128:131], v[244:247], v[84:87], v[128:131]
    v_mfma_f32_16x16x32_bf16 v[136:139], v[244:247], v[92:95], v[136:139]
    s_waitcnt lgkmcnt(4)
    v_mfma_f32_16x16x32_bf16 v[140:143], v[248:251], v[100:103], v[140:143]
    s_waitcnt lgkmcnt(3)
    v_mfma_f32_16x16x32_bf16 v[124:127], v[12:15], v[104:107], v[124:127]
    v_mfma_f32_16x16x32_bf16 v[128:131], v[12:15], v[108:111], v[128:131]
    v_mfma_f32_16x16x32_bf16 v[132:135], v[12:15], v[112:115], v[132:135]
    v_mfma_f32_16x16x32_bf16 v[136:139], v[12:15], v[116:119], v[136:139]
    s_waitcnt lgkmcnt(2)
    v_mfma_f32_16x16x32_bf16 v[124:127], v[16:19], v[108:111], v[124:127]
    v_mfma_f32_16x16x32_bf16 v[132:135], v[16:19], v[116:119], v[132:135]
    s_waitcnt lgkmcnt(1)
    v_mfma_f32_16x16x32_bf16 v[128:131], v[20:23], v[104:107], v[128:131]
    v_mfma_f32_16x16x32_bf16 v[136:139], v[20:23], v[112:115], v[136:139]
    s_waitcnt lgkmcnt(0)
    v_mfma_f32_16x16x32_bf16 v[140:143], v[24:27], v[120:123], v[140:143]
    s_nop 7
    v_cvt_pk_bf16_f32 v152, v140, v141
    v_cvt_pk_bf16_f32 v153, v142, v143
    v_cvt_pk_bf16_f32 v144, v124, v125
    v_cvt_pk_bf16_f32 v145, v126, v127
    v_cvt_pk_bf16_f32 v146, v128, v129
    v_cvt_pk_bf16_f32 v147, v130, v131
    v_cvt_pk_bf16_f32 v148, v132, v133
    v_cvt_pk_bf16_f32 v149, v134, v135
    v_cvt_pk_bf16_f32 v150, v136, v137
    v_cvt_pk_bf16_f32 v151, v138, v139
    v_xor_b32_dpp v154, v152, v162 row_ror:8 row_mask:0xf bank_mask:0xf
    v_xor_b32_dpp v155, v153, v162 row_ror:8 row_mask:0xf bank_mask:0xf
    s_lshl_b32 s98, s10, 2
    s_or_b32 s98, s98, s7
    s_cmp_eq_u32 s98, 7
    s_cbranch_scc1 SPEC_1
SPEC_1R:
    v_mfma_f32_16x16x32_bf16 v[124:127], v[158:161], v[144:147], 0
    v_mfma_f32_16x16x32_bf16 v[128:131], v[156:159], v[144:147], 0
    v_mfma_f32_16x16x32_bf16 v[132:135], v[158:161], v[148:151], 0
    v_mfma_f32_16x16x32_bf16 v[136:139], v[156:159], v[148:151], 0
    v_mfma_f32_16x16x32_bf16 v[140:143], v[158:161], v[152:155], 0
    s_nop 4
    v_cvt_pk_bf16_f32 v236, v124, v128
    v_cvt_pk_bf16_f32 v237, v125, v129
    v_cvt_pk_bf16_f32 v238, v126, v130
    v_cvt_pk_bf16_f32 v239, v127, v131
    ds_write_b128 v168, v[236:239] offset:28672
    v_cvt_pk_bf16_f32 v240, v132, v136
    v_cvt_pk_bf16_f32 v241, v133, v137
    v_cvt_pk_bf16_f32 v242, v134, v138
    v_cvt_pk_bf16_f32 v243, v135, v139
    ds_write_b128 v168, v[240:243] offset:29952
    v_mov_b32_dpp v244, v140 row_ror:8 row_mask:0xf bank_mask:0xf
    v_mov_b32_dpp v245, v141 row_ror:8 row_mask:0xf bank_mask:0xf
    v_mov_b32_dpp v246, v142 row_ror:8 row_mask:0xf bank_mask:0xf
    v_mov_b32_dpp v247, v143 row_ror:8 row_mask:0xf bank_mask:0xf
    v_cvt_pk_bf16_f32 v244, v140, v244
    v_cvt_pk_bf16_f32 v245, v141, v245
    v_cvt_pk_bf16_f32 v246, v142, v246
    v_cvt_pk_bf16_f32 v247, v143, v247
    s_mov_b32 exec_lo, 0x00ff00ff
    s_mov_b32 exec_hi, 0x00ff00ff
    ds_write_b128 v169, v[244:247] offset:28736
    s_mov_b64 exec, -1
    s_waitcnt lgkmcnt(0)
    s_barrier
    s_setprio 0
    ds_read_b128 v[12:15], v4 offset:0
    ds_read_b128 v[16:19], v4 offset:2048
    ds_read_b64_tr_b16 v[204:205], v6 offset:0
    ds_read_b64_tr_b16 v[206:207], v6 offset:512
    ds_read_b64_tr_b16 v[208:209], v7 offset:0
    ds_read_b64_tr_b16 v[210:211], v7 offset:512
    ds_read_b64_tr_b16 v[212:213], v8 offset:0
    ds_read_b64_tr_b16 v[214:215], v8 offset:512
    ds_read_b64_tr_b16 v[216:217], v9 offset:0
    ds_read_b64_tr_b16 v[218:219], v9 offset:512
    ds_read_b128 v[236:239], v252 offset:28672
    ds_read_b128 v[240:243], v252 offset:28688
    ds_read_b128 v[244:247], v252 offset:28704
    ds_read_b128 v[248:251], v252 offset:28720
    s_waitcnt lgkmcnt(10)
    v_mfma_f32_16x16x32_bf16 v[172:175], v[204:207], v[12:15], 0
    ds_read_b128 v[20:23], v5 offset:0
    ds_read_b64_tr_b16 v[220:221], v6 offset:4096
    s_waitcnt lgkmcnt(4)
    v_swap_b32 v237, v240
    v_mfma_f32_16x16x32_bf16 v[176:179], v[204:207], v[16:19], 0
    ds_read_b128 v[24:27], v5 offset:2048
    ds_read_b64_tr_b16 v[222:223], v6 offset:4608
    s_waitcnt lgkmcnt(5)
    v_swap_b32 v238, v244
    v_mfma_f32_16x16x32_bf16 v[180:183], v[208:211], v[12:15], 0
    ds_read_b64_tr_b16 v[224:225], v7 offset:4096
    s_waitcnt lgkmcnt(5)
    v_swap_b32 v239, v248
    v_mfma_f32_16x16x32_bf16 v[184:187], v[208:211], v[16:19], 0
    ds_read_b64_tr_b16 v[226:227], v7 offset:4608
    v_swap_b32 v242, v245
    v_mfma_f32_16x16x32_bf16 v[188:191], v[212:215], v[12:15], 0
    ds_read_b64_tr_b16 v[228:229], v8 offset:4096
    v_swap_b32 v243, v249
    v_mfma_f32_16x16x32_bf16 v[192:195], v[212:215], v[16:19], 0
    ds_read_b64_tr_b16 v[230:231], v8 offset:4608
    v_swap_b32 v247, v250
    v_mfma_f32_16x16x32_bf16 v[196:199], v[216:219], v[12:15], 0
    ds_read_b64_tr_b16 v[232:233], v9 offset:4096
    v_mfma_f32_16x16x32_bf16 v[200:203], v[216:219], v[16:19], 0
    ds_read_b64_tr_b16 v[234:235], v9 offset:4608
    s_waitcnt lgkmcnt(0)
    s_barrier
    v_mfma_f32_16x16x32_bf16 v[172:175], v[220:223], v[20:23], v[172:175]
    ds_read_b128 v[28:31], v4 offset:16384
    ds_read_b64_tr_b16 v[204:205], v6 offset:8192
    v_mfma_f32_16x16x32_bf16 v[176:179], v[220:223], v[24:27], v[176:179]
    ds_read_b128 v[32:35], v4 offset:18432
    ds_read_b64_tr_b16 v[206:207], v6 offset:8704
    v_mfma_f32_16x16x32_bf16 v[180:183], v[224:227], v[20:23], v[180:183]
    ds_read_b64_tr_b16 v[208:209], v7 offset:8192
    v_mfma_f32_16x16x32_bf16 v[184:187], v[224:227], v[24:27], v[184:187]
    ds_read_b64_tr_b16 v[210:211], v7 offset:8704
    v_mfma_f32_16x16x32_bf16 v[188:191], v[228:231], v[20:23], v[188:191]
    ds_read_b64_tr_b16 v[212:213], v8 offset:8192
    v_mfma_f32_16x16x32_bf16 v[192:195], v[228:231], v[24:27], v[192:195]
    ds_read_b64_tr_b16 v[214:215], v8 offset:8704
    v_mfma_f32_16x16x32_bf16 v[196:199], v[232:235], v[20:23], v[196:199]
    ds_read_b64_tr_b16 v[216:217], v9 offset:8192
    v_mfma_f32_16x16x32_bf16 v[200:203], v[232:235], v[24:27], v[200:203]
    ds_read_b64_tr_b16 v[218:219], v9 offset:8704
    buffer_store_dwordx4 v[236:239], v253, s[24:27], s99 offen sc1
    s_add_u32 s99, s99, 180224
    s_waitcnt lgkmcnt(6)
    v_mfma_f32_16x16x32_bf16 v[172:175], v[204:207], v[28:31], v[172:175]
    ds_read_b128 v[36:39], v5 offset:16384
    ds_read_b64_tr_b16 v[220:221], v6 offset:12288
    v_mfma_f32_16x16x32_bf16 v[176:179], v[204:207], v[32:35], v[176:179]
    ds_read_b128 v[40:43], v5 offset:18432
    ds_read_b64_tr_b16 v[222:223], v6 offset:12800
    s_waitcnt lgkmcnt(8)
    v_mfma_f32_16x16x32_bf16 v[180:183], v[208:211], v[28:31], v[180:183]
    ds_read_b64_tr_b16 v[224:225], v7 offset:12288
    v_mfma_f32_16x16x32_bf16 v[184:187], v[208:211], v[32:35], v[184:187]
    ds_read_b64_tr_b16 v[226:227], v7 offset:12800
    s_waitcnt lgkmcnt(8)
    v_mfma_f32_16x16x32_bf16 v[188:191], v[212:215], v[28:31], v[188:191]
    ds_read_b64_tr_b16 v[228:229], v8 offset:12288
    v_mfma_f32_16x16x32_bf16 v[192:195], v[212:215], v[32:35], v[192:195]
    ds_read_b64_tr_b16 v[230:231], v8 offset:12800
    s_waitcnt lgkmcnt(8)
    v_mfma_f32_16x16x32_bf16 v[196:199], v[216:219], v[28:31], v[196:199]
    ds_read_b64_tr_b16 v[232:233], v9 offset:12288
    v_mfma_f32_16x16x32_bf16 v[200:203], v[216:219], v[32:35], v[200:203]
    ds_read_b64_tr_b16 v[234:235], v9 offset:12800
    buffer_store_dwordx4 v[240:243], v253, s[24:27], s99 offen sc1
    s_add_u32 s99, s99, 180224
    s_waitcnt lgkmcnt(0)
    s_barrier
    v_mfma_f32_16x16x32_bf16 v[172:175], v[220:223], v[36:39], v[172:175]
    ds_read_b128 v[44:47], v4 offset:32768
    ds_read_b64_tr_b16 v[204:205], v6 offset:16384
    v_mfma_f32_16x16x32_bf16 v[176:179], v[220:223], v[40:43], v[176:179]
    ds_read_b128 v[48:51], v4 offset:34816
    ds_read_b64_tr_b16 v[206:207], v6 offset:16896
    v_mfma_f32_16x16x32_bf16 v[180:183], v[224:227], v[36:39], v[180:183]
    ds_read_b64_tr_b16 v[208:209], v7 offset:16384
    v_mfma_f32_16x16x32_bf16 v[184:187], v[224:227], v[40:43], v[184:187]
    ds_read_b64_tr_b16 v[210:211], v7 offset:16896
    v_mfma_f32_16x16x32_bf16 v[188:191], v[228:231], v[36:39], v[188:191]
    ds_read_b64_tr_b16 v[212:213], v8 offset:16384
    v_mfma_f32_16x16x32_bf16 v[192:195], v[228:231], v[40:43], v[192:195]
    ds_read_b64_tr_b16 v[214:215], v8 offset:16896
    v_mfma_f32_16x16x32_bf16 v[196:199], v[232:235], v[36:39], v[196:199]
    ds_read_b64_tr_b16 v[216:217], v9 offset:16384
    v_mfma_f32_16x16x32_bf16 v[200:203], v[232:235], v[40:43], v[200:203]
    ds_read_b64_tr_b16 v[218:219], v9 offset:16896
    buffer_store_dwordx4 v[244:247], v253, s[24:27], s99 offen sc1
    s_add_u32 s99, s99, 180224
    s_waitcnt lgkmcnt(6)
    v_mfma_f32_16x16x32_bf16 v[172:175], v[204:207], v[44:47], v[172:175]
    ds_read_b128 v[52:55], v5 offset:32768
    ds_read_b64_tr_b16 v[220:221], v6 offset:20480
    v_mfma_f32_16x16x32_bf16 v[176:179], v[204:207], v[48:51], v[176:179]
    ds_read_b128 v[56:59], v5 offset:34816
    ds_read_b64_tr_b16 v[222:223], v6 offset:20992
    s_waitcnt lgkmcnt(8)
    v_mfma_f32_16x16x32_bf16 v[180:183], v[208:211], v[44:47], v[180:183]
    ds_read_b64_tr_b16 v[224:225], v7 offset:20480
    v_mfma_f32_16x16x32_bf16 v[184:187], v[208:211], v[48:51], v[184:187]
    ds_read_b64_tr_b16 v[226:227], v7 offset:20992
    s_waitcnt lgkmcnt(8)
    v_mfma_f32_16x16x32_bf16 v[188:191], v[212:215], v[44:47], v[188:191]
    ds_read_b64_tr_b16 v[228:229], v8 offset:20480
    v_mfma_f32_16x16x32_bf16 v[192:195], v[212:215], v[48:51], v[192:195]
    ds_read_b64_tr_b16 v[230:231], v8 offset:20992
    s_waitcnt lgkmcnt(8)
    v_mfma_f32_16x16x32_bf16 v[196:199], v[216:219], v[44:47], v[196:199]
    ds_read_b64_tr_b16 v[232:233], v9 offset:20480
    v_mfma_f32_16x16x32_bf16 v[200:203], v[216:219], v[48:51], v[200:203]
    ds_read_b64_tr_b16 v[234:235], v9 offset:20992
    buffer_store_dwordx4 v[248:251], v253, s[24:27], s99 offen sc1
    s_waitcnt lgkmcnt(0)
    s_barrier
    v_mfma_f32_16x16x32_bf16 v[172:175], v[220:223], v[52:55], v[172:175]
    ds_read_b128 v[60:63], v4 offset:49152
    ds_read_b64_tr_b16 v[204:205], v6 offset:24576
    v_mfma_f32_16x16x32_bf16 v[176:179], v[220:223], v[56:59], v[176:179]
    ds_read_b128 v[64:67], v4 offset:51200
    ds_read_b64_tr_b16 v[206:207], v6 offset:25088
    v_mfma_f32_16x16x32_bf16 v[180:183], v[224:227], v[52:55], v[180:183]
    ds_read_b64_tr_b16 v[208:209], v7 offset:24576
    v_mfma_f32_16x16x32_bf16 v[184:187], v[224:227], v[56:59], v[184:187]
    ds_read_b64_tr_b16 v[210:211], v7 offset:25088
    v_mfma_f32_16x16x32_bf16 v[188:191], v[228:231], v[52:55], v[188:191]
    ds_read_b64_tr_b16 v[212:213], v8 offset:24576
    v_mfma_f32_16x16x32_bf16 v[192:195], v[228:231], v[56:59], v[192:195]
    ds_read_b64_tr_b16 v[214:215], v8 offset:25088
    v_mfma_f32_16x16x32_bf16 v[196:199], v[232:235], v[52:55], v[196:199]
    ds_read_b64_tr_b16 v[216:217], v9 offset:24576
    v_mfma_f32_16x16x32_bf16 v[200:203], v[232:235], v[56:59], v[200:203]
    ds_read_b64_tr_b16 v[218:219], v9 offset:25088
    s_waitcnt lgkmcnt(6)
    v_mfma_f32_16x16x32_bf16 v[172:175], v[204:207], v[60:63], v[172:175]
    ds_read_b128 v[68:71], v5 offset:49152
    ds_read_b64_tr_b16 v[220:221], v6 offset:28672
    v_mfma_f32_16x16x32_bf16 v[176:179], v[204:207], v[64:67], v[176:179]
    ds_read_b128 v[72:75], v5 offset:51200
    ds_read_b64_tr_b16 v[222:223], v6 offset:29184
    s_waitcnt lgkmcnt(8)
    v_mfma_f32_16x16x32_bf16 v[180:183], v[208:211], v[60:63], v[180:183]
    ds_read_b64_tr_b16 v[224:225], v7 offset:28672
    v_mfma_f32_16x16x32_bf16 v[184:187], v[208:211], v[64:67], v[184:187]
    ds_read_b64_tr_b16 v[226:227], v7 offset:29184
    s_waitcnt lgkmcnt(8)
    v_mfma_f32_16x16x32_bf16 v[188:191], v[212:215], v[60:63], v[188:191]
    ds_read_b64_tr_b16 v[228:229], v8 offset:28672
    v_mfma_f32_16x16x32_bf16 v[192:195], v[212:215], v[64:67], v[192:195]
    ds_read_b64_tr_b16 v[230:231], v8 offset:29184
    s_waitcnt lgkmcnt(8)
    v_mfma_f32_16x16x32_bf16 v[196:199], v[216:219], v[60:63], v[196:199]
    ds_read_b64_tr_b16 v[232:233], v9 offset:28672
    v_mfma_f32_16x16x32_bf16 v[200:203], v[216:219], v[64:67], v[200:203]
    ds_read_b64_tr_b16 v[234:235], v9 offset:29184
    s_waitcnt lgkmcnt(0)
    s_barrier
    v_mfma_f32_16x16x32_bf16 v[172:175], v[220:223], v[68:71], v[172:175]
    ds_read_b128 v[76:79], v4 offset:0
    ds_read_b64_tr_b16 v[204:205], v6 offset:0
    v_mfma_f32_16x16x32_bf16 v[176:179], v[220:223], v[72:75], v[176:179]
    ds_read_b128 v[80:83], v4 offset:2048
    ds_read_b64_tr_b16 v[206:207], v6 offset:512
    v_mfma_f32_16x16x32_bf16 v[180:183], v[224:227], v[68:71], v[180:183]
    ds_read_b64_tr_b16 v[208:209], v7 offset:0
    v_mfma_f32_16x16x32_bf16 v[184:187], v[224:227], v[72:75], v[184:187]
    ds_read_b64_tr_b16 v[210:211], v7 offset:512
    v_mfma_f32_16x16x32_bf16 v[188:191], v[228:231], v[68:71], v[188:191]
    ds_read_b64_tr_b16 v[212:213], v8 offset:0
    v_mfma_f32_16x16x32_bf16 v[192:195], v[228:231], v[72:75], v[192:195]
    ds_read_b64_tr_b16 v[214:215], v8 offset:512
    v_mfma_f32_16x16x32_bf16 v[196:199], v[232:235], v[68:71], v[196:199]
    ds_read_b64_tr_b16 v[216:217], v9 offset:0
    v_mfma_f32_16x16x32_bf16 v[200:203], v[232:235], v[72:75], v[200:203]
    ds_read_b64_tr_b16 v[218:219], v9 offset:512
    s_waitcnt lgkmcnt(6)
    v_mfma_f32_16x16x32_bf16 v[172:175], v[204:207], v[76:79], v[172:175]
    ds_read_b128 v[84:87], v5 offset:0
    ds_read_b64_tr_b16 v[220:221], v6 offset:4096
    v_mfma_f32_16x16x32_bf16 v[176:179], v[204:207], v[80:83], v[176:179]
    ds_read_b128 v[88:91], v5 offset:2048
    ds_read_b64_tr_b16 v[222:223], v6 offset:4608
    s_waitcnt lgkmcnt(8)
    v_mfma_f32_16x16x32_bf16 v[180:183], v[208:211], v[76:79], v[180:183]
    ds_read_b64_tr_b16 v[224:225], v7 offset:4096
    v_mfma_f32_16x16x32_bf16 v[184:187], v[208:211], v[80:83], v[184:187]
    ds_read_b64_tr_b16 v[226:227], v7 offset:4608
    s_waitcnt lgkmcnt(8)
    v_mfma_f32_16x16x32_bf16 v[188:191], v[212:215], v[76:79], v[188:191]
    ds_read_b64_tr_b16 v[228:229], v8 offset:4096
    v_mfma_f32_16x16x32_bf16 v[192:195], v[212:215], v[80:83], v[192:195]
    ds_read_b64_tr_b16 v[230:231], v8 offset:4608
    s_waitcnt lgkmcnt(8)
    v_mfma_f32_16x16x32_bf16 v[196:199], v[216:219], v[76:79], v[196:199]
    ds_read_b64_tr_b16 v[232:233], v9 offset:4096
    v_mfma_f32_16x16x32_bf16 v[200:203], v[216:219], v[80:83], v[200:203]
    ds_read_b64_tr_b16 v[234:235], v9 offset:4608
    s_waitcnt lgkmcnt(0)
    s_waitcnt vmcnt(0)
    s_barrier
    v_mfma_f32_16x16x32_bf16 v[172:175], v[220:223], v[84:87], v[172:175]
    ds_read_b128 v[92:95], v4 offset:16384
    ds_read_b64_tr_b16 v[204:205], v6 offset:8192
    v_mfma_f32_16x16x32_bf16 v[176:179], v[220:223], v[88:91], v[176:179]
    ds_read_b128 v[96:99], v4 offset:18432
    ds_read_b64_tr_b16 v[206:207], v6 offset:8704
    v_mfma_f32_16x16x32_bf16 v[180:183], v[224:227], v[84:87], v[180:183]
    ds_read_b64_tr_b16 v[208:209], v7 offset:8192
    v_mfma_f32_16x16x32_bf16 v[184:187], v[224:227], v[88:91], v[184:187]
    ds_read_b64_tr_b16 v[210:211], v7 offset:8704
    v_mfma_f32_16x16x32_bf16 v[188:191], v[228:231], v[84:87], v[188:191]
    ds_read_b64_tr_b16 v[212:213], v8 offset:8192
    v_mfma_f32_16x16x32_bf16 v[192:195], v[228:231], v[88:91], v[192:195]
    ds_read_b64_tr_b16 v[214:215], v8 offset:8704
    v_mfma_f32_16x16x32_bf16 v[196:199], v[232:235], v[84:87], v[196:199]
    ds_read_b64_tr_b16 v[216:217], v9 offset:8192
    v_mfma_f32_16x16x32_bf16 v[200:203], v[232:235], v[88:91], v[200:203]
    ds_read_b64_tr_b16 v[218:219], v9 offset:8704
    s_waitcnt lgkmcnt(6)
    v_mfma_f32_16x16x32_bf16 v[172:175], v[204:207], v[92:95], v[172:175]
    ds_read_b128 v[100:103], v5 offset:16384
    ds_read_b64_tr_b16 v[220:221], v6 offset:12288
    v_mfma_f32_16x16x32_bf16 v[176:179], v[204:207], v[96:99], v[176:179]
    ds_read_b128 v[104:107], v5 offset:18432
    ds_read_b64_tr_b16 v[222:223], v6 offset:12800
    s_waitcnt lgkmcnt(8)
    v_mfma_f32_16x16x32_bf16 v[180:183], v[208:211], v[92:95], v[180:183]
    ds_read_b64_tr_b16 v[224:225], v7 offset:12288
    v_mfma_f32_16x16x32_bf16 v[184:187], v[208:211], v[96:99], v[184:187]
    ds_read_b64_tr_b16 v[226:227], v7 offset:12800
    s_waitcnt lgkmcnt(8)
    v_mfma_f32_16x16x32_bf16 v[188:191], v[212:215], v[92:95], v[188:191]
    ds_read_b64_tr_b16 v[228:229], v8 offset:12288
    v_mfma_f32_16x16x32_bf16 v[192:195], v[212:215], v[96:99], v[192:195]
    ds_read_b64_tr_b16 v[230:231], v8 offset:12800
    s_waitcnt lgkmcnt(8)
    v_mfma_f32_16x16x32_bf16 v[196:199], v[216:219], v[92:95], v[196:199]
    ds_read_b64_tr_b16 v[232:233], v9 offset:12288
    v_mfma_f32_16x16x32_bf16 v[200:203], v[216:219], v[96:99], v[200:203]
    ds_read_b64_tr_b16 v[234:235], v9 offset:12800
    s_waitcnt lgkmcnt(0)
    s_barrier
    v_mfma_f32_16x16x32_bf16 v[172:175], v[220:223], v[100:103], v[172:175]
    ds_read_b128 v[108:111], v4 offset:32768
    ds_read_b64_tr_b16 v[204:205], v6 offset:16384
    v_mfma_f32_16x16x32_bf16 v[176:179], v[220:223], v[104:107], v[176:179]
    ds_read_b128 v[112:115], v4 offset:34816
    ds_read_b64_tr_b16 v[206:207], v6 offset:16896
    v_mfma_f32_16x16x32_bf16 v[180:183], v[224:227], v[100:103], v[180:183]
    ds_read_b64_tr_b16 v[208:209], v7 offset:16384
    v_mfma_f32_16x16x32_bf16 v[184:187], v[224:227], v[104:107], v[184:187]
    ds_read_b64_tr_b16 v[210:211], v7 offset:16896
    v_mfma_f32_16x16x32_bf16 v[188:191], v[228:231], v[100:103], v[188:191]
    ds_read_b64_tr_b16 v[212:213], v8 offset:16384
    v_mfma_f32_16x16x32_bf16 v[192:195], v[228:231], v[104:107], v[192:195]
    ds_read_b64_tr_b16 v[214:215], v8 offset:16896
    v_mfma_f32_16x16x32_bf16 v[196:199], v[232:235], v[100:103], v[196:199]
    ds_read_b64_tr_b16 v[216:217], v9 offset:16384
    v_mfma_f32_16x16x32_bf16 v[200:203], v[232:235], v[104:107], v[200:203]
    ds_read_b64_tr_b16 v[218:219], v9 offset:16896
    s_waitcnt lgkmcnt(6)
    v_mfma_f32_16x16x32_bf16 v[172:175], v[204:207], v[108:111], v[172:175]
    ds_read_b128 v[116:119], v5 offset:32768
    ds_read_b64_tr_b16 v[220:221], v6 offset:20480
    v_mfma_f32_16x16x32_bf16 v[176:179], v[204:207], v[112:115], v[176:179]
    ds_read_b128 v[120:123], v5 offset:34816
    ds_read_b64_tr_b16 v[222:223], v6 offset:20992
    s_waitcnt lgkmcnt(8)
    v_mfma_f32_16x16x32_bf16 v[180:183], v[208:211], v[108:111], v[180:183]
    ds_read_b64_tr_b16 v[224:225], v7 offset:20480
    v_mfma_f32_16x16x32_bf16 v[184:187], v[208:211], v[112:115], v[184:187]
    ds_read_b64_tr_b16 v[226:227], v7 offset:20992
    s_waitcnt lgkmcnt(8)
    v_mfma_f32_16x16x32_bf16 v[188:191], v[212:215], v[108:111], v[188:191]
    ds_read_b64_tr_b16 v[228:229], v8 offset:20480
    v_mfma_f32_16x16x32_bf16 v[192:195], v[212:215], v[112:115], v[192:195]
    ds_read_b64_tr_b16 v[230:231], v8 offset:20992
    s_waitcnt lgkmcnt(8)
    v_mfma_f32_16x16x32_bf16 v[196:199], v[216:219], v[108:111], v[196:199]
    ds_read_b64_tr_b16 v[232:233], v9 offset:20480
    v_mfma_f32_16x16x32_bf16 v[200:203], v[216:219], v[112:115], v[200:203]
    ds_read_b64_tr_b16 v[234:235], v9 offset:20992
    s_waitcnt lgkmcnt(0)
    s_barrier
    v_mfma_f32_16x16x32_bf16 v[172:175], v[220:223], v[116:119], v[172:175]
    ds_read_b128 v[124:127], v4 offset:49152
    ds_read_b64_tr_b16 v[204:205], v6 offset:24576
    v_mfma_f32_16x16x32_bf16 v[176:179], v[220:223], v[120:123], v[176:179]
    ds_read_b128 v[128:131], v4 offset:51200
    ds_read_b64_tr_b16 v[206:207], v6 offset:25088
    v_mfma_f32_16x16x32_bf16 v[180:183], v[224:227], v[116:119], v[180:183]
    ds_read_b64_tr_b16 v[208:209], v7 offset:24576
    v_mfma_f32_16x16x32_bf16 v[184:187], v[224:227], v[120:123], v[184:187]
    ds_read_b64_tr_b16 v[210:211], v7 offset:25088
    v_mfma_f32_16x16x32_bf16 v[188:191], v[228:231], v[116:119], v[188:191]
    ds_read_b64_tr_b16 v[212:213], v8 offset:24576
    v_mfma_f32_16x16x32_bf16 v[192:195], v[228:231], v[120:123], v[192:195]
    ds_read_b64_tr_b16 v[214:215], v8 offset:25088
    v_mfma_f32_16x16x32_bf16 v[196:199], v[232:235], v[116:119], v[196:199]
    ds_read_b64_tr_b16 v[216:217], v9 offset:24576
    v_mfma_f32_16x16x32_bf16 v[200:203], v[232:235], v[120:123], v[200:203]
    ds_read_b64_tr_b16 v[218:219], v9 offset:25088
    s_waitcnt lgkmcnt(6)
    v_mfma_f32_16x16x32_bf16 v[172:175], v[204:207], v[124:127], v[172:175]
    ds_read_b128 v[132:135], v5 offset:49152
    ds_read_b64_tr_b16 v[220:221], v6 offset:28672
    v_mfma_f32_16x16x32_bf16 v[176:179], v[204:207], v[128:131], v[176:179]
    ds_read_b128 v[136:139], v5 offset:51200
    ds_read_b64_tr_b16 v[222:223], v6 offset:29184
    s_waitcnt lgkmcnt(8)
    v_mfma_f32_16x16x32_bf16 v[180:183], v[208:211], v[124:127], v[180:183]
    ds_read_b64_tr_b16 v[224:225], v7 offset:28672
    v_mfma_f32_16x16x32_bf16 v[184:187], v[208:211], v[128:131], v[184:187]
    ds_read_b64_tr_b16 v[226:227], v7 offset:29184
    s_waitcnt lgkmcnt(8)
    v_mfma_f32_16x16x32_bf16 v[188:191], v[212:215], v[124:127], v[188:191]
    ds_read_b64_tr_b16 v[228:229], v8 offset:28672
    v_mfma_f32_16x16x32_bf16 v[192:195], v[212:215], v[128:131], v[192:195]
    ds_read_b64_tr_b16 v[230:231], v8 offset:29184
    s_waitcnt lgkmcnt(8)
    v_mfma_f32_16x16x32_bf16 v[196:199], v[216:219], v[124:127], v[196:199]
    ds_read_b64_tr_b16 v[232:233], v9 offset:28672
    v_mfma_f32_16x16x32_bf16 v[200:203], v[216:219], v[128:131], v[200:203]
    ds_read_b64_tr_b16 v[234:235], v9 offset:29184
    s_waitcnt lgkmcnt(0)
    s_barrier
    v_mfma_f32_16x16x32_bf16 v[172:175], v[220:223], v[132:135], v[172:175]
    ds_read_b128 v[140:143], v4 offset:0
    ds_read_b64_tr_b16 v[204:205], v6 offset:0
    v_mfma_f32_16x16x32_bf16 v[176:179], v[220:223], v[136:139], v[176:179]
    ds_read_b128 v[144:147], v4 offset:2048
    ds_read_b64_tr_b16 v[206:207], v6 offset:512
    v_mfma_f32_16x16x32_bf16 v[180:183], v[224:227], v[132:135], v[180:183]
    ds_read_b64_tr_b16 v[208:209], v7 offset:0
    v_mfma_f32_16x16x32_bf16 v[184:187], v[224:227], v[136:139], v[184:187]
    ds_read_b64_tr_b16 v[210:211], v7 offset:512
    v_mfma_f32_16x16x32_bf16 v[188:191], v[228:231], v[132:135], v[188:191]
    ds_read_b64_tr_b16 v[212:213], v8 offset:0
    v_mfma_f32_16x16x32_bf16 v[192:195], v[228:231], v[136:139], v[192:195]
    ds_read_b64_tr_b16 v[214:215], v8 offset:512
    v_mfma_f32_16x16x32_bf16 v[196:199], v[232:235], v[132:135], v[196:199]
    ds_read_b64_tr_b16 v[216:217], v9 offset:0
    v_mfma_f32_16x16x32_bf16 v[200:203], v[232:235], v[136:139], v[200:203]
    ds_read_b64_tr_b16 v[218:219], v9 offset:512
    s_waitcnt lgkmcnt(6)
    v_mfma_f32_16x16x32_bf16 v[172:175], v[204:207], v[140:143], v[172:175]
    ds_read_b128 v[148:151], v5 offset:0
    ds_read_b64_tr_b16 v[220:221], v6 offset:4096
    v_mfma_f32_16x16x32_bf16 v[176:179], v[204:207], v[144:147], v[176:179]
    ds_read_b128 v[152:155], v5 offset:2048
    ds_read_b64_tr_b16 v[222:223], v6 offset:4608
    s_waitcnt lgkmcnt(8)
    v_mfma_f32_16x16x32_bf16 v[180:183], v[208:211], v[140:143], v[180:183]
    ds_read_b64_tr_b16 v[224:225], v7 offset:4096
    v_mfma_f32_16x16x32_bf16 v[184:187], v[208:211], v[144:147], v[184:187]
    ds_read_b64_tr_b16 v[226:227], v7 offset:4608
    s_waitcnt lgkmcnt(8)
    v_mfma_f32_16x16x32_bf16 v[188:191], v[212:215], v[140:143], v[188:191]
    ds_read_b64_tr_b16 v[228:229], v8 offset:4096
    v_mfma_f32_16x16x32_bf16 v[192:195], v[212:215], v[144:147], v[192:195]
    ds_read_b64_tr_b16 v[230:231], v8 offset:4608
    s_waitcnt lgkmcnt(8)
    v_mfma_f32_16x16x32_bf16 v[196:199], v[216:219], v[140:143], v[196:199]
    ds_read_b64_tr_b16 v[232:233], v9 offset:4096
    v_mfma_f32_16x16x32_bf16 v[200:203], v[216:219], v[144:147], v[200:203]
    ds_read_b64_tr_b16 v[234:235], v9 offset:4608
    s_waitcnt lgkmcnt(0)
    s_barrier
    v_mfma_f32_16x16x32_bf16 v[172:175], v[220:223], v[148:151], v[172:175]
    ds_read_b128 v[156:159], v4 offset:16384
    ds_read_b64_tr_b16 v[204:205], v6 offset:8192
    v_mfma_f32_16x16x32_bf16 v[176:179], v[220:223], v[152:155], v[176:179]
    ds_read_b128 v[160:163], v4 offset:18432
    ds_read_b64_tr_b16 v[206:207], v6 offset:8704
    v_mfma_f32_16x16x32_bf16 v[180:183], v[224:227], v[148:151], v[180:183]
    ds_read_b64_tr_b16 v[208:209], v7 offset:8192
    v_mfma_f32_16x16x32_bf16 v[184:187], v[224:227], v[152:155], v[184:187]
    ds_read_b64_tr_b16 v[210:211], v7 offset:8704
    v_mfma_f32_16x16x32_bf16 v[188:191], v[228:231], v[148:151], v[188:191]
    ds_read_b64_tr_b16 v[212:213], v8 offset:8192
    v_mfma_f32_16x16x32_bf16 v[192:195], v[228:231], v[152:155], v[192:195]
    ds_read_b64_tr_b16 v[214:215], v8 offset:8704
    v_mfma_f32_16x16x32_bf16 v[196:199], v[232:235], v[148:151], v[196:199]
    ds_read_b64_tr_b16 v[216:217], v9 offset:8192
    v_mfma_f32_16x16x32_bf16 v[200:203], v[232:235], v[152:155], v[200:203]
    ds_read_b64_tr_b16 v[218:219], v9 offset:8704
    s_waitcnt lgkmcnt(6)
    v_mfma_f32_16x16x32_bf16 v[172:175], v[204:207], v[156:159], v[172:175]
    ds_read_b128 v[164:167], v5 offset:16384
    ds_read_b64_tr_b16 v[220:221], v6 offset:12288
    v_mfma_f32_16x16x32_bf16 v[176:179], v[204:207], v[160:163], v[176:179]
    ds_read_b128 v[168:171], v5 offset:18432
    ds_read_b64_tr_b16 v[222:223], v6 offset:12800
    s_waitcnt lgkmcnt(8)
    v_mfma_f32_16x16x32_bf16 v[180:183], v[208:211], v[156:159], v[180:183]
    ds_read_b64_tr_b16 v[224:225], v7 offset:12288
    v_mfma_f32_16x16x32_bf16 v[184:187], v[208:211], v[160:163], v[184:187]
    ds_read_b64_tr_b16 v[226:227], v7 offset:12800
    s_waitcnt lgkmcnt(8)
    v_mfma_f32_16x16x32_bf16 v[188:191], v[212:215], v[156:159], v[188:191]
    ds_read_b64_tr_b16 v[228:229], v8 offset:12288
    v_mfma_f32_16x16x32_bf16 v[192:195], v[212:215], v[160:163], v[192:195]
    ds_read_b64_tr_b16 v[230:231], v8 offset:12800
    s_waitcnt lgkmcnt(8)
    v_mfma_f32_16x16x32_bf16 v[196:199], v[216:219], v[156:159], v[196:199]
    ds_read_b64_tr_b16 v[232:233], v9 offset:12288
    v_mfma_f32_16x16x32_bf16 v[200:203], v[216:219], v[160:163], v[200:203]
    ds_read_b64_tr_b16 v[234:235], v9 offset:12800
    s_waitcnt lgkmcnt(0)
    s_barrier
    v_mfma_f32_16x16x32_bf16 v[172:175], v[220:223], v[164:167], v[172:175]
    v_add_u32 v6, 0xffff0000, v6
    ds_read_b64_tr_b16 v[204:205], v6 offset:32768
    v_mfma_f32_16x16x32_bf16 v[176:179], v[220:223], v[168:171], v[176:179]
    ds_read_b64_tr_b16 v[206:207], v6 offset:33280
    v_mfma_f32_16x16x32_bf16 v[180:183], v[224:227], v[164:167], v[180:183]
    v_add_u32 v7, 0xffff0000, v7
    ds_read_b64_tr_b16 v[208:209], v7 offset:32768
    v_mfma_f32_16x16x32_bf16 v[184:187], v[224:227], v[168:171], v[184:187]
    ds_read_b64_tr_b16 v[210:211], v7 offset:33280
    v_mfma_f32_16x16x32_bf16 v[188:191], v[228:231], v[164:167], v[188:191]
    v_add_u32 v8, 0xffff0000, v8
    ds_read_b64_tr_b16 v[212:213], v8 offset:32768
    v_mfma_f32_16x16x32_bf16 v[192:195], v[228:231], v[168:171], v[192:195]
    ds_read_b64_tr_b16 v[214:215], v8 offset:33280
    v_mfma_f32_16x16x32_bf16 v[196:199], v[232:235], v[164:167], v[196:199]
    v_add_u32 v9, 0xffff0000, v9
    ds_read_b64_tr_b16 v[216:217], v9 offset:32768
    v_mfma_f32_16x16x32_bf16 v[200:203], v[232:235], v[168:171], v[200:203]
    ds_read_b64_tr_b16 v[218:219], v9 offset:33280
    s_setprio 3
    v_mul_f32 v172, s56, v172
    v_mul_f32 v173, s56, v173
    v_mul_f32 v174, s56, v174
    v_mul_f32 v175, s56, v175
    v_mul_f32 v176, s56, v176
    v_mul_f32 v177, s56, v177
    v_mul_f32 v178, s56, v178
    v_mul_f32 v179, s56, v179
    v_cvt_pk_bf16_f32 v236, v172, v173
    v_cvt_pk_bf16_f32 v237, v174, v175
    v_cvt_pk_bf16_f32 v238, v176, v177
    v_cvt_pk_bf16_f32 v239, v178, v179
    s_waitcnt lgkmcnt(6)
    v_mfma_f32_16x16x32_bf16 v[172:175], v[204:207], v[12:15], 0
    ds_read_b64_tr_b16 v[220:221], v6 offset:36864
    v_mfma_f32_16x16x32_bf16 v[176:179], v[204:207], v[16:19], 0
    ds_read_b64_tr_b16 v[222:223], v6 offset:37376
    v_mul_f32 v180, s56, v180
    v_mul_f32 v181, s56, v181
    v_mul_f32 v182, s56, v182
    v_mul_f32 v183, s56, v183
    v_mul_f32 v184, s56, v184
    v_mul_f32 v185, s56, v185
    v_mul_f32 v186, s56, v186
    v_mul_f32 v187, s56, v187
    v_cvt_pk_bf16_f32 v240, v180, v181
    v_cvt_pk_bf16_f32 v241, v182, v183
    v_cvt_pk_bf16_f32 v242, v184, v185
    v_cvt_pk_bf16_f32 v243, v186, v187
    s_waitcnt lgkmcnt(6)
    v_mfma_f32_16x16x32_bf16 v[180:183], v[208:211], v[12:15], 0
    ds_read_b64_tr_b16 v[224:225], v7 offset:36864
    v_mfma_f32_16x16x32_bf16 v[184:187], v[208:211], v[16:19], 0
    ds_read_b64_tr_b16 v[226:227], v7 offset:37376
    buffer_store_dwordx4 v[236:239], v10, s[24:27], s45 offen sc1
    s_add_u32 s45, s45, 66560
    v_mul_f32 v188, s56, v188
    v_mul_f32 v189, s56, v189
    v_mul_f32 v190, s56, v190
    v_mul_f32 v191, s56, v191
    v_mul_f32 v192, s56, v192
    v_mul_f32 v193, s56, v193
    v_mul_f32 v194, s56, v194
    v_mul_f32 v195, s56, v195
    v_cvt_pk_bf16_f32 v244, v188, v189
    v_cvt_pk_bf16_f32 v245, v190, v191
    v_cvt_pk_bf16_f32 v246, v192, v193
    v_cvt_pk_bf16_f32 v247, v194, v195
    s_waitcnt lgkmcnt(6)
    v_mfma_f32_16x16x32_bf16 v[188:191], v[212:215], v[12:15], 0
    ds_read_b64_tr_b16 v[228:229], v8 offset:36864
    v_mfma_f32_16x16x32_bf16 v[192:195], v[212:215], v[16:19], 0
    ds_read_b64_tr_b16 v[230:231], v8 offset:37376
    v_mul_f32 v196, s56, v196
    v_mul_f32 v197, s56, v197
    v_mul_f32 v198, s56, v198
    v_mul_f32 v199, s56, v199
    v_mul_f32 v200, s56, v200
    v_mul_f32 v201, s56, v201
    v_mul_f32 v202, s56, v202
    v_mul_f32 v203, s56, v203
    v_cvt_pk_bf16_f32 v248, v196, v197
    v_cvt_pk_bf16_f32 v249, v198, v199
    v_cvt_pk_bf16_f32 v250, v200, v201
    v_cvt_pk_bf16_f32 v251, v202, v203
    s_waitcnt lgkmcnt(6)
    v_mfma_f32_16x16x32_bf16 v[196:199], v[216:219], v[12:15], 0
    ds_read_b64_tr_b16 v[232:233], v9 offset:36864
    v_mfma_f32_16x16x32_bf16 v[200:203], v[216:219], v[16:19], 0
    ds_read_b64_tr_b16 v[234:235], v9 offset:37376
    s_waitcnt lgkmcnt(6)
    v_mfma_f32_16x16x32_bf16 v[172:175], v[220:223], v[20:23], v[172:175]
    ds_read_b64_tr_b16 v[204:205], v6 offset:40960
    v_mfma_f32_16x16x32_bf16 v[176:179], v[220:223], v[24:27], v[176:179]
    ds_read_b64_tr_b16 v[206:207], v6 offset:41472
    s_waitcnt lgkmcnt(6)
    v_mfma_f32_16x16x32_bf16 v[180:183], v[224:227], v[20:23], v[180:183]
    ds_read_b64_tr_b16 v[208:209], v7 offset:40960
    v_mfma_f32_16x16x32_bf16 v[184:187], v[224:227], v[24:27], v[184:187]
    ds_read_b64_tr_b16 v[210:211], v7 offset:41472
    buffer_store_dwordx4 v[240:243], v10, s[24:27], s45 offen sc1
    s_add_u32 s45, s45, 66560
    s_waitcnt lgkmcnt(6)
    v_mfma_f32_16x16x32_bf16 v[188:191], v[228:231], v[20:23], v[188:191]
    ds_read_b64_tr_b16 v[212:213], v8 offset:40960
    v_mfma_f32_16x16x32_bf16 v[192:195], v[228:231], v[24:27], v[192:195]
    ds_read_b64_tr_b16 v[214:215], v8 offset:41472
    s_waitcnt lgkmcnt(6)
    v_mfma_f32_16x16x32_bf16 v[196:199], v[232:235], v[20:23], v[196:199]
    ds_read_b64_tr_b16 v[216:217], v9 offset:40960
    v_mfma_f32_16x16x32_bf16 v[200:203], v[232:235], v[24:27], v[200:203]
    ds_read_b64_tr_b16 v[218:219], v9 offset:41472
    s_waitcnt lgkmcnt(6)
    v_mfma_f32_16x16x32_bf16 v[172:175], v[204:207], v[28:31], v[172:175]
    ds_read_b64_tr_b16 v[220:221], v6 offset:45056
    v_mfma_f32_16x16x32_bf16 v[176:179], v[204:207], v[32:35], v[176:179]
    ds_read_b64_tr_b16 v[222:223], v6 offset:45568
    s_waitcnt lgkmcnt(6)
    v_mfma_f32_16x16x32_bf16 v[180:183], v[208:211], v[28:31], v[180:183]
    ds_read_b64_tr_b16 v[224:225], v7 offset:45056
    v_mfma_f32_16x16x32_bf16 v[184:187], v[208:211], v[32:35], v[184:187]
    ds_read_b64_tr_b16 v[226:227], v7 offset:45568
    buffer_store_dwordx4 v[244:247], v10, s[24:27], s45 offen sc1
    s_add_u32 s45, s45, 66560
    s_waitcnt lgkmcnt(6)
    v_mfma_f32_16x16x32_bf16 v[188:191], v[212:215], v[28:31], v[188:191]
    ds_read_b64_tr_b16 v[228:229], v8 offset:45056
    v_mfma_f32_16x16x32_bf16 v[192:195], v[212:215], v[32:35], v[192:195]
    ds_read_b64_tr_b16 v[230:231], v8 offset:45568
    s_waitcnt lgkmcnt(6)
    v_mfma_f32_16x16x32_bf16 v[196:199], v[216:219], v[28:31], v[196:199]
    ds_read_b64_tr_b16 v[232:233], v9 offset:45056
    v_mfma_f32_16x16x32_bf16 v[200:203], v[216:219], v[32:35], v[200:203]
    ds_read_b64_tr_b16 v[234:235], v9 offset:45568
    s_waitcnt lgkmcnt(0)
    s_barrier
    v_mfma_f32_16x16x32_bf16 v[172:175], v[220:223], v[36:39], v[172:175]
    ds_read_b64_tr_b16 v[204:205], v6 offset:49152
    v_mfma_f32_16x16x32_bf16 v[176:179], v[220:223], v[40:43], v[176:179]
    ds_read_b64_tr_b16 v[206:207], v6 offset:49664
    v_mfma_f32_16x16x32_bf16 v[180:183], v[224:227], v[36:39], v[180:183]
    ds_read_b64_tr_b16 v[208:209], v7 offset:49152
    v_mfma_f32_16x16x32_bf16 v[184:187], v[224:227], v[40:43], v[184:187]
    ds_read_b64_tr_b16 v[210:211], v7 offset:49664
    buffer_store_dwordx4 v[248:251], v10, s[24:27], s45 offen sc1
    v_mfma_f32_16x16x32_bf16 v[188:191], v[228:231], v[36:39], v[188:191]
    ds_read_b64_tr_b16 v[212:213], v8 offset:49152
    v_mfma_f32_16x16x32_bf16 v[192:195], v[228:231], v[40:43], v[192:195]
    ds_read_b64_tr_b16 v[214:215], v8 offset:49664
    v_mfma_f32_16x16x32_bf16 v[196:199], v[232:235], v[36:39], v[196:199]
    ds_read_b64_tr_b16 v[216:217], v9 offset:49152
    v_mfma_f32_16x16x32_bf16 v[200:203], v[232:235], v[40:43], v[200:203]
    ds_read_b64_tr_b16 v[218:219], v9 offset:49664
    s_waitcnt lgkmcnt(6)
    v_mfma_f32_16x16x32_bf16 v[172:175], v[204:207], v[44:47], v[172:175]
    ds_read_b64_tr_b16 v[220:221], v6 offset:53248
    v_mfma_f32_16x16x32_bf16 v[176:179], v[204:207], v[48:51], v[176:179]
    ds_read_b64_tr_b16 v[222:223], v6 offset:53760
    s_waitcnt lgkmcnt(6)
    v_mfma_f32_16x16x32_bf16 v[180:183], v[208:211], v[44:47], v[180:183]
    ds_read_b64_tr_b16 v[224:225], v7 offset:53248
    v_mfma_f32_16x16x32_bf16 v[184:187], v[208:211], v[48:51], v[184:187]
    ds_read_b64_tr_b16 v[226:227], v7 offset:53760
    s_waitcnt lgkmcnt(6)
    v_mfma_f32_16x16x32_bf16 v[188:191], v[212:215], v[44:47], v[188:191]
    ds_read_b64_tr_b16 v[228:229], v8 offset:53248
    v_mfma_f32_16x16x32_bf16 v[192:195], v[212:215], v[48:51], v[192:195]
    ds_read_b64_tr_b16 v[230:231], v8 offset:53760
    s_waitcnt lgkmcnt(6)
    v_mfma_f32_16x16x32_bf16 v[196:199], v[216:219], v[44:47], v[196:199]
    ds_read_b64_tr_b16 v[232:233], v9 offset:53248
    v_mfma_f32_16x16x32_bf16 v[200:203], v[216:219], v[48:51], v[200:203]
    ds_read_b64_tr_b16 v[234:235], v9 offset:53760
    s_waitcnt lgkmcnt(6)
    v_mfma_f32_16x16x32_bf16 v[172:175], v[220:223], v[52:55], v[172:175]
    ds_read_b64_tr_b16 v[204:205], v6 offset:57344
    v_mfma_f32_16x16x32_bf16 v[176:179], v[220:223], v[56:59], v[176:179]
    ds_read_b64_tr_b16 v[206:207], v6 offset:57856
    s_waitcnt lgkmcnt(6)
    v_mfma_f32_16x16x32_bf16 v[180:183], v[224:227], v[52:55], v[180:183]
    ds_read_b64_tr_b16 v[208:209], v7 offset:57344
    v_mfma_f32_16x16x32_bf16 v[184:187], v[224:227], v[56:59], v[184:187]
    ds_read_b64_tr_b16 v[210:211], v7 offset:57856
    s_waitcnt lgkmcnt(6)
    v_mfma_f32_16x16x32_bf16 v[188:191], v[228:231], v[52:55], v[188:191]
    ds_read_b64_tr_b16 v[212:213], v8 offset:57344
    v_mfma_f32_16x16x32_bf16 v[192:195], v[228:231], v[56:59], v[192:195]
    ds_read_b64_tr_b16 v[214:215], v8 offset:57856
    s_waitcnt lgkmcnt(6)
    v_mfma_f32_16x16x32_bf16 v[196:199], v[232:235], v[52:55], v[196:199]
    ds_read_b64_tr_b16 v[216:217], v9 offset:57344
    v_mfma_f32_16x16x32_bf16 v[200:203], v[232:235], v[56:59], v[200:203]
    ds_read_b64_tr_b16 v[218:219], v9 offset:57856
    s_waitcnt lgkmcnt(6)
    v_mfma_f32_16x16x32_bf16 v[172:175], v[204:207], v[60:63], v[172:175]
    ds_read_b64_tr_b16 v[220:221], v6 offset:61440
    v_mfma_f32_16x16x32_bf16 v[176:179], v[204:207], v[64:67], v[176:179]
    ds_read_b64_tr_b16 v[222:223], v6 offset:61952
    s_waitcnt lgkmcnt(6)
    v_mfma_f32_16x16x32_bf16 v[180:183], v[208:211], v[60:63], v[180:183]
    ds_read_b64_tr_b16 v[224:225], v7 offset:61440
    v_mfma_f32_16x16x32_bf16 v[184:187], v[208:211], v[64:67], v[184:187]
    ds_read_b64_tr_b16 v[226:227], v7 offset:61952
    s_waitcnt lgkmcnt(6)
    v_mfma_f32_16x16x32_bf16 v[188:191], v[212:215], v[60:63], v[188:191]
    ds_read_b64_tr_b16 v[228:229], v8 offset:61440
    v_mfma_f32_16x16x32_bf16 v[192:195], v[212:215], v[64:67], v[192:195]
    ds_read_b64_tr_b16 v[230:231], v8 offset:61952
    s_waitcnt lgkmcnt(6)
    v_mfma_f32_16x16x32_bf16 v[196:199], v[216:219], v[60:63], v[196:199]
    ds_read_b64_tr_b16 v[232:233], v9 offset:61440
    v_mfma_f32_16x16x32_bf16 v[200:203], v[216:219], v[64:67], v[200:203]
    ds_read_b64_tr_b16 v[234:235], v9 offset:61952
    s_barrier
    s_waitcnt lgkmcnt(6)
    v_mfma_f32_16x16x32_bf16 v[172:175], v[220:223], v[68:71], v[172:175]
    ds_read_b64_tr_b16 v[204:205], v6 offset:0
    v_mfma_f32_16x16x32_bf16 v[176:179], v[220:223], v[72:75], v[176:179]
    ds_read_b64_tr_b16 v[206:207], v6 offset:512
    s_waitcnt lgkmcnt(6)
    v_mfma_f32_16x16x32_bf16 v[180:183], v[224:227], v[68:71], v[180:183]
    ds_read_b64_tr_b16 v[208:209], v7 offset:0
    v_mfma_f32_16x16x32_bf16 v[184:187], v[224:227], v[72:75], v[184:187]
    ds_read_b64_tr_b16 v[210:211], v7 offset:512
    s_waitcnt lgkmcnt(6)
    v_mfma_f32_16x16x32_bf16 v[188:191], v[228:231], v[68:71], v[188:191]
    ds_read_b64_tr_b16 v[212:213], v8 offset:0
    v_mfma_f32_16x16x32_bf16 v[192:195], v[228:231], v[72:75], v[192:195]
    ds_read_b64_tr_b16 v[214:215], v8 offset:512
    s_waitcnt lgkmcnt(6)
    v_mfma_f32_16x16x32_bf16 v[196:199], v[232:235], v[68:71], v[196:199]
    ds_read_b64_tr_b16 v[216:217], v9 offset:0
    v_mfma_f32_16x16x32_bf16 v[200:203], v[232:235], v[72:75], v[200:203]
    ds_read_b64_tr_b16 v[218:219], v9 offset:512
    s_waitcnt lgkmcnt(6)
    v_mfma_f32_16x16x32_bf16 v[172:175], v[204:207], v[76:79], v[172:175]
    ds_read_b64_tr_b16 v[220:221], v6 offset:4096
    v_mfma_f32_16x16x32_bf16 v[176:179], v[204:207], v[80:83], v[176:179]
    ds_read_b64_tr_b16 v[222:223], v6 offset:4608
    s_waitcnt lgkmcnt(6)
    v_mfma_f32_16x16x32_bf16 v[180:183], v[208:211], v[76:79], v[180:183]
    ds_read_b64_tr_b16 v[224:225], v7 offset:4096
    v_mov_b32 v3, 59808
    v_mfma_f32_16x16x32_bf16 v[184:187], v[208:211], v[80:83], v[184:187]
    ds_read_b64_tr_b16 v[226:227], v7 offset:4608
    s_waitcnt lgkmcnt(6)
    v_mfma_f32_16x16x32_bf16 v[188:191], v[212:215], v[76:79], v[188:191]
    ds_read_b64_tr_b16 v[228:229], v8 offset:4096
    ds_read_b32 v2, v3 offset:32
    v_mfma_f32_16x16x32_bf16 v[192:195], v[212:215], v[80:83], v[192:195]
    ds_read_b64_tr_b16 v[230:231], v8 offset:4608
    s_sub_u32 s33, s47, 128
    s_waitcnt lgkmcnt(7)
    v_mfma_f32_16x16x32_bf16 v[196:199], v[216:219], v[76:79], v[196:199]
    ds_read_b64_tr_b16 v[232:233], v9 offset:4096
    v_mfma_f32_16x16x32_bf16 v[200:203], v[216:219], v[80:83], v[200:203]
    ds_read_b64_tr_b16 v[234:235], v9 offset:4608
    s_waitcnt lgkmcnt(7)
    v_mfma_f32_16x16x32_bf16 v[172:175], v[220:223], v[84:87], v[172:175]
    ds_read_b64_tr_b16 v[204:205], v6 offset:8192
    v_mfma_f32_16x16x32_bf16 v[176:179], v[220:223], v[88:91], v[176:179]
    ds_read_b64_tr_b16 v[206:207], v6 offset:8704
    s_waitcnt lgkmcnt(7)
    v_mfma_f32_16x16x32_bf16 v[180:183], v[224:227], v[84:87], v[180:183]
    ds_read_b64_tr_b16 v[208:209], v7 offset:8192
    v_mfma_f32_16x16x32_bf16 v[184:187], v[224:227], v[88:91], v[184:187]
    ds_read_b64_tr_b16 v[210:211], v7 offset:8704
    s_waitcnt lgkmcnt(6)
    v_mfma_f32_16x16x32_bf16 v[188:191], v[228:231], v[84:87], v[188:191]
    ds_read_b64_tr_b16 v[212:213], v8 offset:8192
    v_mfma_f32_16x16x32_bf16 v[192:195], v[228:231], v[88:91], v[192:195]
    ds_read_b64_tr_b16 v[214:215], v8 offset:8704
    s_waitcnt lgkmcnt(6)
    v_mfma_f32_16x16x32_bf16 v[196:199], v[232:235], v[84:87], v[196:199]
    ds_read_b64_tr_b16 v[216:217], v9 offset:8192
    v_mfma_f32_16x16x32_bf16 v[200:203], v[232:235], v[88:91], v[200:203]
    ds_read_b64_tr_b16 v[218:219], v9 offset:8704
    s_waitcnt lgkmcnt(6)
    v_mfma_f32_16x16x32_bf16 v[172:175], v[204:207], v[92:95], v[172:175]
    ds_read_b64_tr_b16 v[220:221], v6 offset:12288
    v_mov_b32 v3, 0
    s_waitcnt vmcnt(0)
    s_mov_b64 exec, 1
    buffer_store_dword v2, v3, s[24:27], s33 offen sc1
    s_mov_b64 exec, -1
    v_mfma_f32_16x16x32_bf16 v[176:179], v[204:207], v[96:99], v[176:179]
    ds_read_b64_tr_b16 v[222:223], v6 offset:12800
    s_waitcnt lgkmcnt(6)
    v_mfma_f32_16x16x32_bf16 v[180:183], v[208:211], v[92:95], v[180:183]
    ds_read_b64_tr_b16 v[224:225], v7 offset:12288
    v_mfma_f32_16x16x32_bf16 v[184:187], v[208:211], v[96:99], v[184:187]
    ds_read_b64_tr_b16 v[226:227], v7 offset:12800
    s_waitcnt lgkmcnt(6)
    v_mfma_f32_16x16x32_bf16 v[188:191], v[212:215], v[92:95], v[188:191]
    ds_read_b64_tr_b16 v[228:229], v8 offset:12288
    v_mfma_f32_16x16x32_bf16 v[192:195], v[212:215], v[96:99], v[192:195]
    ds_read_b64_tr_b16 v[230:231], v8 offset:12800
    s_waitcnt lgkmcnt(6)
    v_mfma_f32_16x16x32_bf16 v[196:199], v[216:219], v[92:95], v[196:199]
    ds_read_b64_tr_b16 v[232:233], v9 offset:12288
    v_mfma_f32_16x16x32_bf16 v[200:203], v[216:219], v[96:99], v[200:203]
    ds_read_b64_tr_b16 v[234:235], v9 offset:12800
    s_barrier
    s_waitcnt lgkmcnt(6)
    v_mfma_f32_16x16x32_bf16 v[172:175], v[220:223], v[100:103], v[172:175]
    ds_read_b64_tr_b16 v[204:205], v6 offset:16384
    v_mfma_f32_16x16x32_bf16 v[176:179], v[220:223], v[104:107], v[176:179]
    ds_read_b64_tr_b16 v[206:207], v6 offset:16896
    s_waitcnt lgkmcnt(6)
    v_mfma_f32_16x16x32_bf16 v[180:183], v[224:227], v[100:103], v[180:183]
    ds_read_b64_tr_b16 v[208:209], v7 offset:16384
    v_mfma_f32_16x16x32_bf16 v[184:187], v[224:227], v[104:107], v[184:187]
    ds_read_b64_tr_b16 v[210:211], v7 offset:16896
    s_waitcnt lgkmcnt(6)
    v_mfma_f32_16x16x32_bf16 v[188:191], v[228:231], v[100:103], v[188:191]
    ds_read_b64_tr_b16 v[212:213], v8 offset:16384
    v_mfma_f32_16x16x32_bf16 v[192:195], v[228:231], v[104:107], v[192:195]
    ds_read_b64_tr_b16 v[214:215], v8 offset:16896
    s_waitcnt lgkmcnt(6)
    v_mfma_f32_16x16x32_bf16 v[196:199], v[232:235], v[100:103], v[196:199]
    ds_read_b64_tr_b16 v[216:217], v9 offset:16384
    v_mfma_f32_16x16x32_bf16 v[200:203], v[232:235], v[104:107], v[200:203]
    ds_read_b64_tr_b16 v[218:219], v9 offset:16896
    s_waitcnt lgkmcnt(6)
    v_mfma_f32_16x16x32_bf16 v[172:175], v[204:207], v[108:111], v[172:175]
    ds_read_b64_tr_b16 v[220:221], v6 offset:20480
    v_mfma_f32_16x16x32_bf16 v[176:179], v[204:207], v[112:115], v[176:179]
    ds_read_b64_tr_b16 v[222:223], v6 offset:20992
    s_waitcnt lgkmcnt(6)
    v_mfma_f32_16x16x32_bf16 v[180:183], v[208:211], v[108:111], v[180:183]
    ds_read_b64_tr_b16 v[224:225], v7 offset:20480
    v_mfma_f32_16x16x32_bf16 v[184:187], v[208:211], v[112:115], v[184:187]
    ds_read_b64_tr_b16 v[226:227], v7 offset:20992
    s_waitcnt lgkmcnt(6)
    v_mfma_f32_16x16x32_bf16 v[188:191], v[212:215], v[108:111], v[188:191]
    ds_read_b64_tr_b16 v[228:229], v8 offset:20480
    v_mfma_f32_16x16x32_bf16 v[192:195], v[212:215], v[112:115], v[192:195]
    ds_read_b64_tr_b16 v[230:231], v8 offset:20992
    s_waitcnt lgkmcnt(6)
    v_mfma_f32_16x16x32_bf16 v[196:199], v[216:219], v[108:111], v[196:199]
    ds_read_b64_tr_b16 v[232:233], v9 offset:20480
    v_mfma_f32_16x16x32_bf16 v[200:203], v[216:219], v[112:115], v[200:203]
    ds_read_b64_tr_b16 v[234:235], v9 offset:20992
    s_waitcnt lgkmcnt(6)
    v_mfma_f32_16x16x32_bf16 v[172:175], v[220:223], v[116:119], v[172:175]
    ds_read_b64_tr_b16 v[204:205], v6 offset:24576
    v_mfma_f32_16x16x32_bf16 v[176:179], v[220:223], v[120:123], v[176:179]
    ds_read_b64_tr_b16 v[206:207], v6 offset:25088
    s_waitcnt lgkmcnt(6)
    v_mfma_f32_16x16x32_bf16 v[180:183], v[224:227], v[116:119], v[180:183]
    ds_read_b64_tr_b16 v[208:209], v7 offset:24576
    v_mov_b32 v3, 59808
    v_mfma_f32_16x16x32_bf16 v[184:187], v[224:227], v[120:123], v[184:187]
    ds_read_b64_tr_b16 v[210:211], v7 offset:25088
    s_waitcnt lgkmcnt(6)
    v_mfma_f32_16x16x32_bf16 v[188:191], v[228:231], v[116:119], v[188:191]
    ds_read_b64_tr_b16 v[212:213], v8 offset:24576
    ds_read_b96 v[252:254], v3 offset:16
    v_mfma_f32_16x16x32_bf16 v[192:195], v[228:231], v[120:123], v[192:195]
    ds_read_b64_tr_b16 v[214:215], v8 offset:25088
    s_waitcnt lgkmcnt(7)
    v_mfma_f32_16x16x32_bf16 v[196:199], v[232:235], v[116:119], v[196:199]
    ds_read_b64_tr_b16 v[216:217], v9 offset:24576
    v_mfma_f32_16x16x32_bf16 v[200:203], v[232:235], v[120:123], v[200:203]
    ds_read_b64_tr_b16 v[218:219], v9 offset:25088
    s_waitcnt lgkmcnt(7)
    v_mfma_f32_16x16x32_bf16 v[172:175], v[204:207], v[124:127], v[172:175]
    ds_read_b64_tr_b16 v[220:221], v6 offset:28672
    v_mfma_f32_16x16x32_bf16 v[176:179], v[204:207], v[128:131], v[176:179]
    ds_read_b64_tr_b16 v[222:223], v6 offset:29184
    s_waitcnt lgkmcnt(7)
    v_mfma_f32_16x16x32_bf16 v[180:183], v[208:211], v[124:127], v[180:183]
    ds_read_b64_tr_b16 v[224:225], v7 offset:28672
    v_mfma_f32_16x16x32_bf16 v[184:187], v[208:211], v[128:131], v[184:187]
    ds_read_b64_tr_b16 v[226:227], v7 offset:29184
    s_waitcnt lgkmcnt(6)
    v_mfma_f32_16x16x32_bf16 v[188:191], v[212:215], v[124:127], v[188:191]
    ds_read_b64_tr_b16 v[228:229], v8 offset:28672
    v_mfma_f32_16x16x32_bf16 v[192:195], v[212:215], v[128:131], v[192:195]
    ds_read_b64_tr_b16 v[230:231], v8 offset:29184
    s_waitcnt lgkmcnt(6)
    v_mfma_f32_16x16x32_bf16 v[196:199], v[216:219], v[124:127], v[196:199]
    ds_read_b64_tr_b16 v[232:233], v9 offset:28672
    v_mfma_f32_16x16x32_bf16 v[200:203], v[216:219], v[128:131], v[200:203]
    ds_read_b64_tr_b16 v[234:235], v9 offset:29184
    s_barrier
    s_waitcnt lgkmcnt(6)
    v_mfma_f32_16x16x32_bf16 v[172:175], v[220:223], v[132:135], v[172:175]
    ds_read_b64_tr_b16 v[204:205], v6 offset:32768
    v_mfma_f32_16x16x32_bf16 v[176:179], v[220:223], v[136:139], v[176:179]
    ds_read_b64_tr_b16 v[206:207], v6 offset:33280
    s_waitcnt lgkmcnt(6)
    v_mfma_f32_16x16x32_bf16 v[180:183], v[224:227], v[132:135], v[180:183]
    ds_read_b64_tr_b16 v[208:209], v6 offset:36864
    v_mfma_f32_16x16x32_bf16 v[184:187], v[224:227], v[136:139], v[184:187]
    ds_read_b64_tr_b16 v[210:211], v6 offset:37376
    s_waitcnt lgkmcnt(6)
    v_mfma_f32_16x16x32_bf16 v[188:191], v[228:231], v[132:135], v[188:191]
    ds_read_b64_tr_b16 v[212:213], v6 offset:40960
    v_mfma_f32_16x16x32_bf16 v[192:195], v[228:231], v[136:139], v[192:195]
    ds_read_b64_tr_b16 v[214:215], v6 offset:41472
    s_waitcnt lgkmcnt(6)
    v_mfma_f32_16x16x32_bf16 v[196:199], v[232:235], v[132:135], v[196:199]
    ds_read_b64_tr_b16 v[216:217], v6 offset:45056
    v_mfma_f32_16x16x32_bf16 v[200:203], v[232:235], v[136:139], v[200:203]
    ds_read_b64_tr_b16 v[218:219], v6 offset:45568
    v_readfirstlane_b32 s96, v252
    v_readfirstlane_b32 s97, v253
    v_readfirstlane_b32 s32, v254
    s_nop 0
    s_and_b32 s33, s58, s32
    s_cbranch_scc0 C_STB_SC1
    s_waitcnt lgkmcnt(6)
    v_mfma_f32_16x16x32_bf16 v[172:175], v[204:207], v[140:143], v[172:175]
    ds_read_b64_tr_b16 v[220:221], v7 offset:32768
    v_mfma_f32_16x16x32_bf16 v[176:179], v[204:207], v[144:147], v[176:179]
    ds_read_b64_tr_b16 v[222:223], v7 offset:33280
    s_waitcnt lgkmcnt(6)
    v_mfma_f32_16x16x32_bf16 v[172:175], v[208:211], v[148:151], v[172:175]
    ds_read_b64_tr_b16 v[224:225], v7 offset:36864
    v_mfma_f32_16x16x32_bf16 v[176:179], v[208:211], v[152:155], v[176:179]
    ds_read_b64_tr_b16 v[226:227], v7 offset:37376
    s_waitcnt lgkmcnt(6)
    v_mfma_f32_16x16x32_bf16 v[172:175], v[212:215], v[156:159], v[172:175]
    ds_read_b64_tr_b16 v[228:229], v7 offset:40960
    v_mfma_f32_16x16x32_bf16 v[176:179], v[212:215], v[160:163], v[176:179]
    ds_read_b64_tr_b16 v[230:231], v7 offset:41472
    s_waitcnt lgkmcnt(6)
    v_mfma_f32_16x16x32_bf16 v[172:175], v[216:219], v[164:167], v[172:175]
    ds_read_b64_tr_b16 v[232:233], v7 offset:45056
    v_mfma_f32_16x16x32_bf16 v[176:179], v[216:219], v[168:171], v[176:179]
    ds_read_b64_tr_b16 v[234:235], v7 offset:45568
    s_waitcnt lgkmcnt(6)
    v_mfma_f32_16x16x32_bf16 v[180:183], v[220:223], v[140:143], v[180:183]
    ds_read_b64_tr_b16 v[204:205], v8 offset:32768
    v_mfma_f32_16x16x32_bf16 v[184:187], v[220:223], v[144:147], v[184:187]
    ds_read_b64_tr_b16 v[206:207], v8 offset:33280
    s_waitcnt lgkmcnt(6)
    v_mfma_f32_16x16x32_bf16 v[180:183], v[224:227], v[148:151], v[180:183]
    ds_read_b64_tr_b16 v[208:209], v8 offset:36864
    v_mfma_f32_16x16x32_bf16 v[184:187], v[224:227], v[152:155], v[184:187]
    ds_read_b64_tr_b16 v[210:211], v8 offset:37376
    v_cvt_pk_bf16_f32 v236, v172, v173
    v_cvt_pk_bf16_f32 v237, v174, v175
    s_waitcnt lgkmcnt(6)
    v_mfma_f32_16x16x32_bf16 v[180:183], v[228:231], v[156:159], v[180:183]
    ds_read_b64_tr_b16 v[212:213], v8 offset:40960
    v_cvt_pk_bf16_f32 v238, v176, v177
    v_cvt_pk_bf16_f32 v239, v178, v179
    v_mfma_f32_16x16x32_bf16 v[184:187], v[228:231], v[160:163], v[184:187]
    ds_read_b64_tr_b16 v[214:215], v8 offset:41472
    buffer_store_dwordx4 v[236:239], v10, s[24:27], s46 offen
    s_add_u32 s46, s46, 66560
    s_waitcnt lgkmcnt(6)
    v_mfma_f32_16x16x32_bf16 v[180:183], v[232:235], v[164:167], v[180:183]
    ds_read_b64_tr_b16 v[216:217], v8 offset:45056
    v_mfma_f32_16x16x32_bf16 v[184:187], v[232:235], v[168:171], v[184:187]
    ds_read_b64_tr_b16 v[218:219], v8 offset:45568
    s_waitcnt lgkmcnt(6)
    v_mfma_f32_16x16x32_bf16 v[188:191], v[204:207], v[140:143], v[188:191]
    ds_read_b64_tr_b16 v[220:221], v9 offset:32768
    v_mfma_f32_16x16x32_bf16 v[192:195], v[204:207], v[144:147], v[192:195]
    ds_read_b64_tr_b16 v[222:223], v9 offset:33280
    s_waitcnt lgkmcnt(6)
    v_mfma_f32_16x16x32_bf16 v[188:191], v[208:211], v[148:151], v[188:191]
    ds_read_b64_tr_b16 v[224:225], v9 offset:36864
    v_mfma_f32_16x16x32_bf16 v[192:195], v[208:211], v[152:155], v[192:195]
    ds_read_b64_tr_b16 v[226:227], v9 offset:37376
    v_cvt_pk_bf16_f32 v240, v180, v181
    v_cvt_pk_bf16_f32 v241, v182, v183
    s_waitcnt lgkmcnt(6)
    v_mfma_f32_16x16x32_bf16 v[188:191], v[212:215], v[156:159], v[188:191]
    ds_read_b64_tr_b16 v[228:229], v9 offset:40960
    v_cvt_pk_bf16_f32 v242, v184, v185
    v_cvt_pk_bf16_f32 v243, v186, v187
    v_mfma_f32_16x16x32_bf16 v[192:195], v[212:215], v[160:163], v[192:195]
    ds_read_b64_tr_b16 v[230:231], v9 offset:41472
    buffer_store_dwordx4 v[240:243], v10, s[24:27], s46 offen
    s_add_u32 s46, s46, 66560
    s_waitcnt lgkmcnt(6)
    v_mfma_f32_16x16x32_bf16 v[188:191], v[216:219], v[164:167], v[188:191]
    ds_read_b64_tr_b16 v[232:233], v9 offset:45056
    v_mfma_f32_16x16x32_bf16 v[192:195], v[216:219], v[168:171], v[192:195]
    ds_read_b64_tr_b16 v[234:235], v9 offset:45568
    s_waitcnt lgkmcnt(6)
    v_mfma_f32_16x16x32_bf16 v[196:199], v[220:223], v[140:143], v[196:199]
    v_mfma_f32_16x16x32_bf16 v[200:203], v[220:223], v[144:147], v[200:203]
    s_waitcnt lgkmcnt(4)
    v_mfma_f32_16x16x32_bf16 v[196:199], v[224:227], v[148:151], v[196:199]
    v_mfma_f32_16x16x32_bf16 v[200:203], v[224:227], v[152:155], v[200:203]
    v_cvt_pk_bf16_f32 v244, v188, v189
    v_cvt_pk_bf16_f32 v245, v190, v191
    s_waitcnt lgkmcnt(2)
    v_mfma_f32_16x16x32_bf16 v[196:199], v[228:231], v[156:159], v[196:199]
    v_cvt_pk_bf16_f32 v246, v192, v193
    v_cvt_pk_bf16_f32 v247, v194, v195
    v_mfma_f32_16x16x32_bf16 v[200:203], v[228:231], v[160:163], v[200:203]
    buffer_store_dwordx4 v[244:247], v10, s[24:27], s46 offen
    s_add_u32 s46, s46, 66560
    s_waitcnt lgkmcnt(0)
    v_mfma_f32_16x16x32_bf16 v[196:199], v[232:235], v[164:167], v[196:199]
    v_mfma_f32_16x16x32_bf16 v[200:203], v[232:235], v[168:171], v[200:203]
    s_nop 6
    v_cvt_pk_bf16_f32 v248, v196, v197
    v_cvt_pk_bf16_f32 v249, v198, v199
    v_cvt_pk_bf16_f32 v250, v200, v201
    v_cvt_pk_bf16_f32 v251, v202, v203
    buffer_store_dwordx4 v[248:251], v10, s[24:27], s46 offen
C_STB_DONE:
    s_setprio 3
    s_barrier
    v_lshlrev_b32 v12, 4, v0
    v_add_u32 v13, 158208, v12
    ds_read_b128 v[240:243], v13 offset:0
    ds_read_b128 v[244:247], v13 offset:1024
    ds_read_b128 v[248:251], v13 offset:2048
    ds_read_b96 v[252:254], v13 offset:3072
    v_cmp_gt_u32 vcc, 32, v0
    v_mov_b32 v14, 0x3f803f80
    s_mul_i32 s49, s4, 83200
    v_cndmask_b32 v230, 0, v14, vcc
    s_lshl_b32 s51, s3, 11
    v_lshrrev_b32 v231, 16, v230
    s_add_u32 s49, s49, s51
    v_mov_b32 v238, v230
    s_lshl_b32 s48, s6, 8
    v_mov_b32 v239, v231
    s_add_u32 s49, s49, s48
    v_mov_b32 v222, s20
    v_writelane_b32 v222, s21, 1
    s_waitcnt lgkmcnt(0)
    v_add_u32 v248, s48, v248
    v_add_u32 v249, s48, v249
    v_mad_u32_u24 v250, v253, s6, v250
    v_add_u32 v251, s49, v251
    v_add_u32 v252, s49, v252
    v_add_u32 v254, s49, v254
    v_mov_b32 v253, v12
    v_mov_b32 v2, s96
    v_lshlrev_b32 v3, 6, v0
    s_lshl_b32 s33, s5, 2
    s_add_u32 s33, s33, s7
    s_lshl_b32 s33, s33, 9
    s_add_u32 s33, s33, 12845056
    s_cmp_eq_u32 s58, 1
    s_cselect_b32 s47, s33, s47
    s_cselect_b32 s34, 0xff, 1
    s_mov_b32 s35, 0
    s_and_b32 s33, s58, s32
    s_waitcnt vmcnt(0)
    s_mov_b64 exec, s[34:35]
    s_cbranch_scc0 C_FB_SC1
    buffer_store_dword v2, v3, s[24:27], s47 offen
    s_branch C_FB_DONE
C_FB_SC1:
    buffer_store_dword v2, v3, s[24:27], s47 offen sc1
C_FB_DONE:
    s_mov_b64 exec, -1
    s_branch C_PREP
C_SPARE:
    s_waitcnt lgkmcnt(0)
    v_mov_b32 v200, 0
    v_mov_b32 v201, 0
    v_mov_b32 v202, 0
    v_mov_b32 v203, 0
    s_barrier
    ds_read_b128 v[236:239], v167 offset:4096
    ds_read_b128 v[240:243], v165 offset:12288
    ds_read_b128 v[244:247], v164 offset:12288
    ds_read_b128 v[248:251], v166 offset:0
    s_waitcnt lgkmcnt(3)
    v_mfma_f32_16x16x32_bf16 v[124:127], v[236:239], v[44:47], 0
    ds_read_b128 v[12:15], v31 offset:5120
    v_mfma_f32_16x16x32_bf16 v[128:131], v[236:239], v[48:51], 0
    ds_read_b128 v[16:19], v29 offset:13312
    v_mfma_f32_16x16x32_bf16 v[132:135], v[236:239], v[52:55], 0
    ds_read_b128 v[20:23], v28 offset:13312
    v_mfma_f32_16x16x32_bf16 v[136:139], v[236:239], v[56:59], 0
    ds_read_b128 v[24:27], v30 offset:1024
    s_waitcnt lgkmcnt(6)
    v_mfma_f32_16x16x32_bf16 v[124:127], v[240:243], v[48:51], v[124:127]
    v_mfma_f32_16x16x32_bf16 v[132:135], v[240:243], v[56:59], v[132:135]
    s_waitcnt lgkmcnt(5)
    v_mfma_f32_16x16x32_bf16 v[128:131], v[244:247], v[44:47], v[128:131]
    v_mfma_f32_16x16x32_bf16 v[136:139], v[244:247], v[52:55], v[136:139]
    s_waitcnt lgkmcnt(4)
    v_mfma_f32_16x16x32_bf16 v[140:143], v[248:251], v[60:63], 0
    s_waitcnt lgkmcnt(3)
    v_mfma_f32_16x16x32_bf16 v[124:127], v[12:15], v[64:67], v[124:127]
    ds_read_b128 v[236:239], v167 offset:6144
    v_mfma_f32_16x16x32_bf16 v[128:131], v[12:15], v[68:71], v[128:131]
    ds_read_b128 v[240:243], v165 offset:14336
    v_mfma_f32_16x16x32_bf16 v[132:135], v[12:15], v[72:75], v[132:135]
    ds_read_b128 v[244:247], v164 offset:14336
    v_mfma_f32_16x16x32_bf16 v[136:139], v[12:15], v[76:79], v[136:139]
    ds_read_b128 v[248:251], v166 offset:2048
    s_waitcnt lgkmcnt(6)
    v_mfma_f32_16x16x32_bf16 v[124:127], v[16:19], v[68:71], v[124:127]
    v_mfma_f32_16x16x32_bf16 v[132:135], v[16:19], v[76:79], v[132:135]
    s_waitcnt lgkmcnt(5)
    v_mfma_f32_16x16x32_bf16 v[128:131], v[20:23], v[64:67], v[128:131]
    v_mfma_f32_16x16x32_bf16 v[136:139], v[20:23], v[72:75], v[136:139]
    s_waitcnt lgkmcnt(4)
    v_mfma_f32_16x16x32_bf16 v[140:143], v[24:27], v[80:83], v[140:143]
    s_waitcnt lgkmcnt(3)
    v_mfma_f32_16x16x32_bf16 v[124:127], v[236:239], v[84:87], v[124:127]
    ds_read_b128 v[12:15], v31 offset:7168
    v_mfma_f32_16x16x32_bf16 v[128:131], v[236:239], v[88:91], v[128:131]
    ds_read_b128 v[16:19], v29 offset:15360
    v_mfma_f32_16x16x32_bf16 v[132:135], v[236:239], v[92:95], v[132:135]
    ds_read_b128 v[20:23], v28 offset:15360
    v_mfma_f32_16x16x32_bf16 v[136:139], v[236:239], v[96:99], v[136:139]
    ds_read_b128 v[24:27], v30 offset:3072
    s_waitcnt lgkmcnt(6)
    v_mfma_f32_16x16x32_bf16 v[124:127], v[240:243], v[88:91], v[124:127]
    v_mfma_f32_16x16x32_bf16 v[132:135], v[240:243], v[96:99], v[132:135]
    s_waitcnt lgkmcnt(5)
    v_mfma_f32_16x16x32_bf16 v[128:131], v[244:247], v[84:87], v[128:131]
    v_mfma_f32_16x16x32_bf16 v[136:139], v[244:247], v[92:95], v[136:139]
    s_waitcnt lgkmcnt(4)
    v_mfma_f32_16x16x32_bf16 v[140:143], v[248:251], v[100:103], v[140:143]
    s_waitcnt lgkmcnt(3)
    v_mfma_f32_16x16x32_bf16 v[124:127], v[12:15], v[104:107], v[124:127]
    v_mfma_f32_16x16x32_bf16 v[128:131], v[12:15], v[108:111], v[128:131]
    v_mfma_f32_16x16x32_bf16 v[132:135], v[12:15], v[112:115], v[132:135]
    v_mfma_f32_16x16x32_bf16 v[136:139], v[12:15], v[116:119], v[136:139]
    s_waitcnt lgkmcnt(2)
    v_mfma_f32_16x16x32_bf16 v[124:127], v[16:19], v[108:111], v[124:127]
    v_mfma_f32_16x16x32_bf16 v[132:135], v[16:19], v[116:119], v[132:135]
    s_waitcnt lgkmcnt(1)
    v_mfma_f32_16x16x32_bf16 v[128:131], v[20:23], v[104:107], v[128:131]
    v_mfma_f32_16x16x32_bf16 v[136:139], v[20:23], v[112:115], v[136:139]
    s_waitcnt lgkmcnt(0)
    v_mfma_f32_16x16x32_bf16 v[140:143], v[24:27], v[120:123], v[140:143]
    s_nop 7
    v_cvt_pk_bf16_f32 v152, v140, v141
    v_cvt_pk_bf16_f32 v153, v142, v143
    v_cvt_pk_bf16_f32 v144, v124, v125
    v_cvt_pk_bf16_f32 v145, v126, v127
    v_cvt_pk_bf16_f32 v146, v128, v129
    v_cvt_pk_bf16_f32 v147, v130, v131
    v_cvt_pk_bf16_f32 v148, v132, v133
    v_cvt_pk_bf16_f32 v149, v134, v135
    v_cvt_pk_bf16_f32 v150, v136, v137
    v_cvt_pk_bf16_f32 v151, v138, v139
    v_xor_b32_dpp v154, v152, v162 row_ror:8 row_mask:0xf bank_mask:0xf
    v_xor_b32_dpp v155, v153, v162 row_ror:8 row_mask:0xf bank_mask:0xf
    s_lshl_b32 s98, s10, 2
    s_or_b32 s98, s98, s7
    s_cmp_eq_u32 s98, 7
    s_cbranch_scc1 SPEC_2
SPEC_2R:
    v_mfma_f32_16x16x32_bf16 v[124:127], v[158:161], v[144:147], 0
    v_mfma_f32_16x16x32_bf16 v[128:131], v[156:159], v[144:147], 0
    v_mfma_f32_16x16x32_bf16 v[132:135], v[158:161], v[148:151], 0
    v_mfma_f32_16x16x32_bf16 v[136:139], v[156:159], v[148:151], 0
    v_mfma_f32_16x16x32_bf16 v[140:143], v[158:161], v[152:155], 0
    s_nop 4
    v_cvt_pk_bf16_f32 v236, v124, v128
    v_cvt_pk_bf16_f32 v237, v125, v129
    v_cvt_pk_bf16_f32 v238, v126, v130
    v_cvt_pk_bf16_f32 v239, v127, v131
    ds_write_b128 v168, v[236:239] offset:28672
    v_cvt_pk_bf16_f32 v240, v132, v136
    v_cvt_pk_bf16_f32 v241, v133, v137
    v_cvt_pk_bf16_f32 v242, v134, v138
    v_cvt_pk_bf16_f32 v243, v135, v139
    ds_write_b128 v168, v[240:243] offset:29952
    v_mov_b32_dpp v244, v140 row_ror:8 row_mask:0xf bank_mask:0xf
    v_mov_b32_dpp v245, v141 row_ror:8 row_mask:0xf bank_mask:0xf
    v_mov_b32_dpp v246, v142 row_ror:8 row_mask:0xf bank_mask:0xf
    v_mov_b32_dpp v247, v143 row_ror:8 row_mask:0xf bank_mask:0xf
    v_cvt_pk_bf16_f32 v244, v140, v244
    v_cvt_pk_bf16_f32 v245, v141, v245
    v_cvt_pk_bf16_f32 v246, v142, v246
    v_cvt_pk_bf16_f32 v247, v143, v247
    s_mov_b32 exec_lo, 0x00ff00ff
    s_mov_b32 exec_hi, 0x00ff00ff
    ds_write_b128 v169, v[244:247] offset:28736
    s_mov_b64 exec, -1
    s_waitcnt lgkmcnt(0)
    s_barrier
    ds_read_b128 v[236:239], v252 offset:28672
    ds_read_b128 v[240:243], v252 offset:28688
    ds_read_b128 v[244:247], v252 offset:28704
    ds_read_b128 v[248:251], v252 offset:28720
    s_waitcnt lgkmcnt(2)
    v_swap_b32 v237, v240
    s_waitcnt lgkmcnt(1)
    v_swap_b32 v238, v244
    s_waitcnt lgkmcnt(0)
    v_swap_b32 v239, v248
    v_swap_b32 v242, v245
    v_swap_b32 v243, v249
    v_swap_b32 v247, v250
    buffer_store_dwordx4 v[236:239], v253, s[24:27], s99 offen sc1
    s_add_u32 s99, s99, 180224
    buffer_store_dwordx4 v[240:243], v253, s[24:27], s99 offen sc1
    s_add_u32 s99, s99, 180224
    buffer_store_dwordx4 v[244:247], v253, s[24:27], s99 offen sc1
    s_add_u32 s99, s99, 180224
    buffer_store_dwordx4 v[248:251], v253, s[24:27], s99 offen sc1
    s_waitcnt vmcnt(0)
    s_barrier
    v_mov_b32 v3, 59808
    ds_read_b96 v[252:254], v3 offset:16
    s_waitcnt lgkmcnt(0)
    v_readfirstlane_b32 s96, v252
    v_readfirstlane_b32 s97, v253
    v_readfirstlane_b32 s32, v254
    s_barrier
    v_lshrrev_b32 v3, 3, v0
    s_mov_b32 s34, 83200
    v_mul_u32_u24 v3, s34, v3
    v_and_b32 v4, 7, v0
    v_lshl_add_u32 v3, v4, 7, v3
    s_mul_i32 s33, s7, 665600
    s_lshl_b32 s34, s3, 11
    s_add_u32 s33, s33, s34
    s_lshl_b32 s34, s10, 10
    s_add_u32 s33, s33, s34
    s_mul_i32 s48, s4, 5
    s_lshr_b32 s20, s48, 4
    s_add_u32 s48, s48, 4
    s_lshr_b32 s21, s48, 4
    s_mul_i32 s20, s20, 4096
    s_mul_i32 s21, s21, 4096
    s_lshl_b32 s48, s3, 5
    s_lshr_b32 s49, s6, 2
    s_add_u32 s48, s48, s49
    s_mul_i32 s48, s48, 2048
    s_lshl_b32 s49, s7, 9
    s_add_u32 s48, s48, s49
    s_add_u32 s48, s48, 12845056
    s_add_u32 s20, s20, s48
    s_add_u32 s21, s21, s48
    s_lshl_b32 s48, s3, 5
    s_add_u32 s48, s48, s6
    s_lshl_b32 s12, s48, 9
    s_lshl_b32 s49, s4, 2
    s_add_u32 s12, s12, s49
    s_add_u32 s12, s12, 12583168
    s_sub_u32 s13, 8, s6
    s_cmp_eq_u32 s3, 0
    s_cselect_b32 s13, s13, 0
    s_movk_i32 s14, 16640
    v_lshlrev_b32 v12, 4, v0
    v_add_u32 v13, 158208, v12
    ds_read_b128 v[240:243], v13 offset:0
    ds_read_b128 v[244:247], v13 offset:1024
    ds_read_b128 v[248:251], v13 offset:2048
    ds_read_b96 v[252:254], v13 offset:3072
    v_cmp_gt_u32 vcc, 32, v0
    v_mov_b32 v14, 0x3f803f80
    s_mul_i32 s49, s4, 83200
    v_cndmask_b32 v230, 0, v14, vcc
    s_lshl_b32 s51, s3, 11
    v_lshrrev_b32 v231, 16, v230
    s_add_u32 s49, s49, s51
    v_mov_b32 v238, v230
    s_lshl_b32 s48, s6, 8
    v_mov_b32 v239, v231
    s_add_u32 s49, s49, s48
    v_mov_b32 v222, s20
    v_writelane_b32 v222, s21, 1
    s_waitcnt lgkmcnt(0)
    v_add_u32 v248, s48, v248
    v_add_u32 v249, s48, v249
    v_mad_u32_u24 v250, v253, s6, v250
    v_add_u32 v251, s49, v251
    v_add_u32 v252, s49, v252
    v_add_u32 v254, s49, v254
    v_mov_b32 v253, v12
    s_and_b32 s40, s4, 3
    s_lshl_b32 s43, s7, 10
    s_lshr_b32 s39, s4, 2
    s_mul_i32 s39, s39, 102400
    s_add_u32 s39, s39, s43
    s_add_u32 s39, s39, 11534336
    s_add_u32 s43, s43, 59904
C_PREP:
    s_mov_b32 s35, 7
RP_3:
    s_load_dword s36, s[22:23], s20
    s_load_dword s37, s[22:23], s21
    s_add_u32 s20, s20, 64
    s_add_u32 s21, s21, 64
    s_waitcnt lgkmcnt(0)
    s_xor_b32 s36, s36, s96
    s_xor_b32 s37, s37, s96
    s_or_b32 s36, s36, s37
    s_cbranch_scc0 RD_4
    s_sub_u32 s35, s35, 1
    s_cbranch_scc0 RP_3
    s_mov_b32 s50, 200000
SP_5:
    buffer_load_dword v223, v222, s[24:27], 0 offen sc1
    s_waitcnt vmcnt(0)
SC_6:
    v_cmp_ne_u32 vcc, s96, v223
    s_sub_u32 s50, s50, 1
    s_cbranch_scc1 SD_7
    s_cbranch_vccnz SP_5
SD_7:
RD_4:
    buffer_load_dwordx4 v[216:219], v251, s[24:27], 0 offen sc1
    buffer_load_dwordx2 v[220:221], v254, s[24:27], 0 offen sc1
    v_mov_b32 v222, 0
    v_mov_b32 v223, 0
    s_cmp_ge_u32 s4, 30
    s_cbranch_scc1 SPUBC
SPUBRC:
    s_waitcnt vmcnt(0)
    s_barrier
    s_setprio 2
    ds_read_b64 v[224:225], v248 offset:2048
    ds_read_b64 v[226:227], v248 offset:6144
    ds_read_b64 v[228:229], v249 offset:2048
    ds_read_b64 v[232:233], v248 offset:0
    ds_read_b64 v[234:235], v248 offset:4096
    ds_read_b64 v[236:237], v249 offset:0
    v_permlane16_swap_b32 v216, v218
    v_permlane16_swap_b32 v217, v219
    s_waitcnt lgkmcnt(4)
    s_nop 0
    v_mfma_f32_32x32x16_bf16 v[48:63], v[224:227], v[216:219], 0
    s_waitcnt lgkmcnt(3)
    v_mfma_f32_32x32x16_bf16 v[48:63], v[228:231], v[220:223], v[48:63]
    s_cmp_gt_u32 s13, 0
    s_cselect_b32 s51, 0xff00, 0
    v_mov_b32 v223, s51
    s_waitcnt lgkmcnt(1)
    v_mfma_f32_32x32x16_bf16 v[64:79], v[232:235], v[216:219], 0
    s_waitcnt lgkmcnt(0)
    v_mfma_f32_32x32x16_bf16 v[64:79], v[236:239], v[220:223], v[64:79]
    s_cmp_gt_u32 s13, 7
    s_cselect_b32 s51, 0xff00, 0
    v_mov_b32 v223, s51
    ds_read_b64 v[224:225], v248 offset:1792
    ds_read_b64 v[226:227], v248 offset:5888
    ds_read_b64 v[228:229], v249 offset:1792
    ds_read_b64 v[232:233], v248 offset:1536
    ds_read_b64 v[234:235], v248 offset:5632
    ds_read_b64 v[236:237], v249 offset:1536
    s_cmp_eq_u32 s3, 0
    s_nop 1
    v_cndmask_b32 v48, v64, v48, s[64:65]
    v_cndmask_b32 v49, v65, v49, s[66:67]
    v_cndmask_b32 v50, v66, v50, s[68:69]
    v_cndmask_b32 v51, v67, v51, s[70:71]
    v_cndmask_b32 v52, v68, v52, s[72:73]
    v_cndmask_b32 v53, v69, v53, s[74:75]
    v_cndmask_b32 v54, v70, v54, s[76:77]
    v_cndmask_b32 v55, v71, v55, s[78:79]
    v_cndmask_b32 v56, v72, v56, s[80:81]
    v_cndmask_b32 v57, v73, v57, s[82:83]
    v_cndmask_b32 v58, v74, v58, s[84:85]
    v_cndmask_b32 v59, v75, v59, s[86:87]
    v_cndmask_b32 v60, v76, v60, s[88:89]
    v_cndmask_b32 v61, v77, v61, s[90:91]
    v_cndmask_b32 v62, v78, v62, s[92:93]
    v_cndmask_b32 v63, v79, v63, s[94:95]
    v_max3_f32 v96, v48, v49, v50
    v_max3_f32 v97, v51, v52, v53
    v_max3_f32 v96, v96, v54, v55
    v_max3_f32 v97, v97, v56, v57
    v_max3_f32 v96, v96, v58, v59
    v_max3_f32 v97, v97, v60, v61
    v_max3_f32 v96, v96, v62, v63
    v_max_f32 v96, v96, v97
    s_cbranch_scc1 G0MAXC
G0RETC:
    v_mov_b32 v97, v96
    s_nop 1
    v_permlane32_swap_b32 v96, v97
    v_max_f32 v96, v96, v97
    v_sub_f32 v96, 0xc2000000, v96
    v_and_b32 v96, 0xffff0000, v96
    v_lshrrev_b32 v222, 16, v96
    s_waitcnt lgkmcnt(4)
    v_mfma_f32_32x32x16_bf16 v[64:79], v[224:227], v[216:219], 0
    v_pk_add_f32 v[48:49], v[48:49], v[96:97] op_sel_hi:[1,0]
    v_pk_add_f32 v[50:51], v[50:51], v[96:97] op_sel_hi:[1,0]
    v_pk_add_f32 v[52:53], v[52:53], v[96:97] op_sel_hi:[1,0]
    v_pk_add_f32 v[54:55], v[54:55], v[96:97] op_sel_hi:[1,0]
    v_pk_add_f32 v[56:57], v[56:57], v[96:97] op_sel_hi:[1,0]
    v_pk_add_f32 v[58:59], v[58:59], v[96:97] op_sel_hi:[1,0]
    v_pk_add_f32 v[60:61], v[60:61], v[96:97] op_sel_hi:[1,0]
    v_pk_add_f32 v[62:63], v[62:63], v[96:97] op_sel_hi:[1,0]
    s_waitcnt lgkmcnt(3)
    v_mfma_f32_32x32x16_bf16 v[64:79], v[228:231], v[220:223], v[64:79]
    ds_read_b64 v[224:225], v248 offset:1280
    ds_read_b64 v[226:227], v248 offset:5376
    ds_read_b64 v[228:229], v249 offset:1280
    v_exp_f32 v48, v48
    v_exp_f32 v49, v49
    v_exp_f32 v50, v50
    v_exp_f32 v51, v51
    v_exp_f32 v52, v52
    v_exp_f32 v53, v53
    v_exp_f32 v54, v54
    v_exp_f32 v55, v55
    v_exp_f32 v56, v56
    v_exp_f32 v57, v57
    v_exp_f32 v58, v58
    v_exp_f32 v59, v59
    v_exp_f32 v60, v60
    v_exp_f32 v61, v61
    v_exp_f32 v62, v62
    v_exp_f32 v63, v63
    v_cvt_pk_bf16_f32 v108, v48, v49
    v_cvt_pk_bf16_f32 v109, v50, v51
    v_cvt_pk_bf16_f32 v110, v52, v53
    v_cvt_pk_bf16_f32 v111, v54, v55
    v_cvt_pk_bf16_f32 v112, v56, v57
    v_cvt_pk_bf16_f32 v113, v58, v59
    v_cvt_pk_bf16_f32 v114, v60, v61
    v_cvt_pk_bf16_f32 v115, v62, v63
    v_and_b32 v100, v108, v240
    v_and_b32 v101, v109, v241
    v_and_b32 v102, v110, v242
    v_and_b32 v103, v111, v243
    v_and_b32 v104, v112, v244
    v_and_b32 v105, v113, v245
    v_and_b32 v106, v114, v246
    v_and_b32 v107, v115, v247
    v_xor_b32 v108, v108, v100
    v_xor_b32 v109, v109, v101
    v_xor_b32 v110, v110, v102
    v_xor_b32 v111, v111, v103
    v_xor_b32 v112, v112, v104
    v_xor_b32 v113, v113, v105
    v_xor_b32 v114, v114, v106
    v_xor_b32 v115, v115, v107
    s_setprio 3
    s_waitcnt lgkmcnt(4)
    v_mfma_f32_32x32x16_bf16 v[48:63], v[232:235], v[216:219], 0
    s_cmp_gt_u32 s13, 6
    s_cselect_b32 s51, 0xff00, 0
    v_mov_b32 v223, s51
    v_exp_f32 v64, v64
    v_exp_f32 v65, v65
    v_exp_f32 v66, v66
    v_exp_f32 v67, v67
    s_mul_i32 s42, s40, 20480
    s_add_u32 s41, s42, s39
    s_add_u32 s42, s42, s43
    s_mov_b32 m0, s42
    s_add_u32 s40, s40, 1
    s_cmp_eq_u32 s40, 5
    s_cselect_b32 s40, 0, s40
    v_exp_f32 v68, v68
    buffer_load_dwordx4 v253, s[24:27], s41 offen sc1 lds
    v_exp_f32 v69, v69
    v_exp_f32 v70, v70
    v_exp_f32 v71, v71
    v_exp_f32 v72, v72
    v_cvt_pk_bf16_f32 v116, v64, v65
    v_cvt_pk_bf16_f32 v117, v66, v67
    s_waitcnt lgkmcnt(3)
    v_mfma_f32_32x32x16_bf16 v[48:63], v[236:239], v[220:223], v[48:63]
    ds_read_b64 v[232:233], v248 offset:1024
    ds_read_b64 v[234:235], v248 offset:5120
    ds_read_b64 v[236:237], v249 offset:1024
    s_add_u32 m0, s42, 4096
    s_add_u32 s41, s41, 4096
    v_cvt_pk_bf16_f32 v118, v68, v69
    buffer_load_dwordx4 v253, s[24:27], s41 offen sc1 lds
    v_cvt_pk_bf16_f32 v119, v70, v71
    v_exp_f32 v73, v73
    v_exp_f32 v74, v74
    v_exp_f32 v75, v75
    v_exp_f32 v76, v76
    v_exp_f32 v77, v77
    v_exp_f32 v78, v78
    s_add_u32 m0, s42, 8192
    s_add_u32 s41, s41, 4096
    v_exp_f32 v79, v79
    buffer_load_dwordx4 v253, s[24:27], s41 offen sc1 lds
    v_cvt_pk_bf16_f32 v120, v72, v73
    v_cvt_pk_bf16_f32 v121, v74, v75
    v_cvt_pk_bf16_f32 v122, v76, v77
    v_cvt_pk_bf16_f32 v123, v78, v79
    s_waitcnt lgkmcnt(4)
    v_mfma_f32_32x32x16_bf16 v[64:79], v[224:227], v[216:219], 0
    s_cmp_gt_u32 s13, 5
    s_cselect_b32 s51, 0xff00, 0
    v_mov_b32 v223, s51
    v_exp_f32 v48, v48
    v_exp_f32 v49, v49
    v_exp_f32 v50, v50
    s_add_u32 m0, s42, 12288
    s_add_u32 s41, s41, 4096
    v_exp_f32 v51, v51
    buffer_load_dwordx4 v253, s[24:27], s41 offen sc1 lds
    v_exp_f32 v52, v52
    v_exp_f32 v53, v53
    v_exp_f32 v54, v54
    v_exp_f32 v55, v55
    s_add_u32 m0, s42, 16384
    s_add_u32 s41, s41, 4096
    v_exp_f32 v56, v56
    buffer_load_dwordx4 v253, s[24:27], s41 offen sc1 lds
    v_cvt_pk_bf16_f32 v124, v48, v49
    v_cvt_pk_bf16_f32 v125, v50, v51
    s_waitcnt lgkmcnt(3)
    v_mfma_f32_32x32x16_bf16 v[64:79], v[228:231], v[220:223], v[64:79]
    ds_read_b64 v[224:225], v248 offset:768
    ds_read_b64 v[226:227], v248 offset:4864
    ds_read_b64 v[228:229], v249 offset:768
    v_cvt_pk_bf16_f32 v126, v52, v53
    v_cvt_pk_bf16_f32 v127, v54, v55
    v_exp_f32 v57, v57
    v_exp_f32 v58, v58
    s_mul_i32 s42, s40, 20480
    s_add_u32 s41, s42, s39
    s_add_u32 s42, s42, s43
    s_mov_b32 m0, s42
    s_add_u32 s40, s40, 1
    s_cmp_eq_u32 s40, 5
    s_cselect_b32 s40, 0, s40
    v_exp_f32 v59, v59
    buffer_load_dwordx4 v253, s[24:27], s41 offen sc1 lds
    v_exp_f32 v60, v60
    v_exp_f32 v61, v61
    v_exp_f32 v62, v62
    v_exp_f32 v63, v63
    s_add_u32 m0, s42, 4096
    s_add_u32 s41, s41, 4096
    v_cvt_pk_bf16_f32 v128, v56, v57
    buffer_load_dwordx4 v253, s[24:27], s41 offen sc1 lds
    v_cvt_pk_bf16_f32 v129, v58, v59
    v_cvt_pk_bf16_f32 v130, v60, v61
    v_cvt_pk_bf16_f32 v131, v62, v63
    s_setprio 2
    s_barrier
    ds_read_b64_tr_b16 v[32:33], v250 offset:2048
    ds_read_b64_tr_b16 v[34:35], v250 offset:2080
    ds_read_b64_tr_b16 v[36:37], v250 offset:2176
    ds_read_b64_tr_b16 v[38:39], v250 offset:2208
    ds_read_b64_tr_b16 v[40:41], v250 offset:0
    ds_read_b64_tr_b16 v[42:43], v250 offset:32
    ds_read_b64_tr_b16 v[44:45], v250 offset:128
    ds_read_b64_tr_b16 v[46:47], v250 offset:160
    s_waitcnt lgkmcnt(12)
    v_mfma_f32_32x32x16_bf16 v[48:63], v[232:235], v[216:219], 0
    s_cmp_gt_u32 s13, 4
    s_cselect_b32 s51, 0xff00, 0
    v_mov_b32 v223, s51
    v_exp_f32 v64, v64
    v_exp_f32 v65, v65
    v_exp_f32 v66, v66
    s_add_u32 m0, s42, 8192
    s_add_u32 s41, s41, 4096
    v_exp_f32 v67, v67
    buffer_load_dwordx4 v253, s[24:27], s41 offen sc1 lds
    s_waitcnt lgkmcnt(11)
    v_mfma_f32_32x32x16_bf16 v[48:63], v[236:239], v[220:223], v[48:63]
    ds_read_b64 v[232:233], v248 offset:512
    ds_read_b64 v[234:235], v248 offset:4608
    ds_read_b64 v[236:237], v249 offset:512
    v_exp_f32 v68, v68
    v_exp_f32 v69, v69
    v_exp_f32 v70, v70
    s_waitcnt lgkmcnt(9)
    v_mfma_f32_32x32x16_bf16 v[80:95], v[32:35], v[100:103], 0
    ds_read_b64_tr_b16 v[32:33], v250 offset:1792
    ds_read_b64_tr_b16 v[34:35], v250 offset:1824
    v_exp_f32 v71, v71
    s_add_u32 m0, s42, 12288
    s_add_u32 s41, s41, 4096
    v_exp_f32 v72, v72
    buffer_load_dwordx4 v253, s[24:27], s41 offen sc1 lds
    v_cvt_pk_bf16_f32 v132, v64, v65
    v_cvt_pk_bf16_f32 v133, v66, v67
    s_waitcnt lgkmcnt(9)
    v_mfma_f32_32x32x16_bf16 v[80:95], v[36:39], v[104:107], v[80:95]
    ds_read_b64_tr_b16 v[36:37], v250 offset:1920
    ds_read_b64_tr_b16 v[38:39], v250 offset:1952
    v_cvt_pk_bf16_f32 v134, v68, v69
    v_cvt_pk_bf16_f32 v135, v70, v71
    v_exp_f32 v73, v73
    v_exp_f32 v74, v74
    s_add_u32 m0, s42, 16384
    s_add_u32 s41, s41, 4096
    v_exp_f32 v75, v75
    buffer_load_dwordx4 v253, s[24:27], s41 offen sc1 lds
    s_waitcnt lgkmcnt(9)
    v_mfma_f32_32x32x16_bf16 v[80:95], v[40:43], v[108:111], v[80:95]
    ds_read_b64_tr_b16 v[40:41], v250 offset:1536
    ds_read_b64_tr_b16 v[42:43], v250 offset:1568
    v_exp_f32 v76, v76
    v_exp_f32 v77, v77
    v_exp_f32 v78, v78
    s_waitcnt lgkmcnt(9)
    v_mfma_f32_32x32x16_bf16 v[80:95], v[44:47], v[112:115], v[80:95]
    ds_read_b64_tr_b16 v[44:45], v250 offset:1664
    ds_read_b64_tr_b16 v[46:47], v250 offset:1696
    v_exp_f32 v79, v79
    s_mul_i32 s42, s40, 20480
    s_add_u32 s41, s42, s39
    s_add_u32 s42, s42, s43
    s_mov_b32 m0, s42
    s_add_u32 s40, s40, 1
    s_cmp_eq_u32 s40, 5
    s_cselect_b32 s40, 0, s40
    v_cvt_pk_bf16_f32 v136, v72, v73
    buffer_load_dwordx4 v253, s[24:27], s41 offen sc1 lds
    v_cvt_pk_bf16_f32 v137, v74, v75
    v_cvt_pk_bf16_f32 v138, v76, v77
    v_cvt_pk_bf16_f32 v139, v78, v79
    v_mfma_f32_32x32x16_bf16 v[64:79], v[224:227], v[216:219], 0
    s_cmp_gt_u32 s13, 3
    s_cselect_b32 s51, 0xff00, 0
    v_mov_b32 v223, s51
    v_exp_f32 v48, v48
    v_exp_f32 v49, v49
    v_exp_f32 v50, v50
    s_add_u32 m0, s42, 4096
    s_add_u32 s41, s41, 4096
    v_exp_f32 v51, v51
    buffer_load_dwordx4 v253, s[24:27], s41 offen sc1 lds
    v_mfma_f32_32x32x16_bf16 v[64:79], v[228:231], v[220:223], v[64:79]
    ds_read_b64 v[224:225], v248 offset:256
    ds_read_b64 v[226:227], v248 offset:4352
    ds_read_b64 v[228:229], v249 offset:256
    v_exp_f32 v52, v52
    v_exp_f32 v53, v53
    v_exp_f32 v54, v54
    v_exp_f32 v55, v55
    s_waitcnt lgkmcnt(9)
    v_mfma_f32_32x32x16_bf16 v[80:95], v[32:35], v[116:119], v[80:95]
    ds_read_b64_tr_b16 v[32:33], v250 offset:1280
    ds_read_b64_tr_b16 v[34:35], v250 offset:1312
    s_add_u32 m0, s42, 8192
    s_add_u32 s41, s41, 4096
    v_exp_f32 v56, v56
    buffer_load_dwordx4 v253, s[24:27], s41 offen sc1 lds
    v_cvt_pk_bf16_f32 v140, v48, v49
    v_cvt_pk_bf16_f32 v141, v50, v51
    v_cvt_pk_bf16_f32 v142, v52, v53
    v_cvt_pk_bf16_f32 v143, v54, v55
    v_exp_f32 v57, v57
    s_waitcnt lgkmcnt(9)
    v_mfma_f32_32x32x16_bf16 v[80:95], v[36:39], v[120:123], v[80:95]
    ds_read_b64_tr_b16 v[36:37], v250 offset:1408
    ds_read_b64_tr_b16 v[38:39], v250 offset:1440
    v_exp_f32 v58, v58
    s_add_u32 m0, s42, 12288
    s_add_u32 s41, s41, 4096
    v_exp_f32 v59, v59
    buffer_load_dwordx4 v253, s[24:27], s41 offen sc1 lds
    v_exp_f32 v60, v60
    v_exp_f32 v61, v61
    s_waitcnt lgkmcnt(9)
    v_mfma_f32_32x32x16_bf16 v[80:95], v[40:43], v[124:127], v[80:95]
    ds_read_b64_tr_b16 v[40:41], v250 offset:1024
    ds_read_b64_tr_b16 v[42:43], v250 offset:1056
    v_exp_f32 v62, v62
    v_exp_f32 v63, v63
    s_add_u32 m0, s42, 16384
    s_add_u32 s41, s41, 4096
    v_cvt_pk_bf16_f32 v144, v56, v57
    buffer_load_dwordx4 v253, s[24:27], s41 offen sc1 lds
    v_cvt_pk_bf16_f32 v145, v58, v59
    v_cvt_pk_bf16_f32 v146, v60, v61
    v_cvt_pk_bf16_f32 v147, v62, v63
    v_mfma_f32_32x32x16_bf16 v[48:63], v[232:235], v[216:219], 0
    s_cmp_gt_u32 s13, 2
    s_cselect_b32 s51, 0xff00, 0
    v_mov_b32 v223, s51
    v_exp_f32 v64, v64
    v_exp_f32 v65, v65
    v_exp_f32 v66, v66
    s_mul_i32 s42, s40, 20480
    s_add_u32 s41, s42, s39
    s_add_u32 s42, s42, s43
    s_mov_b32 m0, s42
    s_add_u32 s40, s40, 1
    s_cmp_eq_u32 s40, 5
    s_cselect_b32 s40, 0, s40
    v_exp_f32 v67, v67
    buffer_load_dwordx4 v253, s[24:27], s41 offen sc1 lds
    v_mfma_f32_32x32x16_bf16 v[48:63], v[236:239], v[220:223], v[48:63]
    v_exp_f32 v68, v68
    v_exp_f32 v69, v69
    v_exp_f32 v70, v70
    s_waitcnt lgkmcnt(9)
    v_mfma_f32_32x32x16_bf16 v[80:95], v[44:47], v[128:131], v[80:95]
    ds_read_b64_tr_b16 v[44:45], v250 offset:1152
    ds_read_b64_tr_b16 v[46:47], v250 offset:1184
    v_exp_f32 v71, v71
    s_add_u32 m0, s42, 4096
    s_add_u32 s41, s41, 4096
    v_exp_f32 v72, v72
    buffer_load_dwordx4 v253, s[24:27], s41 offen sc1 lds
    v_cvt_pk_bf16_f32 v148, v64, v65
    v_cvt_pk_bf16_f32 v149, v66, v67
    s_waitcnt lgkmcnt(6)
    v_mfma_f32_32x32x16_bf16 v[80:95], v[32:35], v[132:135], v[80:95]
    ds_read_b64_tr_b16 v[32:33], v250 offset:768
    ds_read_b64_tr_b16 v[34:35], v250 offset:800
    v_cvt_pk_bf16_f32 v150, v68, v69
    v_cvt_pk_bf16_f32 v151, v70, v71
    v_exp_f32 v73, v73
    v_exp_f32 v74, v74
    s_add_u32 m0, s42, 8192
    s_add_u32 s41, s41, 4096
    v_exp_f32 v75, v75
    buffer_load_dwordx4 v253, s[24:27], s41 offen sc1 lds
    s_waitcnt lgkmcnt(6)
    v_mfma_f32_32x32x16_bf16 v[80:95], v[36:39], v[136:139], v[80:95]
    ds_read_b64_tr_b16 v[36:37], v250 offset:896
    ds_read_b64_tr_b16 v[38:39], v250 offset:928
    v_exp_f32 v76, v76
    v_exp_f32 v77, v77
    v_exp_f32 v78, v78
    s_waitcnt lgkmcnt(6)
    v_mfma_f32_32x32x16_bf16 v[80:95], v[40:43], v[140:143], v[80:95]
    ds_read_b64_tr_b16 v[40:41], v250 offset:512
    ds_read_b64_tr_b16 v[42:43], v250 offset:544
    v_exp_f32 v79, v79
    s_add_u32 m0, s42, 12288
    s_add_u32 s41, s41, 4096
    v_cvt_pk_bf16_f32 v152, v72, v73
    buffer_load_dwordx4 v253, s[24:27], s41 offen sc1 lds
    v_cvt_pk_bf16_f32 v153, v74, v75
    v_cvt_pk_bf16_f32 v154, v76, v77
    v_cvt_pk_bf16_f32 v155, v78, v79
    s_setprio 1
    v_mfma_f32_32x32x16_bf16 v[64:79], v[224:227], v[216:219], 0
    s_cmp_gt_u32 s13, 1
    s_cselect_b32 s51, 0xff00, 0
    v_mov_b32 v223, s51
    v_exp_f32 v48, v48
    v_exp_f32 v49, v49
    v_exp_f32 v50, v50
    s_add_u32 m0, s42, 16384
    s_add_u32 s41, s41, 4096
    v_exp_f32 v51, v51
    buffer_load_dwordx4 v253, s[24:27], s41 offen sc1 lds
    v_mfma_f32_32x32x16_bf16 v[64:79], v[228:231], v[220:223], v[64:79]
    v_exp_f32 v52, v52
    v_exp_f32 v53, v53
    v_exp_f32 v54, v54
    v_exp_f32 v55, v55
    s_waitcnt lgkmcnt(6)
    v_mfma_f32_32x32x16_bf16 v[80:95], v[44:47], v[144:147], v[80:95]
    ds_read_b64_tr_b16 v[44:45], v250 offset:640
    ds_read_b64_tr_b16 v[46:47], v250 offset:672
    s_mul_i32 s42, s40, 20480
    s_add_u32 s41, s42, s39
    s_add_u32 s42, s42, s43
    s_mov_b32 m0, s42
    s_add_u32 s40, s40, 1
    s_cmp_eq_u32 s40, 5
    s_cselect_b32 s40, 0, s40
    v_exp_f32 v56, v56
    buffer_load_dwordx4 v253, s[24:27], s41 offen sc1 lds
    v_cvt_pk_bf16_f32 v156, v48, v49
    v_cvt_pk_bf16_f32 v157, v50, v51
    v_cvt_pk_bf16_f32 v158, v52, v53
    v_cvt_pk_bf16_f32 v159, v54, v55
    v_exp_f32 v57, v57
    s_waitcnt lgkmcnt(6)
    v_mfma_f32_32x32x16_bf16 v[80:95], v[32:35], v[148:151], v[80:95]
    ds_read_b64_tr_b16 v[32:33], v250 offset:256
    ds_read_b64_tr_b16 v[34:35], v250 offset:288
    v_exp_f32 v58, v58
    s_add_u32 m0, s42, 4096
    s_add_u32 s41, s41, 4096
    v_exp_f32 v59, v59
    buffer_load_dwordx4 v253, s[24:27], s41 offen sc1 lds
    v_exp_f32 v60, v60
    v_exp_f32 v61, v61
    s_waitcnt lgkmcnt(6)
    v_mfma_f32_32x32x16_bf16 v[80:95], v[36:39], v[152:155], v[80:95]
    ds_read_b64_tr_b16 v[36:37], v250 offset:384
    ds_read_b64_tr_b16 v[38:39], v250 offset:416
    v_exp_f32 v62, v62
    v_exp_f32 v63, v63
    s_add_u32 m0, s42, 8192
    s_add_u32 s41, s41, 4096
    v_cvt_pk_bf16_f32 v160, v56, v57
    buffer_load_dwordx4 v253, s[24:27], s41 offen sc1 lds
    v_cvt_pk_bf16_f32 v161, v58, v59
    v_cvt_pk_bf16_f32 v162, v60, v61
    v_cvt_pk_bf16_f32 v163, v62, v63
    s_waitcnt lgkmcnt(6)
    v_mfma_f32_32x32x16_bf16 v[80:95], v[40:43], v[156:159], v[80:95]
    v_exp_f32 v64, v64
    v_exp_f32 v65, v65
    v_exp_f32 v66, v66
    v_exp_f32 v67, v67
    v_exp_f32 v68, v68
    s_add_u32 m0, s42, 12288
    s_add_u32 s41, s41, 4096
    v_exp_f32 v69, v69
    buffer_load_dwordx4 v253, s[24:27], s41 offen sc1 lds
    v_exp_f32 v70, v70
    s_waitcnt lgkmcnt(4)
    v_mfma_f32_32x32x16_bf16 v[80:95], v[44:47], v[160:163], v[80:95]
    v_exp_f32 v71, v71
    v_exp_f32 v72, v72
    v_cvt_pk_bf16_f32 v164, v64, v65
    v_cvt_pk_bf16_f32 v165, v66, v67
    v_cvt_pk_bf16_f32 v166, v68, v69
    v_cvt_pk_bf16_f32 v167, v70, v71
    v_exp_f32 v73, v73
    v_exp_f32 v74, v74
    v_exp_f32 v75, v75
    s_waitcnt lgkmcnt(2)
    v_mfma_f32_32x32x16_bf16 v[80:95], v[32:35], v[164:167], v[80:95]
    v_exp_f32 v76, v76
    s_add_u32 m0, s42, 16384
    s_add_u32 s41, s41, 4096
    v_exp_f32 v77, v77
    buffer_load_dwordx4 v253, s[24:27], s41 offen sc1 lds
    v_exp_f32 v78, v78
    v_exp_f32 v79, v79
    v_cvt_pk_bf16_f32 v168, v72, v73
    v_cvt_pk_bf16_f32 v169, v74, v75
    v_cvt_pk_bf16_f32 v170, v76, v77
    v_cvt_pk_bf16_f32 v171, v78, v79
    s_waitcnt lgkmcnt(0)
    s_nop 0
    v_mfma_f32_32x32x16_bf16 v[80:95], v[36:39], v[168:171], v[80:95]
    v_mov_b32 v14, s96
    v_mov_b32 v15, 0
    s_mov_b32 s48, 0x7b800000
    s_cmp_eq_u32 s32, 0
    s_nop 7
    v_rcp_f32 v96, v92
    s_nop 0
    v_pk_mul_f32 v[80:81], v[80:81], v[96:97] op_sel_hi:[1,0]
    v_pk_mul_f32 v[82:83], v[82:83], v[96:97] op_sel_hi:[1,0]
    v_pk_mul_f32 v[84:85], v[84:85], v[96:97] op_sel_hi:[1,0]
    v_pk_mul_f32 v[86:87], v[86:87], v[96:97] op_sel_hi:[1,0]
    v_pk_mul_f32 v[88:89], v[88:89], v[96:97] op_sel_hi:[1,0]
    v_pk_mul_f32 v[90:91], v[90:91], v[96:97] op_sel_hi:[1,0]
    v_cvt_pk_bf16_f32 v100, v80, v81
    v_cvt_pk_bf16_f32 v101, v82, v83
    v_cvt_pk_bf16_f32 v102, v84, v85
    v_cvt_pk_bf16_f32 v103, v86, v87
    v_cvt_pk_bf16_f32 v104, v88, v89
    v_cvt_pk_bf16_f32 v105, v90, v91
    s_cbranch_scc1 O_SC1C
    buffer_store_dwordx4 v[100:103], v251, s[24:27], 0 offen nt
    buffer_store_dwordx2 v[104:105], v252, s[24:27], 0 offen nt
    v_maximum3_f32 v98, |v80|, |v81|, |v82|
    v_maximum3_f32 v98, v98, |v83|, |v84|
    v_maximum3_f32 v98, v98, |v85|, |v86|
    v_maximum3_f32 v98, v98, |v87|, |v88|
    v_maximum3_f32 v98, v98, |v89|, |v90|
    v_maximum3_f32 v98, v98, |v91|, |v92|
    v_mul_f32 v99, 0x53800000, v96
    v_maximum3_f32 v98, v98, v99, v99
    v_cmp_ngt_f32 vcc, s48, v98
    s_nop 0
    s_cbranch_vccnz REDO
    s_waitcnt vmcnt(0)
    s_mov_b64 exec, 1
    buffer_store_dword v14, v15, s[24:27], s12 offen
O_DONEC:
C_END:
    v_mov_b32 v15, 59808
    v_mov_b32 v14, 1
    ds_add_u32 v15, v14
    s_endpgm
L_ROLE2:
    s_and_b32 s34, s3, 1
    s_mul_i32 s34, s34, 5
    s_add_u32 s34, s34, s11
    s_cmp_lt_u32 s11, 5
    s_cselect_b32 s45, 10, 15
    s_cmp_lt_u32 s11, 10
    s_cselect_b32 s45, s45, 0
    s_cselect_b32 s33, 0, 1
    s_add_u32 s45, s45, s34
    s_xor_b32 s33, s33, s3
    s_add_u32 s46, s34, 10
    s_cmp_lt_u32 s11, 10
    s_cselect_b32 s46, s11, s46
    s_setprio 2
    v_lshrrev_b32 v1, 3, v0
    v_and_b32 v2, 7, v0
    v_lshrrev_b32 v3, 1, v1
    v_xor_b32 v3, v2, v3
    v_lshlrev_b32 v3, 4, v3
    s_lshl_b32 s33, s33, 8
    s_lshl_b32 s34, s10, 7
    s_add_u32 s33, s33, s34
    s_lshl_b32 s34, s7, 5
    s_add_u32 s33, s33, s34
    v_lshl_add_u32 v4, v1, 1, s33
    s_lshl_b32 s55, s33, 3
    s_movk_i32 s34, 1280
    v_mad_u32_u24 v4, v4, s34, v3
    v_xor_b32 v5, 64, v4
    v_add_u32 v5, 16*1280, v5
    v_add_u32 v6, 1280, v4
    v_add_u32 v7, 1280, v5
    v_and_b32 v8, 2, v1
    v_xor_b32 v8, v2, v8
    v_lshlrev_b32 v8, 4, v8
    s_lshl_b32 s35, s7, 4
    v_add_u32 v9, s35, v1
    s_movk_i32 s35, 3840
    v_mad_u32_u24 v8, v9, s35, v8
    v_xor_b32 v9, 64, v8
    v_add_u32 v9, 8*3840, v9
    s_mul_i32 s35, s11, 2
    s_sub_u32 s35, s35, 15
    s_cmp_lt_u32 s11, 10
    s_cselect_b32 s35, s11, s35
    s_mul_i32 s44, s3, 5
    s_lshr_b32 s44, s44, 2
    s_add_u32 s44, s44, s35
    s_mul_i32 s35, s10, 2
    s_add_u32 s44, s44, s35
    s_sub_u32 s35, s44, 10
    s_cselect_b32 s44, s44, s35
    s_sub_u32 s35, s44, 10
    s_cselect_b32 s44, s44, s35
    s_lshl_b32 s45, s45, 7
    s_lshl_b32 s46, s46, 7
    s_mov_b32 s59, s44
    s_lshl_b32 s47, s7, 12
    s_lshl_b32 s33, s7, 11
    s_mov_b32 s38, 2621440
    s_mov_b32 s39, 0x00020000
    s_mov_b32 s42, 2457600
    s_mov_b32 s43, 0x00020000
    s_waitcnt lgkmcnt(0)
    s_mov_b64 s[36:37], s[12:13]
    s_mov_b64 s[40:41], s[14:15]
    s_cmp_ge_u32 s4, 30
    s_cbranch_scc1 L_SPARE
    s_lshl_b32 s34, s44, 7
    s_mul_i32 s35, s44, 245760
    s_add_u32 m0, s33, 125440
    s_add_u32 s35, s35, s45
    buffer_load_dwordx4 v8, s[40:43], s35 offen lds
    s_add_u32 m0, s33, 126464
    s_add_u32 s44, s44, 1
    s_cmp_eq_u32 s44, 10
    s_cselect_b32 s44, 0, s44
    buffer_load_dwordx4 v9, s[40:43], s35 offen lds
    s_add_u32 m0, s47, 59904
    s_nop 0
    buffer_load_dwordx4 v4, s[36:39], s34 offen lds
    s_add_u32 m0, s47, 60928
    s_nop 0
    buffer_load_dwordx4 v5, s[36:39], s34 offen lds
    s_add_u32 m0, s47, 61952
    s_nop 0
    buffer_load_dwordx4 v6, s[36:39], s34 offen lds
    s_add_u32 m0, s47, 62976
    s_nop 0
    buffer_load_dwordx4 v7, s[36:39], s34 offen lds
    s_mov_b32 s24, s22
    s_mov_b32 s25, s23
    s_mov_b32 s26, 268435456
    s_mov_b32 s27, 0x00020000
    s_mov_b32 s28, s18
    s_mov_b32 s29, s19
    s_mov_b32 s30, 5242880
    s_mov_b32 s31, 0x00020000
    s_mov_b32 s18, 819200
    s_mov_b32 s19, 0x00020000
    v_mov_b32 v172, 0x3e9e377a
    v_mov_b32 v173, v172
    v_mov_b32 v174, 0xbf4f1bbd
    v_mov_b32 v175, v174
    v_mov_b32 v176, 0x3f737871
    v_mov_b32 v177, v176
    v_mov_b32 v178, 0x3f167918
    v_mov_b32 v179, v178
    v_mov_b32 v180, 0xbf737871
    v_mov_b32 v181, v180
    s_mov_b32 s62, 0xffff0000
    s_mov_b32 s63, 0x80008000
    s_lshl_b32 s50, s7, 2
    v_add_u32 v184, s50, v12
    v_and_b32 v185, 7, v11
    v_xor_b32 v184, v184, v185
    v_lshl_add_u32 v184, v11, 4, v184
    v_lshlrev_b32 v184, 4, v184
    s_setprio 0
    s_setprio 2
    s_waitcnt vmcnt(6)
    s_lshl_b32 s34, s44, 7
    s_mul_i32 s35, s44, 245760
    s_add_u32 m0, s33, 133632
    s_add_u32 s35, s35, s45
    buffer_load_dwordx4 v8, s[40:43], s35 offen lds
    v_lshlrev_b32 v116, 16, v96
    v_and_b32 v117, s62, v96
    v_lshlrev_b32 v118, 16, v100
    v_and_b32 v119, s62, v100
    v_lshlrev_b32 v120, 16, v104
    v_and_b32 v121, s62, v104
    v_lshlrev_b32 v122, 16, v108
    v_and_b32 v123, s62, v108
    v_lshlrev_b32 v124, 16, v112
    v_and_b32 v125, s62, v112
    v_pk_add_f32 v[126:127], v[118:119], v[124:125] neg_lo:[0,1] neg_hi:[0,1]
    v_pk_add_f32 v[118:119], v[118:119], v[124:125]
    v_pk_add_f32 v[124:125], v[120:121], v[122:123] neg_lo:[0,1] neg_hi:[0,1]
    v_pk_add_f32 v[120:121], v[120:121], v[122:123]
    v_pk_add_f32 v[128:129], v[116:117], v[118:119]
    v_pk_fma_f32 v[130:131], v[118:119], v[172:173], v[116:117]
    v_pk_fma_f32 v[132:133], v[118:119], v[174:175], v[116:117]
    v_pk_mul_f32 v[134:135], v[126:127], v[176:177]
    v_pk_mul_f32 v[136:137], v[126:127], v[178:179]
    v_pk_add_f32 v[128:129], v[128:129], v[120:121]
    v_pk_fma_f32 v[130:131], v[120:121], v[174:175], v[130:131]
    v_pk_fma_f32 v[132:133], v[120:121], v[172:173], v[132:133]
    v_pk_fma_f32 v[134:135], v[124:125], v[178:179], v[134:135]
    v_pk_fma_f32 v[136:137], v[124:125], v[180:181], v[136:137]
    v_cvt_pk_bf16_f32 v144, v128, v129
    s_add_u32 m0, s33, 134656
    s_add_u32 s44, s44, 1
    s_cmp_eq_u32 s44, 10
    s_cselect_b32 s44, 0, s44
    buffer_load_dwordx4 v9, s[40:43], s35 offen lds
    v_cvt_pk_bf16_f32 v148, v130, v131
    v_cvt_pk_bf16_f32 v152, v132, v133
    v_cvt_pk_bf16_f32 v156, v134, v135
    v_cvt_pk_bf16_f32 v160, v136, v137
    v_xor_b32 v164, s63, v160
    v_xor_b32 v168, s63, v156
    v_lshlrev_b32 v116, 16, v97
    v_and_b32 v117, s62, v97
    v_lshlrev_b32 v118, 16, v101
    v_and_b32 v119, s62, v101
    v_lshlrev_b32 v120, 16, v105
    v_and_b32 v121, s62, v105
    v_lshlrev_b32 v122, 16, v109
    v_and_b32 v123, s62, v109
    v_lshlrev_b32 v124, 16, v113
    v_and_b32 v125, s62, v113
    v_pk_add_f32 v[126:127], v[118:119], v[124:125] neg_lo:[0,1] neg_hi:[0,1]
    v_pk_add_f32 v[118:119], v[118:119], v[124:125]
    v_pk_add_f32 v[124:125], v[120:121], v[122:123] neg_lo:[0,1] neg_hi:[0,1]
    v_pk_add_f32 v[120:121], v[120:121], v[122:123]
    v_pk_add_f32 v[128:129], v[116:117], v[118:119]
    v_pk_fma_f32 v[130:131], v[118:119], v[172:173], v[116:117]
    v_pk_fma_f32 v[132:133], v[118:119], v[174:175], v[116:117]
    v_pk_mul_f32 v[134:135], v[126:127], v[176:177]
    v_pk_mul_f32 v[136:137], v[126:127], v[178:179]
    v_pk_add_f32 v[128:129], v[128:129], v[120:121]
    v_pk_fma_f32 v[130:131], v[120:121], v[174:175], v[130:131]
    v_pk_fma_f32 v[132:133], v[120:121], v[172:173], v[132:133]
    v_pk_fma_f32 v[134:135], v[124:125], v[178:179], v[134:135]
    v_pk_fma_f32 v[136:137], v[124:125], v[180:181], v[136:137]
    v_cvt_pk_bf16_f32 v145, v128, v129
    v_cvt_pk_bf16_f32 v149, v130, v131
    v_cvt_pk_bf16_f32 v153, v132, v133
    v_cvt_pk_bf16_f32 v157, v134, v135
    v_cvt_pk_bf16_f32 v161, v136, v137
    v_xor_b32 v165, s63, v161
    v_xor_b32 v169, s63, v157
    v_lshlrev_b32 v116, 16, v98
    v_and_b32 v117, s62, v98
    v_lshlrev_b32 v118, 16, v102
    v_and_b32 v119, s62, v102
    v_lshlrev_b32 v120, 16, v106
    v_and_b32 v121, s62, v106
    v_lshlrev_b32 v122, 16, v110
    v_and_b32 v123, s62, v110
    v_lshlrev_b32 v124, 16, v114
    v_and_b32 v125, s62, v114
    v_pk_add_f32 v[126:127], v[118:119], v[124:125] neg_lo:[0,1] neg_hi:[0,1]
    v_pk_add_f32 v[118:119], v[118:119], v[124:125]
    v_pk_add_f32 v[124:125], v[120:121], v[122:123] neg_lo:[0,1] neg_hi:[0,1]
    v_pk_add_f32 v[120:121], v[120:121], v[122:123]
    v_pk_add_f32 v[128:129], v[116:117], v[118:119]
    v_pk_fma_f32 v[130:131], v[118:119], v[172:173], v[116:117]
    v_pk_fma_f32 v[132:133], v[118:119], v[174:175], v[116:117]
    v_pk_mul_f32 v[134:135], v[126:127], v[176:177]
    v_pk_mul_f32 v[136:137], v[126:127], v[178:179]
    v_pk_add_f32 v[128:129], v[128:129], v[120:121]
    v_pk_fma_f32 v[130:131], v[120:121], v[174:175], v[130:131]
    v_pk_fma_f32 v[132:133], v[120:121], v[172:173], v[132:133]
    v_pk_fma_f32 v[134:135], v[124:125], v[178:179], v[134:135]
    v_pk_fma_f32 v[136:137], v[124:125], v[180:181], v[136:137]
    v_cvt_pk_bf16_f32 v146, v128, v129
    v_cvt_pk_bf16_f32 v150, v130, v131
    v_cvt_pk_bf16_f32 v154, v132, v133
    v_cvt_pk_bf16_f32 v158, v134, v135
    v_cvt_pk_bf16_f32 v162, v136, v137
    v_xor_b32 v166, s63, v162
    v_xor_b32 v170, s63, v158
    v_lshlrev_b32 v116, 16, v99
    v_and_b32 v117, s62, v99
    v_lshlrev_b32 v118, 16, v103
    v_and_b32 v119, s62, v103
    v_lshlrev_b32 v120, 16, v107
    v_and_b32 v121, s62, v107
    v_lshlrev_b32 v122, 16, v111
    v_and_b32 v123, s62, v111
    v_lshlrev_b32 v124, 16, v115
    v_and_b32 v125, s62, v115
    v_pk_add_f32 v[126:127], v[118:119], v[124:125] neg_lo:[0,1] neg_hi:[0,1]
    v_pk_add_f32 v[118:119], v[118:119], v[124:125]
    v_pk_add_f32 v[124:125], v[120:121], v[122:123] neg_lo:[0,1] neg_hi:[0,1]
    v_pk_add_f32 v[120:121], v[120:121], v[122:123]
    v_pk_add_f32 v[128:129], v[116:117], v[118:119]
    v_pk_fma_f32 v[130:131], v[118:119], v[172:173], v[116:117]
    v_pk_fma_f32 v[132:133], v[118:119], v[174:175], v[116:117]
    v_pk_mul_f32 v[134:135], v[126:127], v[176:177]
    v_pk_mul_f32 v[136:137], v[126:127], v[178:179]
    v_pk_add_f32 v[128:129], v[128:129], v[120:121]
    v_pk_fma_f32 v[130:131], v[120:121], v[174:175], v[130:131]
    v_pk_fma_f32 v[132:133], v[120:121], v[172:173], v[132:133]
    v_pk_fma_f32 v[134:135], v[124:125], v[178:179], v[134:135]
    v_pk_fma_f32 v[136:137], v[124:125], v[180:181], v[136:137]
    v_cvt_pk_bf16_f32 v147, v128, v129
    v_cvt_pk_bf16_f32 v151, v130, v131
    v_cvt_pk_bf16_f32 v155, v132, v133
    v_cvt_pk_bf16_f32 v159, v134, v135
    v_cvt_pk_bf16_f32 v163, v136, v137
    v_xor_b32 v167, s63, v163
    v_xor_b32 v171, s63, v159
    ds_write_b128 v184, v[144:147] offset:0
    ds_write_b128 v184, v[148:151] offset:4096
    ds_write_b128 v184, v[152:155] offset:8192
    ds_write_b128 v184, v[156:159] offset:12288
    ds_write_b128 v184, v[160:163] offset:16384
    ds_write_b128 v184, v[164:167] offset:20480
    ds_write_b128 v184, v[168:171] offset:24576
    s_waitcnt lgkmcnt(0)
    s_barrier
    s_add_u32 m0, s47, 76288
    s_nop 0
    buffer_load_dwordx4 v4, s[36:39], s34 offen lds
    s_add_u32 m0, s47, 77312
    s_nop 0
    buffer_load_dwordx4 v5, s[36:39], s34 offen lds
    s_add_u32 m0, s47, 78336
    s_nop 0
    buffer_load_dwordx4 v6, s[36:39], s34 offen lds
    s_add_u32 m0, s47, 79360
    s_nop 0
    buffer_load_dwordx4 v7, s[36:39], s34 offen lds
    s_lshl_b32 s62, s7, 10
    v_lshl_add_u32 v207, v0, 4, s62
    s_add_u32 m0, s62, 158208
    s_nop 0
    global_load_lds_dwordx4 v207, s[0:1]
    s_setprio 0
    s_lshl_b32 s34, s44, 7
    s_mul_i32 s35, s44, 245760
    s_add_u32 m0, s33, 141824
    s_add_u32 s35, s35, s45
    buffer_load_dwordx4 v8, s[40:43], s35 offen lds
    s_add_u32 m0, s33, 142848
    s_add_u32 s44, s44, 1
    s_cmp_eq_u32 s44, 10
    s_cselect_b32 s44, 0, s44
    buffer_load_dwordx4 v9, s[40:43], s35 offen lds
    s_add_u32 m0, s47, 92672
    s_nop 0
    buffer_load_dwordx4 v4, s[36:39], s34 offen lds
    s_add_u32 m0, s47, 93696
    s_nop 0
    buffer_load_dwordx4 v5, s[36:39], s34 offen lds
    s_add_u32 m0, s47, 94720
    s_nop 0
    buffer_load_dwordx4 v6, s[36:39], s34 offen lds
    s_add_u32 m0, s47, 95744
    s_nop 0
    buffer_load_dwordx4 v7, s[36:39], s34 offen lds
    s_lshl_b32 s34, s44, 7
    s_mul_i32 s35, s44, 245760
    s_add_u32 m0, s33, 150016
    s_add_u32 s35, s35, s45
    buffer_load_dwordx4 v8, s[40:43], s35 offen lds
    s_mul_i32 s62, s7, 20
    v_add_u32 v214, s62, v0
    v_lshrrev_b32 v215, 4, v214
    s_movk_i32 s62, 14592
    v_mul_u32_u24 v215, s62, v215
    v_lshl_add_u32 v214, v214, 7, v215
    s_mul_i32 s62, s4, 83200
    s_lshl_b32 s63, s3, 11
    s_add_u32 s62, s62, s63
    v_add_u32 v214, s62, v214
    s_lshl_b32 s62, s5, 2
    s_add_u32 s62, s62, s7
    s_lshl_b32 s62, s62, 7
    s_add_u32 s62, s62, 12582912
    v_writelane_b32 v214, s62, 20
    s_lshl_b32 s62, s62, 2
    s_add_u32 s62, s62, 4257480704
    v_writelane_b32 v214, s62, 21
    s_add_u32 s62, s62, 128
    v_writelane_b32 v214, s62, 22
    s_add_u32 s62, s62, 128
    v_writelane_b32 v214, s62, 23
    s_add_u32 s62, s62, 128
    v_writelane_b32 v214, s62, 24
    s_mov_b64 exec, 0x1ffffff
    buffer_load_dword v215, v214, s[24:27], 0 offen
    s_mov_b64 exec, -1
    v_mov_b32 v20, 0x3f80
    v_mov_b32 v21, 0
    v_mov_b32 v22, v20
    v_mov_b32 v23, v21
    s_mul_i32 s48, s7, 576
    v_lshl_add_u32 v16, v0, 4, s48
    s_mov_b32 exec_hi, 0xf
    ds_write_b128 v16, v[20:23] offset:41120
    s_mov_b64 exec, -1
    v_mov_b32 v24, 0
    v_mov_b32 v25, 0
    s_load_dwordx16 s[64:79], s[0:1], 20480
    s_load_dwordx16 s[80:95], s[0:1], 20544
    s_mov_b32 s97, 12588800
    s_load_dword s96, s[22:23], s97
    s_setprio 2
    s_waitcnt vmcnt(15)
    s_barrier
    s_add_u32 m0, s33, 151040
    s_add_u32 s44, s44, 1
    s_cmp_eq_u32 s44, 10
    s_cselect_b32 s44, 0, s44
    buffer_load_dwordx4 v9, s[40:43], s35 offen lds
    v_mov_b32 v17, 59808
    ds_write_b64 v17, v[24:25]
    v_lshlrev_b32 v17, 3, v0
    v_add_u32 v17, 162816, v17
    ds_write_b64 v17, v[24:25]
    s_sub_u32 s48, s3, 1
    s_cselect_b32 s48, 0, s48
    s_add_u32 m0, s47, 109056
    s_nop 0
    buffer_load_dwordx4 v4, s[36:39], s34 offen lds
    s_cmp_lt_u32 s7, 2
    s_cselect_b32 s48, s48, s3
    s_and_b32 s49, s7, 1
    s_lshl_b32 s60, s48, 11
    s_lshl_b32 s51, s49, 10
    s_add_u32 s60, s60, s51
    s_add_u32 m0, s47, 110080
    s_nop 0
    buffer_load_dwordx4 v5, s[36:39], s34 offen lds
    s_mul_i32 s51, s4, 83200
    s_add_u32 s60, s60, s51
    s_add_u32 s61, s60, 5324800
    s_add_u32 s60, s60, 2662400
    s_lshr_b32 s51, s4, 4
    s_xor_b32 s58, s48, s51
    s_add_u32 m0, s47, 111104
    s_nop 0
    buffer_load_dwordx4 v6, s[36:39], s34 offen lds
    s_and_b32 s58, s58, 1
    s_xor_b32 s48, s48, s58
    s_lshl_b32 s48, s48, 5
    s_add_u32 s48, s48, s49
    s_mul_i32 s49, s58, 20
    s_add_u32 s48, s48, s49
    s_add_u32 m0, s47, 112128
    s_nop 0
    buffer_load_dwordx4 v7, s[36:39], s34 offen lds
    s_mul_i32 s48, s48, 512
    s_add_u32 s48, s48, 12582912
    s_and_b32 s49, s4, 15
    s_mul_i32 s49, s49, 5
    s_lshr_b32 s56, s49, 4
    s_add_u32 s49, s49, 4
    s_lshl_b32 s62, s7, 12
    s_add_u32 m0, s62, 43424
    s_add_u32 s62, s62, 4096
    v_lshl_add_u32 v207, v0, 4, s62
    global_load_lds_dwordx4 v207, s[0:1] offset:0
    global_load_lds_dwordx4 v207, s[0:1] offset:1024
    global_load_lds_dwordx4 v207, s[0:1] offset:2048
    global_load_lds_dwordx4 v207, s[0:1] offset:3072
    s_waitcnt vmcnt(17)
    s_barrier
    s_lshl_b32 s34, s44, 7
    s_mul_i32 s35, s44, 245760
    s_add_u32 m0, s33, 125440
    s_add_u32 s35, s35, s45
    buffer_load_dwordx4 v8, s[40:43], s35 offen lds
    s_lshr_b32 s57, s49, 4
    s_mul_i32 s56, s56, 1024
    s_mul_i32 s57, s57, 1024
    s_add_u32 s56, s56, s48
    s_add_u32 s57, s57, s48
    v_and_b32 v14, 4, v0
    s_add_u32 m0, s33, 126464
    s_add_u32 s44, s44, 1
    s_cmp_eq_u32 s44, 10
    s_cselect_b32 s44, 0, s44
    buffer_load_dwordx4 v9, s[40:43], s35 offen lds
    v_cmp_eq_u32 vcc, 0, v14
    v_mov_b32 v14, s56
    v_mov_b32 v15, s57
    v_cndmask_b32 v15, v15, v14, vcc
    v_and_b32 v14, 3, v0
    v_lshl_add_u32 v14, v14, 2, v15
    s_add_u32 m0, s47, 59904
    s_nop 0
    buffer_load_dwordx4 v4, s[36:39], s34 offen lds
    v_add_u32 v15, 0x80, v14
    s_cmp_eq_u32 s58, 0
    s_cselect_b32 s49, 640, 0
    v_and_b32 v12, 8, v0
    v_mad_u32_u24 v14, v12, s49, v14
    s_mul_i32 s48, s3, 16384
    s_add_u32 m0, s47, 60928
    s_nop 0
    buffer_load_dwordx4 v5, s[36:39], s34 offen lds
    s_add_u32 s48, s48, 12587776
    v_and_b32 v13, 31, v0
    v_lshl_add_u32 v13, v13, 2, s48
    s_mul_i32 s48, s4, 5
    s_lshr_b32 s20, s48, 4
    s_add_u32 s48, s48, 4
    s_add_u32 m0, s47, 61952
    s_nop 0
    buffer_load_dwordx4 v6, s[36:39], s34 offen lds
    s_lshr_b32 s21, s48, 4
    s_mul_i32 s20, s20, 4096
    s_mul_i32 s21, s21, 4096
    s_lshl_b32 s48, s3, 5
    s_lshr_b32 s49, s6, 2
    s_add_u32 s48, s48, s49
    s_waitcnt vmcnt(16) lgkmcnt(0)
    s_barrier
    s_add_u32 m0, s47, 62976
    s_nop 0
    buffer_load_dwordx4 v7, s[36:39], s34 offen lds
    s_mul_i32 s96, s96, 0x9e3779b1
    s_add_u32 s96, s96, 0x7f4a7c15
    s_getreg_b32 s97, hwreg(HW_REG_XCC_ID, 0, 4)
    s_xor_b32 s97, s97, s96
    s_lshl_b32 s62, s3, 14
    s_lshl_b32 s63, s4, 2
    s_lshl_b32 s34, s44, 7
    s_mul_i32 s35, s44, 245760
    s_add_u32 m0, s33, 133632
    s_add_u32 s35, s35, s45
    buffer_load_dwordx4 v8, s[40:43], s35 offen lds
    s_add_u32 s62, s62, s63
    s_add_u32 s62, s62, 12587776
    s_lshl_b32 s63, s7, 30
    v_mov_b32 v214, s97
    v_mov_b32 v207, s63
    s_mov_b64 exec, 1
    buffer_store_dword v214, v207, s[24:27], s62 offen
    s_mov_b64 exec, -1
    s_add_u32 m0, s33, 134656
    s_add_u32 s44, s44, 1
    s_cmp_eq_u32 s44, 10
    s_cselect_b32 s44, 0, s44
    buffer_load_dwordx4 v9, s[40:43], s35 offen lds
    v_mov_b32 v214, s96
    v_mov_b32 v207, 59808
    ds_write_b32 v207, v214 offset:32
    s_waitcnt lgkmcnt(0)
    s_mul_i32 s48, s48, 2048
    s_lshl_b32 s49, s7, 9
    s_add_u32 m0, s47, 76288
    s_nop 0
    buffer_load_dwordx4 v4, s[36:39], s34 offen lds
    s_add_u32 s48, s48, s49
    s_add_u32 s48, s48, 12845056
    s_add_u32 s20, s20, s48
    s_add_u32 s21, s21, s48
    s_lshl_b32 s48, s3, 5
    s_add_u32 s48, s48, s6
    s_add_u32 m0, s47, 77312
    s_nop 0
    buffer_load_dwordx4 v5, s[36:39], s34 offen lds
    s_lshl_b32 s12, s48, 9
    s_lshl_b32 s49, s4, 2
    s_add_u32 s12, s12, s49
    s_add_u32 s12, s12, 12583168
    s_sub_u32 s13, 8, s6
    s_cmp_eq_u32 s3, 0
    s_cselect_b32 s13, s13, 0
    s_waitcnt vmcnt(15)
    s_barrier
    s_add_u32 m0, s47, 78336
    s_nop 0
    buffer_load_dwordx4 v6, s[36:39], s34 offen lds
    s_movk_i32 s14, 16640
    v_lshlrev_b32 v208, 4, v0
    v_add_u32 v209, 158208, v208
    ds_read_b128 v[240:243], v209 offset:0
    ds_read_b128 v[244:247], v209 offset:1024
    ds_read_b128 v[248:251], v209 offset:2048
    s_add_u32 m0, s47, 79360
    s_nop 0
    buffer_load_dwordx4 v7, s[36:39], s34 offen lds
    ds_read_b96 v[252:254], v209 offset:3072
    v_cmp_gt_u32 vcc, 32, v0
    v_mov_b32 v210, 0x3f803f80
    s_mul_i32 s49, s4, 83200
    v_cndmask_b32 v230, 0, v210, vcc
    s_lshl_b32 s51, s3, 11
    s_lshl_b32 s34, s44, 7
    s_mul_i32 s35, s44, 245760
    s_add_u32 m0, s33, 141824
    s_add_u32 s35, s35, s45
    buffer_load_dwordx4 v8, s[40:43], s35 offen lds
    v_lshrrev_b32 v231, 16, v230
    s_add_u32 s49, s49, s51
    v_mov_b32 v238, v230
    s_lshl_b32 s48, s6, 8
    v_mov_b32 v239, v231
    s_add_u32 s49, s49, s48
    s_add_u32 m0, s33, 142848
    s_add_u32 s44, s44, 1
    s_cmp_eq_u32 s44, 10
    s_cselect_b32 s44, 0, s44
    buffer_load_dwordx4 v9, s[40:43], s35 offen lds
    v_mov_b32 v222, s20
    v_writelane_b32 v222, s21, 1
    s_waitcnt lgkmcnt(0)
    v_add_u32 v248, s48, v248
    v_add_u32 v249, s48, v249
    v_mad_u32_u24 v250, v253, s6, v250
    s_add_u32 m0, s47, 92672
    s_nop 0
    buffer_load_dwordx4 v4, s[36:39], s34 offen lds
    v_add_u32 v251, s49, v251
    v_add_u32 v252, s49, v252
    v_add_u32 v254, s49, v254
    v_mov_b32 v253, v208
    s_sub_u32 s100, 31, s4
    s_cmp_ge_u32 s100, 10
    s_cselect_b32 s101, 8, 0
    s_cselect_b32 s48, 10, 0
    s_waitcnt vmcnt(10)
    s_barrier
    s_add_u32 m0, s47, 93696
    s_nop 0
    buffer_load_dwordx4 v5, s[36:39], s34 offen lds
    s_sub_u32 s100, s100, s48
    s_cmp_ge_u32 s100, 10
    s_cselect_b32 s100, 11, s100
    s_add_u32 s101, s101, s3
    v_and_b32 v11, 7, v0
    v_lshlrev_b32 v10, 4, v11
    s_add_u32 m0, s47, 94720
    s_nop 0
    buffer_load_dwordx4 v6, s[36:39], s34 offen lds
    v_and_b32 v11, 31, v0
    s_cmp_ge_u32 s100, 5
    s_cselect_b32 s48, 1, 0
    s_lshl_b32 s49, s7, 1
    s_add_u32 s48, s48, s49
    s_lshl_b32 s48, s48, 9
    s_add_u32 m0, s47, 95744
    s_nop 0
    buffer_load_dwordx4 v7, s[36:39], s34 offen lds
    s_add_u32 s48, s48, 12583296
    v_and_b32 v16, 3, v0
    v_and_b32 v11, 28, v0
    v_lshl_add_u32 v11, v11, 12, s48
    v_lshl_add_u32 v11, v16, 2, v11
    s_cmp_eq_u32 s100, 0
    s_cselect_b32 s48, 32, 0
    s_lshl_b32 s34, s44, 7
    s_mul_i32 s35, s44, 245760
    s_add_u32 m0, s33, 150016
    s_add_u32 s35, s35, s45
    buffer_load_dwordx4 v8, s[40:43], s35 offen lds
    s_cmp_eq_u32 s100, 5
    s_cselect_b32 s48, 32, s48
    v_and_b32 v16, s48, v0
    v_lshlrev_b32 v16, 4, v16
    v_xor_b32 v11, v16, v11
    s_lshr_b32 s48, s4, 2
    s_add_u32 m0, s33, 151040
    s_add_u32 s44, s44, 1
    s_cmp_eq_u32 s44, 10
    s_cselect_b32 s44, 0, s44
    buffer_load_dwordx4 v9, s[40:43], s35 offen lds
    s_lshl_b32 s48, s48, 14
    s_add_u32 s48, s48, 12588288
    v_writelane_b32 v14, s48, 32
    s_nop 0
    s_add_u32 s48, s48, 4
    v_writelane_b32 v14, s48, 33
    s_waitcnt vmcnt(8)
    s_barrier
    s_add_u32 m0, s47, 109056
    s_nop 0
    buffer_load_dwordx4 v4, s[36:39], s34 offen lds
    s_andn2_b32 s62, s5, 24
    s_lshl_b32 s62, s62, 9
    s_lshr_b32 s63, s4, 3
    s_lshl_b32 s63, s63, 2
    s_add_u32 s62, s62, s63
    s_add_u32 s62, s62, 12583296
    s_add_u32 m0, s47, 110080
    s_nop 0
    buffer_load_dwordx4 v5, s[36:39], s34 offen lds
    s_lshl_b32 s63, s7, 30
    v_mov_b32 v214, s96
    v_mov_b32 v207, s63
    s_mov_b64 exec, 1
    buffer_store_dword v214, v207, s[24:27], s62 offen sc1
    s_mov_b64 exec, -1
    s_add_u32 m0, s47, 111104
    s_nop 0
    buffer_load_dwordx4 v6, s[36:39], s34 offen lds
    v_lshrrev_b32 v12, 5, v0
    v_bfe_u32 v16, v0, 3, 1
    v_lshl_add_u32 v16, v12, 1, v16
    v_bfe_u32 v17, v0, 4, 1
    v_lshl_add_u32 v16, v16, 1, v17
    s_movk_i32 s48, 5632
    s_add_u32 m0, s47, 112128
    s_nop 0
    buffer_load_dwordx4 v7, s[36:39], s34 offen lds
    v_mad_u32_u24 v10, v16, s48, v10
    s_lshl_b32 s98, s101, 7
    s_add_u32 s98, s98, s7
    s_mul_i32 s98, s98, 1408
    s_lshl_b32 s48, s100, 7
    s_add_u32 s98, s98, s48
    s_lshl_b32 s34, s44, 7
    s_mul_i32 s35, s44, 245760
    s_add_u32 m0, s33, 125440
    s_add_u32 s35, s35, s45
    buffer_load_dwordx4 v8, s[40:43], s35 offen lds
    s_add_u32 s98, s98, 7987200
    s_movk_i32 s48, 5632
    v_mul_u32_u24 v204, s48, v0
    s_cmp_eq_u32 s100, 11
    s_cselect_b32 s49, 2.0, 0
    v_or_b32 v10, s49, v10
    s_add_u32 m0, s33, 126464
    s_add_u32 s44, s44, 1
    s_cmp_eq_u32 s44, 10
    s_cselect_b32 s44, 0, s44
    buffer_load_dwordx4 v9, s[40:43], s35 offen lds
    v_or_b32 v204, s49, v204
    v_lshlrev_b32 v205, 4, v12
    v_add_u32 v205, 162304, v205
    v_bfe_u32 v17, v0, 4, 1
    v_mul_u32_u24 v17, 20, v17
    v_and_b32 v16, 31, v0
    s_waitcnt vmcnt(9)
    s_barrier
    s_add_u32 m0, s47, 59904
    s_nop 0
    buffer_load_dwordx4 v4, s[36:39], s34 offen lds
    v_xor_b32 v16, v16, v17
    v_min_u32 v16, 1, v16
    v_lshl_add_u32 v205, v16, 9, v205
    s_lshl_b32 s48, s6, 8
    v_subrev_u32 v206, s48, v249
    v_lshrrev_b32 v206, 1, v206
    s_add_u32 m0, s47, 60928
    s_nop 0
    buffer_load_dwordx4 v5, s[36:39], s34 offen lds
    v_lshl_add_u32 v206, v12, 9, v206
    v_add_u32 v206, 35232, v206
    s_lshl_b32 s48, s7, 9
    s_add_u32 s48, s48, s101
    v_and_b32 v16, 15, v0
    v_lshl_add_u32 v17, v16, 4, s48
    s_add_u32 m0, s47, 61952
    s_nop 0
    buffer_load_dwordx4 v6, s[36:39], s34 offen lds
    s_movk_i32 s48, 2560
    v_bfe_u32 v18, v0, 4, 1
    v_lshlrev_b32 v18, 5, v18
    v_lshl_add_u32 v18, v12, 4, v18
    s_lshl_b32 s51, s100, 6
    v_add_u32 v18, s51, v18
    s_add_u32 m0, s47, 62976
    s_nop 0
    buffer_load_dwordx4 v7, s[36:39], s34 offen lds
    v_mad_u32_u24 v200, v17, s48, v18
    v_add_u32 v201, 655360, v200
    v_sub_u32 v18, 1264, v18
    v_sub_u32 v16, 2048, v17
    v_and_b32 v16, 2047, v16
    v_mad_u32_u24 v202, v16, s48, v18
    s_lshl_b32 s34, s44, 7
    s_mul_i32 s35, s44, 245760
    s_add_u32 m0, s33, 133632
    s_add_u32 s35, s35, s45
    buffer_load_dwordx4 v8, s[40:43], s35 offen lds
    v_sub_u32 v16, 1792, v17
    v_mad_u32_u24 v203, v16, s48, v18
    v_or_b32 v200, s49, v200
    v_or_b32 v201, s49, v201
    v_or_b32 v202, s49, v202
    v_or_b32 v203, s49, v203
    s_add_u32 m0, s33, 134656
    s_add_u32 s44, s44, 1
    s_cmp_eq_u32 s44, 10
    s_cselect_b32 s44, 0, s44
    buffer_load_dwordx4 v9, s[40:43], s35 offen lds
    ds_read_b128 v[104:107], v253 offset:43424
    ds_read_b128 v[108:111], v253 offset:44448
    ds_read_b128 v[112:115], v253 offset:45472
    ds_read_b128 v[116:119], v253 offset:46496
    ds_read_b128 v[120:123], v253 offset:47520
    ds_read_b128 v[124:127], v253 offset:48544
    s_waitcnt vmcnt(8)
    s_barrier
    s_add_u32 m0, s47, 76288
    s_nop 0
    buffer_load_dwordx4 v4, s[36:39], s34 offen lds
    ds_read_b128 v[128:131], v253 offset:49568
    ds_read_b128 v[132:135], v253 offset:50592
    ds_read_b128 v[136:139], v253 offset:51616
    ds_read_b128 v[140:143], v253 offset:52640
    ds_read_b128 v[144:147], v253 offset:53664
    ds_read_b128 v[148:151], v253 offset:54688
    s_add_u32 m0, s47, 77312
    s_nop 0
    buffer_load_dwordx4 v5, s[36:39], s34 offen lds
    ds_read_b128 v[152:155], v253 offset:55712
    ds_read_b128 v[156:159], v253 offset:56736
    ds_read_b128 v[160:163], v253 offset:57760
    ds_read_b128 v[164:167], v253 offset:58784
    s_and_b32 s8, s7, 1
    s_mul_i32 s9, s8, 0x80008000
    s_add_u32 m0, s47, 78336
    s_nop 0
    buffer_load_dwordx4 v6, s[36:39], s34 offen lds
    s_lshl_b32 s8, s8, 4
    s_add_u32 s15, s7, 1
    s_lshl_b32 s15, s15, 30
    s_and_b32 s15, s15, 0x80000000
    s_and_b32 s99, s7, 2
    s_lshl_b32 s99, s99, 14
    s_add_u32 m0, s47, 79360
    s_nop 0
    buffer_load_dwordx4 v7, s[36:39], s34 offen lds
    s_or_b32 s15, s15, s99
    s_xor_b32 s99, s15, s9
    s_waitcnt lgkmcnt(0)
    s_mul_i32 s35, s59, 245760
    s_add_u32 m0, s33, 92672
    s_add_u32 s35, s35, s46
    buffer_load_dwordx4 v8, s[40:43], s35 offen lds
    s_waitcnt vmcnt(7)
    s_barrier
    s_add_u32 m0, s33, 93696
    s_add_u32 s59, s59, 1
    s_cmp_eq_u32 s59, 10
    s_cselect_b32 s59, 0, s59
    buffer_load_dwordx4 v9, s[40:43], s35 offen lds
    s_mul_i32 s35, s59, 245760
    s_add_u32 m0, s33, 100864
    s_add_u32 s35, s35, s46
    buffer_load_dwordx4 v8, s[40:43], s35 offen lds
    s_add_u32 m0, s33, 101888
    s_add_u32 s59, s59, 1
    s_cmp_eq_u32 s59, 10
    s_cselect_b32 s59, 0, s59
    buffer_load_dwordx4 v9, s[40:43], s35 offen lds
    s_mul_i32 s35, s59, 245760
    s_add_u32 m0, s33, 109056
    s_add_u32 s35, s35, s46
    buffer_load_dwordx4 v8, s[40:43], s35 offen lds
    s_add_u32 m0, s33, 110080
    s_add_u32 s59, s59, 1
    s_cmp_eq_u32 s59, 10
    s_cselect_b32 s59, 0, s59
    buffer_load_dwordx4 v9, s[40:43], s35 offen lds
    s_mul_i32 s35, s59, 245760
    s_add_u32 m0, s33, 117248
    s_add_u32 s35, s35, s46
    buffer_load_dwordx4 v8, s[40:43], s35 offen lds
    s_waitcnt vmcnt(7)
    s_barrier
    s_add_u32 m0, s33, 118272
    s_add_u32 s59, s59, 1
    s_cmp_eq_u32 s59, 10
    s_cselect_b32 s59, 0, s59
    buffer_load_dwordx4 v9, s[40:43], s35 offen lds
    s_mul_i32 s35, s59, 245760
    s_add_u32 m0, s33, 59904
    s_add_u32 s35, s35, s46
    buffer_load_dwordx4 v8, s[40:43], s35 offen lds
    s_add_u32 m0, s33, 60928
    s_add_u32 s59, s59, 1
    s_cmp_eq_u32 s59, 10
    s_cselect_b32 s59, 0, s59
    buffer_load_dwordx4 v9, s[40:43], s35 offen lds
    s_mul_i32 s35, s59, 245760
    s_add_u32 m0, s33, 68096
    s_add_u32 s35, s35, s46
    buffer_load_dwordx4 v8, s[40:43], s35 offen lds
    s_add_u32 m0, s33, 69120
    s_add_u32 s59, s59, 1
    s_cmp_eq_u32 s59, 10
    s_cselect_b32 s59, 0, s59
    buffer_load_dwordx4 v9, s[40:43], s35 offen lds
    s_waitcnt vmcnt(8)
    s_barrier
    buffer_load_dword v208, v13, s[24:27], 0 offen sc1
    s_mul_i32 s35, s59, 245760
    s_add_u32 m0, s33, 76288
    s_add_u32 s35, s35, s46
    buffer_load_dwordx4 v8, s[40:43], s35 offen lds
    s_add_u32 m0, s33, 77312
    s_add_u32 s59, s59, 1
    s_cmp_eq_u32 s59, 10
    s_cselect_b32 s59, 0, s59
    buffer_load_dwordx4 v9, s[40:43], s35 offen lds
    s_mul_i32 s35, s59, 245760
    s_add_u32 m0, s33, 84480
    s_add_u32 s35, s35, s46
    buffer_load_dwordx4 v8, s[40:43], s35 offen lds
    s_add_u32 m0, s33, 85504
    s_add_u32 s59, s59, 1
    s_cmp_eq_u32 s59, 10
    s_cselect_b32 s59, 0, s59
    buffer_load_dwordx4 v9, s[40:43], s35 offen lds
    s_waitcnt vmcnt(9)
    s_barrier
    s_mul_i32 s35, s59, 245760
    s_add_u32 m0, s33, 92672
    s_add_u32 s35, s35, s46
    buffer_load_dwordx4 v8, s[40:43], s35 offen lds
    s_add_u32 m0, s33, 93696
    s_add_u32 s59, s59, 1
    s_cmp_eq_u32 s59, 10
    s_cselect_b32 s59, 0, s59
    buffer_load_dwordx4 v9, s[40:43], s35 offen lds
    s_mul_i32 s35, s59, 245760
    s_add_u32 m0, s33, 100864
    s_add_u32 s35, s35, s46
    buffer_load_dwordx4 v8, s[40:43], s35 offen lds
    s_add_u32 m0, s33, 101888
    s_add_u32 s59, s59, 1
    s_cmp_eq_u32 s59, 10
    s_cselect_b32 s59, 0, s59
    buffer_load_dwordx4 v9, s[40:43], s35 offen lds
    s_waitcnt vmcnt(8)
    s_barrier
    buffer_load_dword v36, v11, s[24:27], 0 offen sc1
    v_cmp_ne_u32 vcc, s97, v208
    s_nop 1
    s_cmp_eq_u64 vcc, 0
    s_cselect_b32 s32, 1, 0
    v_mov_b32 v40, s96
    v_mov_b32 v41, s97
    v_mov_b32 v42, s32
    v_mov_b32 v207, 59808
    ds_write_b96 v207, v[40:42] offset:16
    s_waitcnt lgkmcnt(0)
    s_waitcnt vmcnt(5)
    s_barrier
    s_mov_b32 s50, 200000
    s_waitcnt vmcnt(0)
    s_branch SC_9
SP_8:
    buffer_load_dword v36, v11, s[24:27], 0 offen sc1
    s_waitcnt vmcnt(0)
SC_9:
    v_cmp_ne_u32 vcc, s96, v36
    s_sub_u32 s50, s50, 1
    s_cbranch_scc1 SD_10
    s_cbranch_vccnz SP_8
SD_10:
    s_cmp_eq_u32 s100, 0
    s_cselect_b32 s49, 0x500, -4
    s_add_u32 s49, s49, s98
    s_lshl_b32 s48, s7, 7
    s_add_u32 m0, s48, 162304
    s_mov_b32 exec_hi, 0
    buffer_load_dword v204, s[24:27], s49 offen sc1 lds
    s_mov_b64 exec, -1
    s_lshl_b32 s48, s7, 12
    s_add_u32 m0, s48, 43424
    s_nop 0
    buffer_load_dwordx4 v10, s[24:27], s98 offen sc1 lds
    s_add_u32 s98, s98, 45056
    s_add_u32 m0, s48, 44448
    s_nop 0
    buffer_load_dwordx4 v10, s[24:27], s98 offen sc1 lds
    s_add_u32 s98, s98, 45056
    s_add_u32 m0, s48, 45472
    s_nop 0
    buffer_load_dwordx4 v10, s[24:27], s98 offen sc1 lds
    s_add_u32 s98, s98, 45056
    s_add_u32 m0, s48, 46496
    s_nop 0
    buffer_load_dwordx4 v10, s[24:27], s98 offen sc1 lds
    s_waitcnt vmcnt(6)
    s_barrier
    buffer_load_dword v209, v14, s[24:27], 0 offen sc1
    s_waitcnt vmcnt(0)
    s_barrier
    s_branch L_KV
L_SPARE:
    s_mov_b32 s24, s22
    s_mov_b32 s25, s23
    s_mov_b32 s26, 268435456
    s_mov_b32 s27, 0x00020000
    s_mov_b32 s28, s18
    s_mov_b32 s29, s19
    s_mov_b32 s30, 5242880
    s_mov_b32 s31, 0x00020000
    s_mov_b32 s18, 819200
    s_mov_b32 s19, 0x00020000
    s_lshl_b32 s33, s7, 6
    v_add_u32 v9, s33, v0
    s_movk_i32 s33, 6554
    s_movk_i32 s34, 1120
    s_mul_i32 s41, s3, 160
    v_add_u32 v1, 0, v9
    v_mul_u32_u24 v2, s33, v1
    v_lshrrev_b32 v2, 16, v2
    v_lshl_add_u32 v1, v1, 4, s41
    v_mad_u32_u24 v4, v2, s34, v1
    v_add_u32 v1, 256, v9
    v_mul_u32_u24 v2, s33, v1
    v_lshrrev_b32 v2, 16, v2
    v_lshl_add_u32 v1, v1, 4, s41
    v_mad_u32_u24 v5, v2, s34, v1
    v_add_u32 v1, 512, v9
    v_mul_u32_u24 v2, s33, v1
    v_lshrrev_b32 v2, 16, v2
    v_lshl_add_u32 v1, v1, 4, s41
    v_mad_u32_u24 v6, v2, s34, v1
    v_add_u32 v1, 768, v9
    v_mul_u32_u24 v2, s33, v1
    v_lshrrev_b32 v2, 16, v2
    v_lshl_add_u32 v1, v1, 4, s41
    v_mad_u32_u24 v7, v2, s34, v1
    v_add_u32 v1, 1024, v9
    v_mul_u32_u24 v2, s33, v1
    v_lshrrev_b32 v2, 16, v2
    v_lshl_add_u32 v1, v1, 4, s41
    v_mad_u32_u24 v8, v2, s34, v1
    s_mul_i32 s41, s10, 409600
    s_lshl_b32 s43, s7, 10
    s_add_u32 m0, s43, 59904
    s_nop 0
    buffer_load_dwordx4 v4, s[16:19], s41 offen lds
    s_add_u32 m0, s43, 64000
    s_nop 0
    buffer_load_dwordx4 v5, s[16:19], s41 offen lds
    s_add_u32 m0, s43, 68096
    s_nop 0
    buffer_load_dwordx4 v6, s[16:19], s41 offen lds
    s_add_u32 m0, s43, 72192
    s_nop 0
    buffer_load_dwordx4 v7, s[16:19], s41 offen lds
    s_add_u32 m0, s43, 76288
    s_nop 0
    buffer_load_dwordx4 v8, s[16:19], s41 offen lds
    s_add_u32 s41, s41, 163840
    s_add_u32 m0, s43, 80384
    s_nop 0
    buffer_load_dwordx4 v4, s[16:19], s41 offen lds
    s_add_u32 m0, s43, 84480
    s_nop 0
    buffer_load_dwordx4 v5, s[16:19], s41 offen lds
    s_add_u32 m0, s43, 88576
    s_nop 0
    buffer_load_dwordx4 v6, s[16:19], s41 offen lds
    s_add_u32 m0, s43, 92672
    s_nop 0
    buffer_load_dwordx4 v7, s[16:19], s41 offen lds
    s_add_u32 m0, s43, 96768
    s_nop 0
    buffer_load_dwordx4 v8, s[16:19], s41 offen lds
    s_add_u32 s41, s41, 163840
    s_add_u32 m0, s43, 100864
    s_nop 0
    buffer_load_dwordx4 v4, s[16:19], s41 offen lds
    s_add_u32 m0, s43, 104960
    s_nop 0
    buffer_load_dwordx4 v5, s[16:19], s41 offen lds
    s_add_u32 m0, s43, 109056
    s_nop 0
    buffer_load_dwordx4 v6, s[16:19], s41 offen lds
    s_mul_i32 s62, s7, 20
    v_add_u32 v214, s62, v0
    v_lshrrev_b32 v215, 4, v214
    s_movk_i32 s62, 14592
    v_mul_u32_u24 v215, s62, v215
    v_lshl_add_u32 v214, v214, 7, v215
    s_mul_i32 s62, s4, 83200
    s_lshl_b32 s63, s3, 11
    s_add_u32 s62, s62, s63
    v_add_u32 v214, s62, v214
    s_lshl_b32 s62, s5, 2
    s_add_u32 s62, s62, s7
    s_lshl_b32 s62, s62, 7
    s_add_u32 s62, s62, 12582912
    v_writelane_b32 v214, s62, 20
    s_lshl_b32 s62, s62, 2
    s_add_u32 s62, s62, 4257480704
    v_writelane_b32 v214, s62, 21
    s_add_u32 s62, s62, 128
    v_writelane_b32 v214, s62, 22
    s_add_u32 s62, s62, 128
    v_writelane_b32 v214, s62, 23
    s_add_u32 s62, s62, 128
    v_writelane_b32 v214, s62, 24
    s_mov_b64 exec, 0x1ffffff
    buffer_load_dword v215, v214, s[24:27], 0 offen
    s_mov_b64 exec, -1
    v_mov_b32 v172, 0x3e9e377a
    v_mov_b32 v173, v172
    v_mov_b32 v174, 0xbf4f1bbd
    v_mov_b32 v175, v174
    v_mov_b32 v176, 0x3f737871
    v_mov_b32 v177, v176
    v_mov_b32 v178, 0x3f167918
    v_mov_b32 v179, v178
    v_mov_b32 v180, 0xbf737871
    v_mov_b32 v181, v180
    s_mov_b32 s62, 0xffff0000
    s_mov_b32 s63, 0x80008000
    s_lshl_b32 s50, s7, 2
    v_add_u32 v184, s50, v12
    v_and_b32 v185, 7, v11
    v_xor_b32 v184, v184, v185
    v_lshl_add_u32 v184, v11, 4, v184
    v_lshlrev_b32 v184, 4, v184
    s_waitcnt vmcnt(14)
    v_lshlrev_b32 v116, 16, v96
    v_and_b32 v117, s62, v96
    v_lshlrev_b32 v118, 16, v100
    v_and_b32 v119, s62, v100
    v_lshlrev_b32 v120, 16, v104
    v_and_b32 v121, s62, v104
    v_lshlrev_b32 v122, 16, v108
    v_and_b32 v123, s62, v108
    v_lshlrev_b32 v124, 16, v112
    v_and_b32 v125, s62, v112
    v_pk_add_f32 v[126:127], v[118:119], v[124:125] neg_lo:[0,1] neg_hi:[0,1]
    v_pk_add_f32 v[118:119], v[118:119], v[124:125]
    v_pk_add_f32 v[124:125], v[120:121], v[122:123] neg_lo:[0,1] neg_hi:[0,1]
    v_pk_add_f32 v[120:121], v[120:121], v[122:123]
    v_pk_add_f32 v[128:129], v[116:117], v[118:119]
    v_pk_fma_f32 v[130:131], v[118:119], v[172:173], v[116:117]
    v_pk_fma_f32 v[132:133], v[118:119], v[174:175], v[116:117]
    v_pk_mul_f32 v[134:135], v[126:127], v[176:177]
    v_pk_mul_f32 v[136:137], v[126:127], v[178:179]
    v_pk_add_f32 v[128:129], v[128:129], v[120:121]
    v_pk_fma_f32 v[130:131], v[120:121], v[174:175], v[130:131]
    v_pk_fma_f32 v[132:133], v[120:121], v[172:173], v[132:133]
    v_pk_fma_f32 v[134:135], v[124:125], v[178:179], v[134:135]
    v_pk_fma_f32 v[136:137], v[124:125], v[180:181], v[136:137]
    v_cvt_pk_bf16_f32 v144, v128, v129
    v_cvt_pk_bf16_f32 v148, v130, v131
    v_cvt_pk_bf16_f32 v152, v132, v133
    v_cvt_pk_bf16_f32 v156, v134, v135
    v_cvt_pk_bf16_f32 v160, v136, v137
    v_xor_b32 v164, s63, v160
    v_xor_b32 v168, s63, v156
    v_lshlrev_b32 v116, 16, v97
    v_and_b32 v117, s62, v97
    v_lshlrev_b32 v118, 16, v101
    v_and_b32 v119, s62, v101
    v_lshlrev_b32 v120, 16, v105
    v_and_b32 v121, s62, v105
    v_lshlrev_b32 v122, 16, v109
    v_and_b32 v123, s62, v109
    v_lshlrev_b32 v124, 16, v113
    v_and_b32 v125, s62, v113
    v_pk_add_f32 v[126:127], v[118:119], v[124:125] neg_lo:[0,1] neg_hi:[0,1]
    v_pk_add_f32 v[118:119], v[118:119], v[124:125]
    v_pk_add_f32 v[124:125], v[120:121], v[122:123] neg_lo:[0,1] neg_hi:[0,1]
    v_pk_add_f32 v[120:121], v[120:121], v[122:123]
    v_pk_add_f32 v[128:129], v[116:117], v[118:119]
    v_pk_fma_f32 v[130:131], v[118:119], v[172:173], v[116:117]
    v_pk_fma_f32 v[132:133], v[118:119], v[174:175], v[116:117]
    v_pk_mul_f32 v[134:135], v[126:127], v[176:177]
    v_pk_mul_f32 v[136:137], v[126:127], v[178:179]
    v_pk_add_f32 v[128:129], v[128:129], v[120:121]
    v_pk_fma_f32 v[130:131], v[120:121], v[174:175], v[130:131]
    v_pk_fma_f32 v[132:133], v[120:121], v[172:173], v[132:133]
    v_pk_fma_f32 v[134:135], v[124:125], v[178:179], v[134:135]
    v_pk_fma_f32 v[136:137], v[124:125], v[180:181], v[136:137]
    v_cvt_pk_bf16_f32 v145, v128, v129
    v_cvt_pk_bf16_f32 v149, v130, v131
    v_cvt_pk_bf16_f32 v153, v132, v133
    v_cvt_pk_bf16_f32 v157, v134, v135
    v_cvt_pk_bf16_f32 v161, v136, v137
    v_xor_b32 v165, s63, v161
    v_xor_b32 v169, s63, v157
    v_lshlrev_b32 v116, 16, v98
    v_and_b32 v117, s62, v98
    v_lshlrev_b32 v118, 16, v102
    v_and_b32 v119, s62, v102
    v_lshlrev_b32 v120, 16, v106
    v_and_b32 v121, s62, v106
    v_lshlrev_b32 v122, 16, v110
    v_and_b32 v123, s62, v110
    v_lshlrev_b32 v124, 16, v114
    v_and_b32 v125, s62, v114
    v_pk_add_f32 v[126:127], v[118:119], v[124:125] neg_lo:[0,1] neg_hi:[0,1]
    v_pk_add_f32 v[118:119], v[118:119], v[124:125]
    v_pk_add_f32 v[124:125], v[120:121], v[122:123] neg_lo:[0,1] neg_hi:[0,1]
    v_pk_add_f32 v[120:121], v[120:121], v[122:123]
    v_pk_add_f32 v[128:129], v[116:117], v[118:119]
    v_pk_fma_f32 v[130:131], v[118:119], v[172:173], v[116:117]
    v_pk_fma_f32 v[132:133], v[118:119], v[174:175], v[116:117]
    v_pk_mul_f32 v[134:135], v[126:127], v[176:177]
    v_pk_mul_f32 v[136:137], v[126:127], v[178:179]
    v_pk_add_f32 v[128:129], v[128:129], v[120:121]
    v_pk_fma_f32 v[130:131], v[120:121], v[174:175], v[130:131]
    v_pk_fma_f32 v[132:133], v[120:121], v[172:173], v[132:133]
    v_pk_fma_f32 v[134:135], v[124:125], v[178:179], v[134:135]
    v_pk_fma_f32 v[136:137], v[124:125], v[180:181], v[136:137]
    v_cvt_pk_bf16_f32 v146, v128, v129
    v_cvt_pk_bf16_f32 v150, v130, v131
    v_cvt_pk_bf16_f32 v154, v132, v133
    v_cvt_pk_bf16_f32 v158, v134, v135
    v_cvt_pk_bf16_f32 v162, v136, v137
    v_xor_b32 v166, s63, v162
    v_xor_b32 v170, s63, v158
    v_lshlrev_b32 v116, 16, v99
    v_and_b32 v117, s62, v99
    v_lshlrev_b32 v118, 16, v103
    v_and_b32 v119, s62, v103
    v_lshlrev_b32 v120, 16, v107
    v_and_b32 v121, s62, v107
    v_lshlrev_b32 v122, 16, v111
    v_and_b32 v123, s62, v111
    v_lshlrev_b32 v124, 16, v115
    v_and_b32 v125, s62, v115
    v_pk_add_f32 v[126:127], v[118:119], v[124:125] neg_lo:[0,1] neg_hi:[0,1]
    v_pk_add_f32 v[118:119], v[118:119], v[124:125]
    v_pk_add_f32 v[124:125], v[120:121], v[122:123] neg_lo:[0,1] neg_hi:[0,1]
    v_pk_add_f32 v[120:121], v[120:121], v[122:123]
    v_pk_add_f32 v[128:129], v[116:117], v[118:119]
    v_pk_fma_f32 v[130:131], v[118:119], v[172:173], v[116:117]
    v_pk_fma_f32 v[132:133], v[118:119], v[174:175], v[116:117]
    v_pk_mul_f32 v[134:135], v[126:127], v[176:177]
    v_pk_mul_f32 v[136:137], v[126:127], v[178:179]
    v_pk_add_f32 v[128:129], v[128:129], v[120:121]
    v_pk_fma_f32 v[130:131], v[120:121], v[174:175], v[130:131]
    v_pk_fma_f32 v[132:133], v[120:121], v[172:173], v[132:133]
    v_pk_fma_f32 v[134:135], v[124:125], v[178:179], v[134:135]
    v_pk_fma_f32 v[136:137], v[124:125], v[180:181], v[136:137]
    v_cvt_pk_bf16_f32 v147, v128, v129
    v_cvt_pk_bf16_f32 v151, v130, v131
    v_cvt_pk_bf16_f32 v155, v132, v133
    v_cvt_pk_bf16_f32 v159, v134, v135
    v_cvt_pk_bf16_f32 v163, v136, v137
    v_xor_b32 v167, s63, v163
    v_xor_b32 v171, s63, v159
    ds_write_b128 v184, v[144:147] offset:0
    ds_write_b128 v184, v[148:151] offset:4096
    ds_write_b128 v184, v[152:155] offset:8192
    ds_write_b128 v184, v[156:159] offset:12288
    ds_write_b128 v184, v[160:163] offset:16384
    ds_write_b128 v184, v[164:167] offset:20480
    ds_write_b128 v184, v[168:171] offset:24576
    s_waitcnt lgkmcnt(0)
    s_barrier
    s_setprio 0
    s_lshl_b32 s62, s7, 10
    v_lshl_add_u32 v207, v0, 4, s62
    s_add_u32 m0, s62, 158208
    s_nop 0
    global_load_lds_dwordx4 v207, s[0:1]
    s_lshl_b32 s62, s7, 12
    s_add_u32 m0, s62, 43424
    s_add_u32 s62, s62, 4096
    v_lshl_add_u32 v207, v0, 4, s62
    global_load_lds_dwordx4 v207, s[0:1] offset:0
    global_load_lds_dwordx4 v207, s[0:1] offset:1024
    global_load_lds_dwordx4 v207, s[0:1] offset:2048
    global_load_lds_dwordx4 v207, s[0:1] offset:3072
    s_load_dwordx16 s[64:79], s[0:1], 20480
    s_load_dwordx16 s[80:95], s[0:1], 20544
    s_mov_b32 s97, 12588800
    s_load_dword s96, s[22:23], s97
    s_waitcnt lgkmcnt(0)
    s_mul_i32 s96, s96, 0x9e3779b1
    s_add_u32 s96, s96, 0x7f4a7c15
    s_getreg_b32 s97, hwreg(HW_REG_XCC_ID, 0, 4)
    s_xor_b32 s97, s97, s96
    s_lshl_b32 s62, s3, 14
    s_lshl_b32 s63, s4, 2
    s_add_u32 s62, s62, s63
    s_add_u32 s62, s62, 12587776
    s_lshl_b32 s63, s7, 30
    v_mov_b32 v214, s97
    v_mov_b32 v207, s63
    s_mov_b64 exec, 1
    buffer_store_dword v214, v207, s[24:27], s62 offen
    s_mov_b64 exec, -1
    s_mov_b32 s32, 0
    v_mov_b32 v40, s96
    v_mov_b32 v41, s97
    v_mov_b32 v42, s32
    v_mov_b32 v207, 59808
    ds_write_b96 v207, v[40:42] offset:16
    s_waitcnt lgkmcnt(0)
    s_waitcnt vmcnt(0)
    s_barrier
    v_and_b32 v1, 15, v0
    v_lshrrev_b32 v2, 4, v0
    v_and_b32 v3, 1, v2
    v_lshrrev_b32 v4, 1, v2
    v_lshrrev_b32 v7, 2, v1
    s_movk_i32 s38, 160
    v_mul_u32_u24 v7, s38, v7
    v_and_b32 v1, 3, v1
    s_and_b32 s33, s3, 1
    s_lshl_b32 s34, s33, 5
    s_add_u32 s34, s34, 59904
    v_lshl_add_u32 v8, v1, 4, v7
    v_add_u32 v8, s34, v8
    s_xor_b32 s33, s33, 1
    s_lshl_b32 s34, s33, 7
    s_add_u32 s34, s34, 59904
    v_lshl_add_u32 v9, v1, 3, v7
    v_add_u32 v9, s34, v9
    v_mul_u32_u24 v5, 20, v4
    s_mul_i32 s33, s7, 40
    v_add_u32 v5, s33, v5
    v_mad_u32_u24 v6, v3, 4, v5
    v_add_u32 v6, 4, v6
    v_mad_u32_u24 v5, v3, 12, v5
    v_mad_u32_u24 v16, v5, s38, v8
    v_mad_u32_u24 v17, v6, s38, v8
    v_mad_u32_u24 v18, v5, s38, v9
    v_mad_u32_u24 v19, v6, s38, v9
    v_lshl_add_u32 v5, v2, 1, v3
    s_and_b32 s33, s7, 1
    s_lshl_b32 s34, s33, 3
    v_add_u32 v5, s34, v5
    v_xor_b32 v6, 1, v5
    s_movk_i32 s38, 3200
    v_mad_u32_u24 v20, v5, s38, v8
    v_mad_u32_u24 v21, v6, s38, v8
    v_mad_u32_u24 v22, v5, s38, v9
    v_mad_u32_u24 v23, v6, s38, v9
    s_mul_i32 s41, s3, 102400
    s_mul_i32 s34, s10, 51200
    s_add_u32 s41, s41, s34
    s_add_u32 s41, s41, 11534336
    s_mul_i32 s34, s33, 25600
    s_add_u32 s42, s41, s34
    s_add_u32 s42, s42, 20480
    s_mul_i32 s34, s7, 5120
    s_add_u32 s41, s41, s34
    s_and_b32 s34, s7, 2
    s_lshl_b32 s34, s34, 29
    v_lshlrev_b32 v24, 4, v0
    v_or_b32 v25, s34, v24
    ds_read_b64_tr_b16 v[40:41], v16 offset:0
    ds_read_b64_tr_b16 v[42:43], v17 offset:0
    ds_read_b64_tr_b16 v[44:45], v16 offset:8
    ds_read_b64_tr_b16 v[46:47], v17 offset:8
    ds_read_b64_tr_b16 v[48:49], v16 offset:64
    ds_read_b64_tr_b16 v[50:51], v17 offset:64
    ds_read_b64_tr_b16 v[52:53], v16 offset:72
    ds_read_b64_tr_b16 v[54:55], v17 offset:72
    ds_read_b64_tr_b16 v[56:57], v18 offset:0
    ds_read_b64_tr_b16 v[58:59], v19 offset:0
    s_waitcnt lgkmcnt(0)
    buffer_store_dwordx4 v[40:43], v24, s[24:27], s41 offen sc1
    s_add_u32 s41, s41, 1024
    buffer_store_dwordx4 v[44:47], v24, s[24:27], s41 offen sc1
    s_add_u32 s41, s41, 1024
    buffer_store_dwordx4 v[48:51], v24, s[24:27], s41 offen sc1
    s_add_u32 s41, s41, 1024
    buffer_store_dwordx4 v[52:55], v24, s[24:27], s41 offen sc1
    s_add_u32 s41, s41, 1024
    buffer_store_dwordx4 v[56:59], v24, s[24:27], s41 offen sc1
    s_add_u32 s41, s41, 21504
    ds_read_b64_tr_b16 v[60:61], v16 offset:25600
    ds_read_b64_tr_b16 v[62:63], v17 offset:25600
    ds_read_b64_tr_b16 v[64:65], v16 offset:25608
    ds_read_b64_tr_b16 v[66:67], v17 offset:25608
    ds_read_b64_tr_b16 v[68:69], v16 offset:25664
    ds_read_b64_tr_b16 v[70:71], v17 offset:25664
    ds_read_b64_tr_b16 v[72:73], v16 offset:25672
    ds_read_b64_tr_b16 v[74:75], v17 offset:25672
    ds_read_b64_tr_b16 v[76:77], v18 offset:25600
    ds_read_b64_tr_b16 v[78:79], v19 offset:25600
    s_waitcnt lgkmcnt(0)
    buffer_store_dwordx4 v[60:63], v24, s[24:27], s41 offen sc1
    s_add_u32 s41, s41, 1024
    buffer_store_dwordx4 v[64:67], v24, s[24:27], s41 offen sc1
    s_add_u32 s41, s41, 1024
    buffer_store_dwordx4 v[68:71], v24, s[24:27], s41 offen sc1
    s_add_u32 s41, s41, 1024
    buffer_store_dwordx4 v[72:75], v24, s[24:27], s41 offen sc1
    s_add_u32 s41, s41, 1024
    buffer_store_dwordx4 v[76:79], v24, s[24:27], s41 offen sc1
    s_add_u32 s41, s41, 21504
    ds_read_b64_tr_b16 v[80:81], v20 offset:2560
    ds_read_b64_tr_b16 v[82:83], v21 offset:2560
    ds_read_b64_tr_b16 v[84:85], v20 offset:2568
    ds_read_b64_tr_b16 v[86:87], v21 offset:2568
    ds_read_b64_tr_b16 v[88:89], v20 offset:2624
    ds_read_b64_tr_b16 v[90:91], v21 offset:2624
    ds_read_b64_tr_b16 v[92:93], v20 offset:2632
    ds_read_b64_tr_b16 v[94:95], v21 offset:2632
    ds_read_b64_tr_b16 v[96:97], v22 offset:2560
    ds_read_b64_tr_b16 v[98:99], v23 offset:2560
    s_waitcnt lgkmcnt(0)
    buffer_store_dwordx4 v[80:83], v25, s[24:27], s42 offen sc1
    s_add_u32 s42, s42, 1024
    buffer_store_dwordx4 v[84:87], v25, s[24:27], s42 offen sc1
    s_add_u32 s42, s42, 1024
    buffer_store_dwordx4 v[88:91], v25, s[24:27], s42 offen sc1
    s_add_u32 s42, s42, 1024
    buffer_store_dwordx4 v[92:95], v25, s[24:27], s42 offen sc1
    s_add_u32 s42, s42, 1024
    buffer_store_dwordx4 v[96:99], v25, s[24:27], s42 offen sc1
    s_add_u32 s42, s42, 21504
    s_barrier
    s_andn2_b32 s62, s5, 24
    s_lshl_b32 s62, s62, 9
    s_lshr_b32 s63, s4, 3
    s_lshl_b32 s63, s63, 2
    s_add_u32 s62, s62, s63
    s_add_u32 s62, s62, 12583296
    s_lshl_b32 s63, s7, 30
    v_mov_b32 v214, s96
    v_mov_b32 v207, s63
    s_mov_b64 exec, 1
    buffer_store_dword v214, v207, s[24:27], s62 offen sc1
    s_mov_b64 exec, -1
    v_mov_b32 v20, 0x3f80
    v_mov_b32 v21, 0
    v_mov_b32 v22, v20
    v_mov_b32 v23, v21
    s_mul_i32 s48, s7, 576
    v_lshl_add_u32 v16, v0, 4, s48
    s_mov_b32 exec_hi, 0xf
    ds_write_b128 v16, v[20:23] offset:41120
    s_mov_b64 exec, -1
    v_mov_b32 v24, 0
    v_mov_b32 v25, 0
    v_mov_b32 v17, 59808
    ds_write_b64 v17, v[24:25]
    v_lshlrev_b32 v17, 3, v0
    v_add_u32 v17, 162816, v17
    ds_write_b64 v17, v[24:25]
    s_sub_u32 s48, s3, 1
    s_cselect_b32 s48, 0, s48
    s_cmp_lt_u32 s7, 2
    s_cselect_b32 s48, s48, s3
    s_and_b32 s49, s7, 1
    s_lshl_b32 s60, s48, 11
    s_lshl_b32 s51, s49, 10
    s_add_u32 s60, s60, s51
    s_mul_i32 s51, s4, 83200
    s_add_u32 s60, s60, s51
    s_add_u32 s61, s60, 5324800
    s_add_u32 s60, s60, 2662400
    s_lshr_b32 s51, s4, 4
    s_xor_b32 s58, s48, s51
    s_and_b32 s58, s58, 1
    s_xor_b32 s48, s48, s58
    s_lshl_b32 s48, s48, 5
    s_add_u32 s48, s48, s49
    s_mul_i32 s49, s58, 20
    s_add_u32 s48, s48, s49
    s_mul_i32 s48, s48, 512
    s_add_u32 s48, s48, 12582912
    s_and_b32 s49, s4, 15
    s_mul_i32 s49, s49, 5
    s_lshr_b32 s56, s49, 4
    s_add_u32 s49, s49, 4
    s_lshr_b32 s57, s49, 4
    s_mul_i32 s56, s56, 1024
    s_mul_i32 s57, s57, 1024
    s_add_u32 s56, s56, s48
    s_add_u32 s57, s57, s48
    v_and_b32 v14, 4, v0
    v_cmp_eq_u32 vcc, 0, v14
    v_mov_b32 v14, s56
    v_mov_b32 v15, s57
    v_cndmask_b32 v15, v15, v14, vcc
    v_and_b32 v14, 3, v0
    v_lshl_add_u32 v14, v14, 2, v15
    v_add_u32 v15, 0x80, v14
    s_cmp_eq_u32 s58, 0
    s_cselect_b32 s49, 640, 0
    v_and_b32 v12, 8, v0
    v_mad_u32_u24 v14, v12, s49, v14
    s_mul_i32 s48, s3, 16384
    s_add_u32 s48, s48, 12587776
    v_and_b32 v13, 31, v0
    v_lshl_add_u32 v13, v13, 2, s48
    s_mul_i32 s48, s4, 5
    s_lshr_b32 s20, s48, 4
    s_add_u32 s48, s48, 4
    s_lshr_b32 s21, s48, 4
    s_mul_i32 s20, s20, 4096
    s_mul_i32 s21, s21, 4096
    s_lshl_b32 s48, s3, 5
    s_lshr_b32 s49, s6, 2
    s_add_u32 s48, s48, s49
    s_mul_i32 s48, s48, 2048
    s_lshl_b32 s49, s7, 9
    s_add_u32 s48, s48, s49
    s_add_u32 s48, s48, 12845056
    s_add_u32 s20, s20, s48
    s_add_u32 s21, s21, s48
    s_lshl_b32 s48, s3, 5
    s_add_u32 s48, s48, s6
    s_lshl_b32 s12, s48, 9
    s_lshl_b32 s49, s4, 2
    s_add_u32 s12, s12, s49
    s_add_u32 s12, s12, 12583168
    s_sub_u32 s13, 8, s6
    s_cmp_eq_u32 s3, 0
    s_cselect_b32 s13, s13, 0
    s_movk_i32 s14, 16640
    v_lshlrev_b32 v208, 4, v0
    v_add_u32 v209, 158208, v208
    ds_read_b128 v[240:243], v209 offset:0
    ds_read_b128 v[244:247], v209 offset:1024
    ds_read_b128 v[248:251], v209 offset:2048
    ds_read_b96 v[252:254], v209 offset:3072
    v_cmp_gt_u32 vcc, 32, v0
    v_mov_b32 v210, 0x3f803f80
    s_mul_i32 s49, s4, 83200
    v_cndmask_b32 v230, 0, v210, vcc
    s_lshl_b32 s51, s3, 11
    v_lshrrev_b32 v231, 16, v230
    s_add_u32 s49, s49, s51
    v_mov_b32 v238, v230
    s_lshl_b32 s48, s6, 8
    v_mov_b32 v239, v231
    s_add_u32 s49, s49, s48
    v_mov_b32 v222, s20
    v_writelane_b32 v222, s21, 1
    s_waitcnt lgkmcnt(0)
    v_add_u32 v248, s48, v248
    v_add_u32 v249, s48, v249
    v_mad_u32_u24 v250, v253, s6, v250
    v_add_u32 v251, s49, v251
    v_add_u32 v252, s49, v252
    v_add_u32 v254, s49, v254
    v_mov_b32 v253, v208
    s_sub_u32 s100, 31, s4
    s_cmp_ge_u32 s100, 10
    s_cselect_b32 s101, 8, 0
    s_cselect_b32 s48, 10, 0
    s_sub_u32 s100, s100, s48
    s_cmp_ge_u32 s100, 10
    s_cselect_b32 s100, 11, s100
    s_add_u32 s101, s101, s3
    v_and_b32 v11, 7, v0
    v_lshlrev_b32 v10, 4, v11
    v_and_b32 v11, 31, v0
    s_cmp_ge_u32 s100, 5
    s_cselect_b32 s48, 1, 0
    s_lshl_b32 s49, s7, 1
    s_add_u32 s48, s48, s49
    s_lshl_b32 s48, s48, 9
    s_add_u32 s48, s48, 12583296
    v_and_b32 v16, 3, v0
    v_and_b32 v11, 28, v0
    v_lshl_add_u32 v11, v11, 12, s48
    v_lshl_add_u32 v11, v16, 2, v11
    s_cmp_eq_u32 s100, 0
    s_cselect_b32 s48, 32, 0
    s_cmp_eq_u32 s100, 5
    s_cselect_b32 s48, 32, s48
    v_and_b32 v16, s48, v0
    v_lshlrev_b32 v16, 4, v16
    v_xor_b32 v11, v16, v11
    s_lshr_b32 s48, s4, 2
    s_lshl_b32 s48, s48, 14
    s_add_u32 s48, s48, 12588288
    v_writelane_b32 v14, s48, 32
    s_nop 0
    s_add_u32 s48, s48, 4
    v_writelane_b32 v14, s48, 33
    v_lshrrev_b32 v12, 5, v0
    v_bfe_u32 v16, v0, 3, 1
    v_lshl_add_u32 v16, v12, 1, v16
    v_bfe_u32 v17, v0, 4, 1
    v_lshl_add_u32 v16, v16, 1, v17
    s_movk_i32 s48, 5632
    v_mad_u32_u24 v10, v16, s48, v10
    s_lshl_b32 s98, s101, 7
    s_add_u32 s98, s98, s7
    s_mul_i32 s98, s98, 1408
    s_lshl_b32 s48, s100, 7
    s_add_u32 s98, s98, s48
    s_add_u32 s98, s98, 7987200
    s_movk_i32 s48, 5632
    v_mul_u32_u24 v204, s48, v0
    s_cmp_eq_u32 s100, 11
    s_cselect_b32 s49, 2.0, 0
    v_or_b32 v10, s49, v10
    v_or_b32 v204, s49, v204
    v_lshlrev_b32 v205, 4, v12
    v_add_u32 v205, 162304, v205
    v_bfe_u32 v17, v0, 4, 1
    v_mul_u32_u24 v17, 20, v17
    v_and_b32 v16, 31, v0
    v_xor_b32 v16, v16, v17
    v_min_u32 v16, 1, v16
    v_lshl_add_u32 v205, v16, 9, v205
    s_lshl_b32 s48, s6, 8
    v_subrev_u32 v206, s48, v249
    v_lshrrev_b32 v206, 1, v206
    v_lshl_add_u32 v206, v12, 9, v206
    v_add_u32 v206, 35232, v206
    s_lshl_b32 s48, s7, 9
    s_add_u32 s48, s48, s101
    v_and_b32 v16, 15, v0
    v_lshl_add_u32 v17, v16, 4, s48
    s_movk_i32 s48, 2560
    v_bfe_u32 v18, v0, 4, 1
    v_lshlrev_b32 v18, 5, v18
    v_lshl_add_u32 v18, v12, 4, v18
    s_lshl_b32 s51, s100, 6
    v_add_u32 v18, s51, v18
    v_mad_u32_u24 v200, v17, s48, v18
    v_add_u32 v201, 655360, v200
    v_sub_u32 v18, 1264, v18
    v_sub_u32 v16, 2048, v17
    v_and_b32 v16, 2047, v16
    v_mad_u32_u24 v202, v16, s48, v18
    v_sub_u32 v16, 1792, v17
    v_mad_u32_u24 v203, v16, s48, v18
    v_or_b32 v200, s49, v200
    v_or_b32 v201, s49, v201
    v_or_b32 v202, s49, v202
    v_or_b32 v203, s49, v203
    ds_read_b128 v[104:107], v253 offset:43424
    ds_read_b128 v[108:111], v253 offset:44448
    ds_read_b128 v[112:115], v253 offset:45472
    ds_read_b128 v[116:119], v253 offset:46496
    ds_read_b128 v[120:123], v253 offset:47520
    ds_read_b128 v[124:127], v253 offset:48544
    ds_read_b128 v[128:131], v253 offset:49568
    ds_read_b128 v[132:135], v253 offset:50592
    ds_read_b128 v[136:139], v253 offset:51616
    ds_read_b128 v[140:143], v253 offset:52640
    ds_read_b128 v[144:147], v253 offset:53664
    ds_read_b128 v[148:151], v253 offset:54688
    ds_read_b128 v[152:155], v253 offset:55712
    ds_read_b128 v[156:159], v253 offset:56736
    ds_read_b128 v[160:163], v253 offset:57760
    ds_read_b128 v[164:167], v253 offset:58784
    s_and_b32 s8, s7, 1
    s_mul_i32 s9, s8, 0x80008000
    s_lshl_b32 s8, s8, 4
    s_add_u32 s15, s7, 1
    s_lshl_b32 s15, s15, 30
    s_and_b32 s15, s15, 0x80000000
    s_and_b32 s99, s7, 2
    s_lshl_b32 s99, s99, 14
    s_or_b32 s15, s15, s99
    s_xor_b32 s99, s15, s9
    s_waitcnt lgkmcnt(0)
    s_waitcnt vmcnt(0)
    s_barrier
    s_lshl_b32 s48, s3, 14
    s_lshl_b32 s49, s10, 2
    s_add_u32 s48, s48, s49
    s_add_u32 s48, s48, 12588288
    s_lshl_b32 s49, s7, 30
    v_mov_b32 v16, s96
    v_mov_b32 v17, s49
    s_mov_b64 exec, 1
    buffer_store_dword v16, v17, s[24:27], s48 offen sc1
    s_mov_b64 exec, -1
    buffer_load_dword v36, v11, s[24:27], 0 offen sc1
    s_mov_b32 s50, 200000
    s_waitcnt vmcnt(0)
    s_branch SC_12
SP_11:
    buffer_load_dword v36, v11, s[24:27], 0 offen sc1
    s_waitcnt vmcnt(0)
SC_12:
    v_cmp_ne_u32 vcc, s96, v36
    s_sub_u32 s50, s50, 1
    s_cbranch_scc1 SD_13
    s_cbranch_vccnz SP_11
SD_13:
    s_cmp_eq_u32 s100, 0
    s_cselect_b32 s49, 0x500, -4
    s_add_u32 s49, s49, s98
    s_lshl_b32 s48, s7, 7
    s_add_u32 m0, s48, 162304
    s_mov_b32 exec_hi, 0
    buffer_load_dword v204, s[24:27], s49 offen sc1 lds
    s_mov_b64 exec, -1
    s_lshl_b32 s48, s7, 12
    s_add_u32 m0, s48, 43424
    s_nop 0
    buffer_load_dwordx4 v10, s[24:27], s98 offen sc1 lds
    s_add_u32 s98, s98, 45056
    s_add_u32 m0, s48, 44448
    s_nop 0
    buffer_load_dwordx4 v10, s[24:27], s98 offen sc1 lds
    s_add_u32 s98, s98, 45056
    s_add_u32 m0, s48, 45472
    s_nop 0
    buffer_load_dwordx4 v10, s[24:27], s98 offen sc1 lds
    s_add_u32 s98, s98, 45056
    s_add_u32 m0, s48, 46496
    s_nop 0
    buffer_load_dwordx4 v10, s[24:27], s98 offen sc1 lds
    buffer_load_dword v209, v14, s[24:27], 0 offen sc1
    s_waitcnt vmcnt(0)
    v_mov_b32 v16, 59808
    v_mov_b32 v17, 1
    s_mov_b64 exec, 1
    ds_add_u32 v16, v17 offset:4
    s_mov_b64 exec, -1
    s_mov_b32 s50, 200000
GW_14:
    ds_read_b32 v17, v16 offset:4
    s_sub_u32 s50, s50, 1
    s_waitcnt lgkmcnt(0)
    v_cmp_ne_u32 vcc, 4, v17
    s_cbranch_scc1 GD_15
    s_cbranch_vccnz GW_14
GD_15:
L_KV:
    s_setprio 0
    s_cmp_eq_u32 s58, 0
    s_cselect_b32 s62, 5120, 0
    s_add_u32 s63, s62, s57
    s_add_u32 s62, s62, s56
    s_cmp_eq_u32 s100, 11
    s_cbranch_scc1 NA2_16
    v_add_u32 v207, 128, v206
    ds_read2st64_b32 v[32:33], v206 offset0:0 offset1:1
    ds_read2st64_b32 v[34:35], v207 offset0:0 offset1:1
    ds_read_b128 v[80:83], v205 offset:0
    ds_read2st64_b32 v[36:37], v206 offset0:4 offset1:5
    ds_read2st64_b32 v[38:39], v207 offset0:4 offset1:5
    ds_read_b128 v[84:87], v205 offset:32
    ds_read2st64_b32 v[40:41], v206 offset0:8 offset1:9
    ds_read2st64_b32 v[42:43], v207 offset0:8 offset1:9
    ds_read_b128 v[88:91], v205 offset:64
    s_waitcnt lgkmcnt(7)
    v_mfma_f32_32x32x16_bf16 v[168:183], v[32:35], v[104:107], 0
    ds_read2st64_b32 v[44:45], v206 offset0:12 offset1:13
    ds_read2st64_b32 v[46:47], v207 offset0:12 offset1:13
    v_alignbit_b32 v120, v120, v120, s8
    v_alignbit_b32 v121, v121, v121, s8
    v_alignbit_b32 v122, v122, v122, s8
    v_alignbit_b32 v123, v123, v123, s8
    s_waitcnt lgkmcnt(8)
    v_mfma_f32_16x16x32_bf16 v[16:19], v[80:83], v[104:107], 0
    ds_read_b128 v[92:95], v205 offset:96
    v_xor_b32 v120, s15, v120
    v_xor_b32 v121, s15, v121
    v_xor_b32 v122, s15, v122
    v_xor_b32 v123, s15, v123
NA2_16:
    s_mov_b32 s50, 200000
    s_waitcnt vmcnt(0)
    s_branch SC_18
SP_17:
    buffer_load_dword v209, v14, s[24:27], 0 offen sc1
    s_waitcnt vmcnt(0)
SC_18:
    v_cmp_ne_u32 vcc, s96, v209
    s_sub_u32 s50, s50, 1
    s_cbranch_scc1 SD_19
    s_cbranch_vccnz SP_17
SD_19:
    s_lshl_b32 s48, s7, 10
    s_add_u32 m0, s48, 0
    s_nop 0
    buffer_load_dwordx4 v253, s[24:27], s60 offen sc1 lds
    s_add_u32 s60, s60, 16640
    s_add_u32 m0, s48, 4096
    s_nop 0
    buffer_load_dwordx4 v253, s[24:27], s60 offen sc1 lds
    s_add_u32 s60, s60, 16640
    s_add_u32 m0, s48, 8192
    s_nop 0
    buffer_load_dwordx4 v253, s[24:27], s60 offen sc1 lds
    s_add_u32 s60, s60, 16640
    s_add_u32 m0, s48, 12288
    s_nop 0
    buffer_load_dwordx4 v253, s[24:27], s60 offen sc1 lds
    s_add_u32 s60, s60, 16640
    s_add_u32 m0, s48, 16384
    s_nop 0
    buffer_load_dwordx4 v253, s[24:27], s60 offen sc1 lds
    s_setprio 0
    s_waitcnt vmcnt(5)
    s_cmp_eq_u32 s100, 11
    s_cbranch_scc1 NA2_20
    s_waitcnt lgkmcnt(7)
    v_mfma_f32_32x32x16_bf16 v[168:183], v[36:39], v[108:111], v[168:183]
    ds_read2st64_b32 v[32:33], v206 offset0:16 offset1:17
    ds_read2st64_b32 v[34:35], v207 offset0:16 offset1:17
    v_alignbit_b32 v124, v124, v124, s8
    v_alignbit_b32 v125, v125, v125, s8
    v_alignbit_b32 v126, v126, v126, s8
    v_alignbit_b32 v127, v127, v127, s8
    s_waitcnt lgkmcnt(8)
    v_mfma_f32_16x16x32_bf16 v[16:19], v[84:87], v[108:111], v[16:19]
    ds_read_b128 v[80:83], v205 offset:128
    v_xor_b32 v124, s15, v124
    v_xor_b32 v125, s15, v125
    v_xor_b32 v126, s15, v126
    v_xor_b32 v127, s15, v127
    s_waitcnt lgkmcnt(7)
    v_mfma_f32_32x32x16_bf16 v[168:183], v[40:43], v[112:115], v[168:183]
    ds_read2st64_b32 v[36:37], v206 offset0:20 offset1:21
    ds_read2st64_b32 v[38:39], v207 offset0:20 offset1:21
    v_alignbit_b32 v128, v128, v128, s8
    v_alignbit_b32 v129, v129, v129, s8
    v_alignbit_b32 v130, v130, v130, s8
    v_alignbit_b32 v131, v131, v131, s8
    s_waitcnt lgkmcnt(8)
    v_mfma_f32_16x16x32_bf16 v[16:19], v[88:91], v[112:115], v[16:19]
    ds_read_b128 v[84:87], v205 offset:160
    v_xor_b32 v128, s15, v128
    v_xor_b32 v129, s15, v129
    v_xor_b32 v130, s15, v130
    v_xor_b32 v131, s15, v131
    s_waitcnt lgkmcnt(7)
    v_mfma_f32_32x32x16_bf16 v[168:183], v[44:47], v[116:119], v[168:183]
    ds_read2st64_b32 v[40:41], v206 offset0:24 offset1:25
    ds_read2st64_b32 v[42:43], v207 offset0:24 offset1:25
    v_alignbit_b32 v132, v132, v132, s8
    v_alignbit_b32 v133, v133, v133, s8
    v_alignbit_b32 v134, v134, v134, s8
    v_alignbit_b32 v135, v135, v135, s8
    s_waitcnt lgkmcnt(8)
    v_mfma_f32_16x16x32_bf16 v[16:19], v[92:95], v[116:119], v[16:19]
    ds_read_b128 v[88:91], v205 offset:192
    v_xor_b32 v132, s15, v132
    v_xor_b32 v133, s15, v133
    v_xor_b32 v134, s15, v134
    v_xor_b32 v135, s15, v135
    s_waitcnt lgkmcnt(7)
    v_mfma_f32_32x32x16_bf16 v[168:183], v[32:35], v[120:123], v[168:183]
    ds_read2st64_b32 v[44:45], v206 offset0:28 offset1:29
    ds_read2st64_b32 v[46:47], v207 offset0:28 offset1:29
    v_xor_b32 v136, s9, v136
    v_xor_b32 v137, s9, v137
    v_xor_b32 v138, s9, v138
    v_xor_b32 v139, s9, v139
    s_waitcnt lgkmcnt(8)
    v_mfma_f32_16x16x32_bf16 v[16:19], v[80:83], v[120:123], v[16:19]
    ds_read_b128 v[92:95], v205 offset:224
    s_waitcnt lgkmcnt(7)
    v_mfma_f32_32x32x16_bf16 v[168:183], v[36:39], v[124:127], v[168:183]
    ds_read2st64_b32 v[32:33], v206 offset0:32 offset1:33
    ds_read2st64_b32 v[34:35], v207 offset0:32 offset1:33
    v_xor_b32 v140, s9, v140
    v_xor_b32 v141, s9, v141
    v_xor_b32 v142, s9, v142
    v_xor_b32 v143, s9, v143
    s_waitcnt lgkmcnt(8)
    v_mfma_f32_16x16x32_bf16 v[16:19], v[84:87], v[124:127], v[16:19]
    ds_read_b128 v[80:83], v205 offset:256
    s_waitcnt lgkmcnt(7)
    v_mfma_f32_32x32x16_bf16 v[168:183], v[40:43], v[128:131], v[168:183]
    ds_read2st64_b32 v[36:37], v206 offset0:36 offset1:37
    ds_read2st64_b32 v[38:39], v207 offset0:36 offset1:37
    v_xor_b32 v144, s9, v144
    v_xor_b32 v145, s9, v145
    v_xor_b32 v146, s9, v146
    v_xor_b32 v147, s9, v147
    s_waitcnt lgkmcnt(8)
    v_mfma_f32_16x16x32_bf16 v[16:19], v[88:91], v[128:131], v[16:19]
    ds_read_b128 v[84:87], v205 offset:288
    s_waitcnt lgkmcnt(7)
    v_mfma_f32_32x32x16_bf16 v[168:183], v[44:47], v[132:135], v[168:183]
    ds_read2st64_b32 v[40:41], v206 offset0:40 offset1:41
    ds_read2st64_b32 v[42:43], v207 offset0:40 offset1:41
    v_xor_b32 v148, s9, v148
    v_xor_b32 v149, s9, v149
    v_xor_b32 v150, s9, v150
    v_xor_b32 v151, s9, v151
    s_waitcnt lgkmcnt(8)
    v_mfma_f32_16x16x32_bf16 v[16:19], v[92:95], v[132:135], v[16:19]
    ds_read_b128 v[88:91], v205 offset:320
NA2_20:
    s_nop 0
    s_cmp_eq_u32 s100, 11
    s_cbranch_scc1 NA2_21
    s_waitcnt lgkmcnt(7)
    v_mfma_f32_32x32x16_bf16 v[168:183], v[32:35], v[136:139], v[168:183]
    ds_read2st64_b32 v[44:45], v206 offset0:44 offset1:45
    ds_read2st64_b32 v[46:47], v207 offset0:44 offset1:45
    v_alignbit_b32 v152, v152, v152, s8
    v_alignbit_b32 v153, v153, v153, s8
    v_alignbit_b32 v154, v154, v154, s8
    v_alignbit_b32 v155, v155, v155, s8
    s_waitcnt lgkmcnt(8)
    v_mfma_f32_16x16x32_bf16 v[16:19], v[80:83], v[136:139], v[16:19]
    ds_read_b128 v[92:95], v205 offset:352
    v_xor_b32 v152, s99, v152
    v_xor_b32 v153, s99, v153
    v_xor_b32 v154, s99, v154
    v_xor_b32 v155, s99, v155
    s_waitcnt lgkmcnt(7)
    v_mfma_f32_32x32x16_bf16 v[168:183], v[36:39], v[140:143], v[168:183]
    ds_read2st64_b32 v[32:33], v206 offset0:48 offset1:49
    ds_read2st64_b32 v[34:35], v207 offset0:48 offset1:49
    v_alignbit_b32 v156, v156, v156, s8
    v_alignbit_b32 v157, v157, v157, s8
    v_alignbit_b32 v158, v158, v158, s8
    v_alignbit_b32 v159, v159, v159, s8
    s_waitcnt lgkmcnt(8)
    v_mfma_f32_16x16x32_bf16 v[16:19], v[84:87], v[140:143], v[16:19]
    ds_read_b128 v[80:83], v205 offset:384
    v_xor_b32 v156, s99, v156
    v_xor_b32 v157, s99, v157
    v_xor_b32 v158, s99, v158
    v_xor_b32 v159, s99, v159
    s_waitcnt lgkmcnt(7)
    v_mfma_f32_32x32x16_bf16 v[168:183], v[40:43], v[144:147], v[168:183]
    ds_read2st64_b32 v[36:37], v206 offset0:52 offset1:53
    ds_read2st64_b32 v[38:39], v207 offset0:52 offset1:53
    v_alignbit_b32 v160, v160, v160, s8
    v_alignbit_b32 v161, v161, v161, s8
    v_alignbit_b32 v162, v162, v162, s8
    v_alignbit_b32 v163, v163, v163, s8
    s_waitcnt lgkmcnt(8)
    v_mfma_f32_16x16x32_bf16 v[16:19], v[88:91], v[144:147], v[16:19]
    ds_read_b128 v[84:87], v205 offset:416
    v_xor_b32 v160, s99, v160
    v_xor_b32 v161, s99, v161
    v_xor_b32 v162, s99, v162
    v_xor_b32 v163, s99, v163
NA2_21:
    s_mov_b32 s35, 7
RP_22:
    s_load_dword s36, s[22:23], s20
    s_load_dword s37, s[22:23], s21
    s_add_u32 s20, s20, 64
    s_add_u32 s21, s21, 64
    s_waitcnt lgkmcnt(0)
    s_xor_b32 s36, s36, s96
    s_xor_b32 s37, s37, s96
    s_or_b32 s36, s36, s37
    s_cbranch_scc0 RD_23
    s_sub_u32 s35, s35, 1
    s_cbranch_scc0 RP_22
    s_mov_b32 s50, 200000
SP_24:
    buffer_load_dword v223, v222, s[24:27], 0 offen sc1
    s_waitcnt vmcnt(0)
SC_25:
    v_cmp_ne_u32 vcc, s96, v223
    s_sub_u32 s50, s50, 1
    s_cbranch_scc1 SD_26
    s_cbranch_vccnz SP_24
SD_26:
RD_23:
    buffer_load_dwordx4 v[216:219], v251, s[24:27], 0 offen sc1
    buffer_load_dwordx2 v[220:221], v254, s[24:27], 0 offen sc1
    s_cmp_eq_u32 s100, 11
    s_cbranch_scc1 NA2_27
    s_waitcnt lgkmcnt(7)
    v_mfma_f32_32x32x16_bf16 v[168:183], v[44:47], v[148:151], v[168:183]
    ds_read2st64_b32 v[40:41], v206 offset0:56 offset1:57
    ds_read2st64_b32 v[42:43], v207 offset0:56 offset1:57
    v_alignbit_b32 v164, v164, v164, s8
    v_alignbit_b32 v165, v165, v165, s8
    v_alignbit_b32 v166, v166, v166, s8
    v_alignbit_b32 v167, v167, v167, s8
    s_waitcnt lgkmcnt(8)
    v_mfma_f32_16x16x32_bf16 v[16:19], v[92:95], v[148:151], v[16:19]
    ds_read_b128 v[88:91], v205 offset:448
    v_xor_b32 v164, s99, v164
    v_xor_b32 v165, s99, v165
    v_xor_b32 v166, s99, v166
    v_xor_b32 v167, s99, v167
    s_waitcnt lgkmcnt(7)
    v_mfma_f32_32x32x16_bf16 v[168:183], v[32:35], v[152:155], v[168:183]
    ds_read2st64_b32 v[44:45], v206 offset0:60 offset1:61
    ds_read2st64_b32 v[46:47], v207 offset0:60 offset1:61
    s_waitcnt lgkmcnt(8)
    v_mfma_f32_16x16x32_bf16 v[16:19], v[80:83], v[152:155], v[16:19]
    ds_read_b128 v[92:95], v205 offset:480
    s_waitcnt lgkmcnt(7)
    v_mfma_f32_32x32x16_bf16 v[168:183], v[36:39], v[156:159], v[168:183]
    s_waitcnt lgkmcnt(6)
    v_mfma_f32_16x16x32_bf16 v[16:19], v[84:87], v[156:159], v[16:19]
    s_waitcnt lgkmcnt(4)
    v_mfma_f32_32x32x16_bf16 v[168:183], v[40:43], v[160:163], v[168:183]
    s_waitcnt lgkmcnt(3)
    v_mfma_f32_16x16x32_bf16 v[16:19], v[88:91], v[160:163], v[16:19]
    s_waitcnt lgkmcnt(1)
    v_mfma_f32_32x32x16_bf16 v[168:183], v[44:47], v[164:167], v[168:183]
    s_waitcnt lgkmcnt(0)
    v_mfma_f32_16x16x32_bf16 v[16:19], v[92:95], v[164:167], v[16:19]
    s_nop 9
    v_cvt_pk_bf16_f32 v192, v175, v174
    v_cvt_pk_bf16_f32 v193, v173, v172
    v_cvt_pk_bf16_f32 v194, v171, v170
    v_cvt_pk_bf16_f32 v195, v169, v168
    v_cvt_pk_bf16_f32 v196, v183, v182
    v_cvt_pk_bf16_f32 v197, v181, v180
    v_cvt_pk_bf16_f32 v198, v179, v178
    v_cvt_pk_bf16_f32 v199, v177, v176
    v_cvt_pk_bf16_f32 v185, v169, v170
    v_cvt_pk_bf16_f32 v186, v171, v172
    v_cvt_pk_bf16_f32 v187, v173, v174
    v_cvt_pk_bf16_f32 v189, v177, v178
    v_cvt_pk_bf16_f32 v190, v179, v180
    v_cvt_pk_bf16_f32 v191, v181, v182
    v_mov_b32 v32, v175
    v_permlane32_swap_b32 v16, v175
    s_nop 0
    v_permlane32_swap_b32 v32, v183
    s_mov_b32 exec_hi, 0
    v_mov_b32 v32, v183
    s_mov_b64 exec, -1
    v_permlane16_swap_b32 v192, v196
    v_permlane16_swap_b32 v193, v197
    v_permlane16_swap_b32 v194, v198
    v_permlane16_swap_b32 v195, v199
    v_cvt_pk_bf16_f32 v184, v16, v168
    v_cvt_pk_bf16_f32 v188, v32, v176
    v_permlane16_swap_b32 v185, v189
    v_permlane16_swap_b32 v186, v190
    v_permlane16_swap_b32 v187, v191
    v_permlane16_swap_b32 v184, v188
NA2_27:
    v_mov_b32 v222, 0
    v_mov_b32 v223, 0
    s_cmp_ge_u32 s4, 30
    s_cbranch_scc1 SPUBL
SPUBRL:
    s_waitcnt vmcnt(0)
    s_barrier
    s_setprio 3
    ds_read_b64 v[224:225], v248 offset:2048
    ds_read_b64 v[226:227], v248 offset:6144
    ds_read_b64 v[228:229], v249 offset:2048
    ds_read_b64 v[232:233], v248 offset:0
    ds_read_b64 v[234:235], v248 offset:4096
    ds_read_b64 v[236:237], v249 offset:0
    v_permlane16_swap_b32 v216, v218
    v_permlane16_swap_b32 v217, v219
    s_cmp_eq_u32 s58, 0
    s_cbranch_scc1 V_EARLY
    buffer_load_dword v14, v15, s[24:27], 0 offen sc1
V_EARLY_RET:
    s_waitcnt lgkmcnt(4)
    v_mfma_f32_32x32x16_bf16 v[48:63], v[224:227], v[216:219], 0
    s_waitcnt lgkmcnt(3)
    v_mfma_f32_32x32x16_bf16 v[48:63], v[228:231], v[220:223], v[48:63]
    s_cmp_gt_u32 s13, 0
    s_cselect_b32 s51, 0xff00, 0
    v_mov_b32 v223, s51
    s_waitcnt lgkmcnt(1)
    v_mfma_f32_32x32x16_bf16 v[64:79], v[232:235], v[216:219], 0
    s_waitcnt lgkmcnt(0)
    v_mfma_f32_32x32x16_bf16 v[64:79], v[236:239], v[220:223], v[64:79]
    s_cmp_gt_u32 s13, 7
    s_cselect_b32 s51, 0xff00, 0
    v_mov_b32 v223, s51
    ds_read_b64 v[224:225], v248 offset:1792
    ds_read_b64 v[226:227], v248 offset:5888
    ds_read_b64 v[228:229], v249 offset:1792
    ds_read_b64 v[232:233], v248 offset:1536
    ds_read_b64 v[234:235], v248 offset:5632
    ds_read_b64 v[236:237], v249 offset:1536
    buffer_store_dwordx4 v[192:195], v202, s[28:31], 0 offen nt
    s_cmp_eq_u32 s3, 0
    s_nop 0
    v_cndmask_b32 v48, v64, v48, s[64:65]
    v_cndmask_b32 v49, v65, v49, s[66:67]
    v_cndmask_b32 v50, v66, v50, s[68:69]
    v_cndmask_b32 v51, v67, v51, s[70:71]
    v_cndmask_b32 v52, v68, v52, s[72:73]
    v_cndmask_b32 v53, v69, v53, s[74:75]
    v_cndmask_b32 v54, v70, v54, s[76:77]
    v_cndmask_b32 v55, v71, v55, s[78:79]
    v_cndmask_b32 v56, v72, v56, s[80:81]
    v_cndmask_b32 v57, v73, v57, s[82:83]
    v_cndmask_b32 v58, v74, v58, s[84:85]
    v_cndmask_b32 v59, v75, v59, s[86:87]
    v_cndmask_b32 v60, v76, v60, s[88:89]
    v_cndmask_b32 v61, v77, v61, s[90:91]
    v_cndmask_b32 v62, v78, v62, s[92:93]
    v_cndmask_b32 v63, v79, v63, s[94:95]
    v_max3_f32 v96, v48, v49, v50
    v_max3_f32 v97, v51, v52, v53
    v_max3_f32 v96, v96, v54, v55
    v_max3_f32 v97, v97, v56, v57
    v_max3_f32 v96, v96, v58, v59
    v_max3_f32 v97, v97, v60, v61
    v_max3_f32 v96, v96, v62, v63
    v_max_f32 v96, v96, v97
    s_cbranch_scc1 G0MAXL
G0RETL:
    v_mov_b32 v97, v96
    s_nop 1
    v_permlane32_swap_b32 v96, v97
    v_max_f32 v96, v96, v97
    v_sub_f32 v96, 0xc2000000, v96
    v_and_b32 v96, 0xffff0000, v96
    v_lshrrev_b32 v222, 16, v96
    s_waitcnt lgkmcnt(4)
    v_mfma_f32_32x32x16_bf16 v[64:79], v[224:227], v[216:219], 0
    v_pk_add_f32 v[48:49], v[48:49], v[96:97] op_sel_hi:[1,0]
    v_pk_add_f32 v[50:51], v[50:51], v[96:97] op_sel_hi:[1,0]
    v_pk_add_f32 v[52:53], v[52:53], v[96:97] op_sel_hi:[1,0]
    v_pk_add_f32 v[54:55], v[54:55], v[96:97] op_sel_hi:[1,0]
    v_pk_add_f32 v[56:57], v[56:57], v[96:97] op_sel_hi:[1,0]
    v_pk_add_f32 v[58:59], v[58:59], v[96:97] op_sel_hi:[1,0]
    v_pk_add_f32 v[60:61], v[60:61], v[96:97] op_sel_hi:[1,0]
    v_pk_add_f32 v[62:63], v[62:63], v[96:97] op_sel_hi:[1,0]
    s_waitcnt lgkmcnt(3)
    v_mfma_f32_32x32x16_bf16 v[64:79], v[228:231], v[220:223], v[64:79]
    ds_read_b64 v[224:225], v248 offset:1280
    ds_read_b64 v[226:227], v248 offset:5376
    ds_read_b64 v[228:229], v249 offset:1280
    s_cmp_eq_u32 s58, 0
    s_cbranch_scc0 V_LATE
V_LATE_RET:
    v_exp_f32 v48, v48
    v_exp_f32 v49, v49
    v_exp_f32 v50, v50
    v_exp_f32 v51, v51
    v_exp_f32 v52, v52
    v_exp_f32 v53, v53
    v_exp_f32 v54, v54
    v_exp_f32 v55, v55
    v_exp_f32 v56, v56
    v_exp_f32 v57, v57
    v_exp_f32 v58, v58
    v_exp_f32 v59, v59
    v_exp_f32 v60, v60
    v_exp_f32 v61, v61
    v_exp_f32 v62, v62
    v_exp_f32 v63, v63
    v_cvt_pk_bf16_f32 v108, v48, v49
    v_cvt_pk_bf16_f32 v109, v50, v51
    v_cvt_pk_bf16_f32 v110, v52, v53
    v_cvt_pk_bf16_f32 v111, v54, v55
    v_cvt_pk_bf16_f32 v112, v56, v57
    v_cvt_pk_bf16_f32 v113, v58, v59
    v_cvt_pk_bf16_f32 v114, v60, v61
    v_cvt_pk_bf16_f32 v115, v62, v63
    v_and_b32 v100, v108, v240
    v_and_b32 v101, v109, v241
    v_and_b32 v102, v110, v242
    v_and_b32 v103, v111, v243
    v_and_b32 v104, v112, v244
    v_and_b32 v105, v113, v245
    v_and_b32 v106, v114, v246
    v_and_b32 v107, v115, v247
    v_xor_b32 v108, v108, v100
    v_xor_b32 v109, v109, v101
    v_xor_b32 v110, v110, v102
    v_xor_b32 v111, v111, v103
    v_xor_b32 v112, v112, v104
    v_xor_b32 v113, v113, v105
    v_xor_b32 v114, v114, v106
    v_xor_b32 v115, v115, v107
    s_setprio 2
    s_waitcnt lgkmcnt(4)
    v_mfma_f32_32x32x16_bf16 v[48:63], v[232:235], v[216:219], 0
    s_cmp_gt_u32 s13, 6
    s_cselect_b32 s51, 0xff00, 0
    v_mov_b32 v223, s51
    v_exp_f32 v64, v64
    v_exp_f32 v65, v65
    v_exp_f32 v66, v66
    v_exp_f32 v67, v67
    v_exp_f32 v68, v68
    v_exp_f32 v69, v69
    v_exp_f32 v70, v70
    v_exp_f32 v71, v71
    v_exp_f32 v72, v72
    v_cvt_pk_bf16_f32 v116, v64, v65
    v_cvt_pk_bf16_f32 v117, v66, v67
    s_waitcnt lgkmcnt(3)
    v_mfma_f32_32x32x16_bf16 v[48:63], v[236:239], v[220:223], v[48:63]
    ds_read_b64 v[232:233], v248 offset:1024
    ds_read_b64 v[234:235], v248 offset:5120
    ds_read_b64 v[236:237], v249 offset:1024
    v_cvt_pk_bf16_f32 v118, v68, v69
    buffer_store_dwordx4 v[196:199], v203, s[28:31], 0 offen nt
    v_cvt_pk_bf16_f32 v119, v70, v71
    v_exp_f32 v73, v73
    v_exp_f32 v74, v74
    v_exp_f32 v75, v75
    v_exp_f32 v76, v76
    v_exp_f32 v77, v77
    v_exp_f32 v78, v78
    v_exp_f32 v79, v79
    v_cvt_pk_bf16_f32 v120, v72, v73
    v_cvt_pk_bf16_f32 v121, v74, v75
    v_cvt_pk_bf16_f32 v122, v76, v77
    v_cvt_pk_bf16_f32 v123, v78, v79
    s_setprio 1
    s_waitcnt lgkmcnt(4)
    v_mfma_f32_32x32x16_bf16 v[64:79], v[224:227], v[216:219], 0
    s_cmp_gt_u32 s13, 5
    s_cselect_b32 s51, 0xff00, 0
    v_mov_b32 v223, s51
    v_exp_f32 v48, v48
    v_exp_f32 v49, v49
    v_exp_f32 v50, v50
    v_exp_f32 v51, v51
    v_exp_f32 v52, v52
    v_exp_f32 v53, v53
    v_exp_f32 v54, v54
    v_exp_f32 v55, v55
    v_exp_f32 v56, v56
    v_cvt_pk_bf16_f32 v124, v48, v49
    v_cvt_pk_bf16_f32 v125, v50, v51
    s_waitcnt lgkmcnt(3)
    v_mfma_f32_32x32x16_bf16 v[64:79], v[228:231], v[220:223], v[64:79]
    ds_read_b64 v[224:225], v248 offset:768
    ds_read_b64 v[226:227], v248 offset:4864
    ds_read_b64 v[228:229], v249 offset:768
    v_cvt_pk_bf16_f32 v126, v52, v53
    buffer_store_dwordx4 v[184:187], v200, s[28:31], 0 offen nt
    v_cvt_pk_bf16_f32 v127, v54, v55
    v_exp_f32 v57, v57
    v_exp_f32 v58, v58
    v_exp_f32 v59, v59
    v_exp_f32 v60, v60
    v_exp_f32 v61, v61
    v_exp_f32 v62, v62
    v_exp_f32 v63, v63
    v_cvt_pk_bf16_f32 v128, v56, v57
    v_cvt_pk_bf16_f32 v129, v58, v59
    v_cvt_pk_bf16_f32 v130, v60, v61
    v_cvt_pk_bf16_f32 v131, v62, v63
    s_waitcnt vmcnt(2)
    s_barrier
    ds_read_b64_tr_b16 v[32:33], v250 offset:2048
    ds_read_b64_tr_b16 v[34:35], v250 offset:2080
    ds_read_b64_tr_b16 v[36:37], v250 offset:2176
    ds_read_b64_tr_b16 v[38:39], v250 offset:2208
    ds_read_b64_tr_b16 v[40:41], v250 offset:0
    ds_read_b64_tr_b16 v[42:43], v250 offset:32
    ds_read_b64_tr_b16 v[44:45], v250 offset:128
    ds_read_b64_tr_b16 v[46:47], v250 offset:160
    s_waitcnt lgkmcnt(12)
    v_mfma_f32_32x32x16_bf16 v[48:63], v[232:235], v[216:219], 0
    s_cmp_gt_u32 s13, 4
    s_cselect_b32 s51, 0xff00, 0
    v_mov_b32 v223, s51
    v_exp_f32 v64, v64
    v_exp_f32 v65, v65
    v_exp_f32 v66, v66
    v_exp_f32 v67, v67
    s_waitcnt lgkmcnt(11)
    v_mfma_f32_32x32x16_bf16 v[48:63], v[236:239], v[220:223], v[48:63]
    ds_read_b64 v[232:233], v248 offset:512
    ds_read_b64 v[234:235], v248 offset:4608
    ds_read_b64 v[236:237], v249 offset:512
    v_exp_f32 v68, v68
    v_exp_f32 v69, v69
    v_exp_f32 v70, v70
    s_waitcnt lgkmcnt(9)
    v_mfma_f32_32x32x16_bf16 v[80:95], v[32:35], v[100:103], 0
    ds_read_b64_tr_b16 v[32:33], v250 offset:1792
    ds_read_b64_tr_b16 v[34:35], v250 offset:1824
    v_exp_f32 v71, v71
    v_exp_f32 v72, v72
    v_cvt_pk_bf16_f32 v132, v64, v65
    v_cvt_pk_bf16_f32 v133, v66, v67
    s_waitcnt lgkmcnt(9)
    v_mfma_f32_32x32x16_bf16 v[80:95], v[36:39], v[104:107], v[80:95]
    ds_read_b64_tr_b16 v[36:37], v250 offset:1920
    ds_read_b64_tr_b16 v[38:39], v250 offset:1952
    v_cvt_pk_bf16_f32 v134, v68, v69
    buffer_store_dwordx4 v[188:191], v201, s[28:31], 0 offen nt
    v_cvt_pk_bf16_f32 v135, v70, v71
    v_exp_f32 v73, v73
    v_exp_f32 v74, v74
    v_exp_f32 v75, v75
    s_waitcnt lgkmcnt(9)
    v_mfma_f32_32x32x16_bf16 v[80:95], v[40:43], v[108:111], v[80:95]
    ds_read_b64_tr_b16 v[40:41], v250 offset:1536
    ds_read_b64_tr_b16 v[42:43], v250 offset:1568
    v_exp_f32 v76, v76
    v_exp_f32 v77, v77
    v_exp_f32 v78, v78
    s_waitcnt lgkmcnt(9)
    v_mfma_f32_32x32x16_bf16 v[80:95], v[44:47], v[112:115], v[80:95]
    ds_read_b64_tr_b16 v[44:45], v250 offset:1664
    ds_read_b64_tr_b16 v[46:47], v250 offset:1696
    v_exp_f32 v79, v79
    v_cvt_pk_bf16_f32 v136, v72, v73
    v_cvt_pk_bf16_f32 v137, v74, v75
    v_cvt_pk_bf16_f32 v138, v76, v77
    v_cvt_pk_bf16_f32 v139, v78, v79
    s_setprio 0
    v_mfma_f32_32x32x16_bf16 v[64:79], v[224:227], v[216:219], 0
    s_cmp_gt_u32 s13, 3
    s_cselect_b32 s51, 0xff00, 0
    v_mov_b32 v223, s51
    v_exp_f32 v48, v48
    v_exp_f32 v49, v49
    v_exp_f32 v50, v50
    v_exp_f32 v51, v51
    v_mfma_f32_32x32x16_bf16 v[64:79], v[228:231], v[220:223], v[64:79]
    ds_read_b64 v[224:225], v248 offset:256
    ds_read_b64 v[226:227], v248 offset:4352
    ds_read_b64 v[228:229], v249 offset:256
    v_exp_f32 v52, v52
    v_exp_f32 v53, v53
    v_exp_f32 v54, v54
    v_exp_f32 v55, v55
    s_waitcnt lgkmcnt(9)
    v_mfma_f32_32x32x16_bf16 v[80:95], v[32:35], v[116:119], v[80:95]
    ds_read_b64_tr_b16 v[32:33], v250 offset:1280
    ds_read_b64_tr_b16 v[34:35], v250 offset:1312
    v_exp_f32 v56, v56
    v_cvt_pk_bf16_f32 v140, v48, v49
    v_cvt_pk_bf16_f32 v141, v50, v51
    v_cvt_pk_bf16_f32 v142, v52, v53
    v_cvt_pk_bf16_f32 v143, v54, v55
    v_exp_f32 v57, v57
    s_waitcnt lgkmcnt(9)
    v_mfma_f32_32x32x16_bf16 v[80:95], v[36:39], v[120:123], v[80:95]
    ds_read_b64_tr_b16 v[36:37], v250 offset:1408
    ds_read_b64_tr_b16 v[38:39], v250 offset:1440
    v_exp_f32 v58, v58
    v_exp_f32 v59, v59
    v_exp_f32 v60, v60
    v_exp_f32 v61, v61
    s_waitcnt lgkmcnt(9)
    v_mfma_f32_32x32x16_bf16 v[80:95], v[40:43], v[124:127], v[80:95]
    ds_read_b64_tr_b16 v[40:41], v250 offset:1024
    ds_read_b64_tr_b16 v[42:43], v250 offset:1056
    v_exp_f32 v62, v62
    v_exp_f32 v63, v63
    v_cvt_pk_bf16_f32 v144, v56, v57
    v_cvt_pk_bf16_f32 v145, v58, v59
    v_cvt_pk_bf16_f32 v146, v60, v61
    v_cvt_pk_bf16_f32 v147, v62, v63
    v_mfma_f32_32x32x16_bf16 v[48:63], v[232:235], v[216:219], 0
    s_cmp_gt_u32 s13, 2
    s_cselect_b32 s51, 0xff00, 0
    v_mov_b32 v223, s51
    v_exp_f32 v64, v64
    v_exp_f32 v65, v65
    v_exp_f32 v66, v66
    v_exp_f32 v67, v67
    v_mfma_f32_32x32x16_bf16 v[48:63], v[236:239], v[220:223], v[48:63]
    v_exp_f32 v68, v68
    v_exp_f32 v69, v69
    v_exp_f32 v70, v70
    s_waitcnt lgkmcnt(9)
    v_mfma_f32_32x32x16_bf16 v[80:95], v[44:47], v[128:131], v[80:95]
    ds_read_b64_tr_b16 v[44:45], v250 offset:1152
    ds_read_b64_tr_b16 v[46:47], v250 offset:1184
    v_exp_f32 v71, v71
    v_exp_f32 v72, v72
    v_cvt_pk_bf16_f32 v148, v64, v65
    v_cvt_pk_bf16_f32 v149, v66, v67
    s_waitcnt lgkmcnt(6)
    v_mfma_f32_32x32x16_bf16 v[80:95], v[32:35], v[132:135], v[80:95]
    ds_read_b64_tr_b16 v[32:33], v250 offset:768
    ds_read_b64_tr_b16 v[34:35], v250 offset:800
    v_cvt_pk_bf16_f32 v150, v68, v69
    v_cvt_pk_bf16_f32 v151, v70, v71
    v_exp_f32 v73, v73
    v_exp_f32 v74, v74
    v_exp_f32 v75, v75
    s_waitcnt lgkmcnt(6)
    v_mfma_f32_32x32x16_bf16 v[80:95], v[36:39], v[136:139], v[80:95]
    ds_read_b64_tr_b16 v[36:37], v250 offset:896
    ds_read_b64_tr_b16 v[38:39], v250 offset:928
    v_exp_f32 v76, v76
    v_exp_f32 v77, v77
    v_exp_f32 v78, v78
    s_waitcnt lgkmcnt(6)
    v_mfma_f32_32x32x16_bf16 v[80:95], v[40:43], v[140:143], v[80:95]
    ds_read_b64_tr_b16 v[40:41], v250 offset:512
    ds_read_b64_tr_b16 v[42:43], v250 offset:544
    v_exp_f32 v79, v79
    v_cvt_pk_bf16_f32 v152, v72, v73
    v_cvt_pk_bf16_f32 v153, v74, v75
    v_cvt_pk_bf16_f32 v154, v76, v77
    v_cvt_pk_bf16_f32 v155, v78, v79
    v_mfma_f32_32x32x16_bf16 v[64:79], v[224:227], v[216:219], 0
    s_cmp_gt_u32 s13, 1
    s_cselect_b32 s51, 0xff00, 0
    v_mov_b32 v223, s51
    v_exp_f32 v48, v48
    v_exp_f32 v49, v49
    v_exp_f32 v50, v50
    v_exp_f32 v51, v51
    v_mfma_f32_32x32x16_bf16 v[64:79], v[228:231], v[220:223], v[64:79]
    v_exp_f32 v52, v52
    v_exp_f32 v53, v53
    v_exp_f32 v54, v54
    v_exp_f32 v55, v55
    s_waitcnt lgkmcnt(6)
    v_mfma_f32_32x32x16_bf16 v[80:95], v[44:47], v[144:147], v[80:95]
    ds_read_b64_tr_b16 v[44:45], v250 offset:640
    ds_read_b64_tr_b16 v[46:47], v250 offset:672
    v_exp_f32 v56, v56
    v_cvt_pk_bf16_f32 v156, v48, v49
    v_cvt_pk_bf16_f32 v157, v50, v51
    v_cvt_pk_bf16_f32 v158, v52, v53
    v_cvt_pk_bf16_f32 v159, v54, v55
    v_exp_f32 v57, v57
    s_waitcnt lgkmcnt(6)
    v_mfma_f32_32x32x16_bf16 v[80:95], v[32:35], v[148:151], v[80:95]
    ds_read_b64_tr_b16 v[32:33], v250 offset:256
    ds_read_b64_tr_b16 v[34:35], v250 offset:288
    v_exp_f32 v58, v58
    v_exp_f32 v59, v59
    v_exp_f32 v60, v60
    v_exp_f32 v61, v61
    s_waitcnt lgkmcnt(6)
    v_mfma_f32_32x32x16_bf16 v[80:95], v[36:39], v[152:155], v[80:95]
    ds_read_b64_tr_b16 v[36:37], v250 offset:384
    ds_read_b64_tr_b16 v[38:39], v250 offset:416
    v_exp_f32 v62, v62
    v_exp_f32 v63, v63
    v_cvt_pk_bf16_f32 v160, v56, v57
    v_cvt_pk_bf16_f32 v161, v58, v59
    v_cvt_pk_bf16_f32 v162, v60, v61
    v_cvt_pk_bf16_f32 v163, v62, v63
    s_waitcnt lgkmcnt(6)
    v_mfma_f32_32x32x16_bf16 v[80:95], v[40:43], v[156:159], v[80:95]
    v_exp_f32 v64, v64
    v_exp_f32 v65, v65
    v_exp_f32 v66, v66
    v_exp_f32 v67, v67
    v_exp_f32 v68, v68
    v_exp_f32 v69, v69
    v_exp_f32 v70, v70
    s_waitcnt lgkmcnt(4)
    v_mfma_f32_32x32x16_bf16 v[80:95], v[44:47], v[160:163], v[80:95]
    v_exp_f32 v71, v71
    v_exp_f32 v72, v72
    v_cvt_pk_bf16_f32 v164, v64, v65
    v_cvt_pk_bf16_f32 v165, v66, v67
    v_cvt_pk_bf16_f32 v166, v68, v69
    v_cvt_pk_bf16_f32 v167, v70, v71
    v_exp_f32 v73, v73
    v_exp_f32 v74, v74
    v_exp_f32 v75, v75
    s_waitcnt lgkmcnt(2)
    v_mfma_f32_32x32x16_bf16 v[80:95], v[32:35], v[164:167], v[80:95]
    v_exp_f32 v76, v76
    v_exp_f32 v77, v77
    v_exp_f32 v78, v78
    v_exp_f32 v79, v79
    v_cvt_pk_bf16_f32 v168, v72, v73
    v_cvt_pk_bf16_f32 v169, v74, v75
    v_cvt_pk_bf16_f32 v170, v76, v77
    v_cvt_pk_bf16_f32 v171, v78, v79
    s_waitcnt lgkmcnt(0)
    s_nop 0
    v_mfma_f32_32x32x16_bf16 v[80:95], v[36:39], v[168:171], v[80:95]
    v_mov_b32 v14, s96
    v_mov_b32 v15, 0
    s_mov_b32 s48, 0x7b800000
    s_cmp_eq_u32 s32, 0
    s_nop 7
    v_rcp_f32 v96, v92
    s_nop 0
    v_pk_mul_f32 v[80:81], v[80:81], v[96:97] op_sel_hi:[1,0]
    v_pk_mul_f32 v[82:83], v[82:83], v[96:97] op_sel_hi:[1,0]
    v_pk_mul_f32 v[84:85], v[84:85], v[96:97] op_sel_hi:[1,0]
    v_pk_mul_f32 v[86:87], v[86:87], v[96:97] op_sel_hi:[1,0]
    v_pk_mul_f32 v[88:89], v[88:89], v[96:97] op_sel_hi:[1,0]
    v_pk_mul_f32 v[90:91], v[90:91], v[96:97] op_sel_hi:[1,0]
    v_cvt_pk_bf16_f32 v100, v80, v81
    v_cvt_pk_bf16_f32 v101, v82, v83
    v_cvt_pk_bf16_f32 v102, v84, v85
    v_cvt_pk_bf16_f32 v103, v86, v87
    v_cvt_pk_bf16_f32 v104, v88, v89
    v_cvt_pk_bf16_f32 v105, v90, v91
    s_cbranch_scc1 O_SC1L
    buffer_store_dwordx4 v[100:103], v251, s[24:27], 0 offen nt
    buffer_store_dwordx2 v[104:105], v252, s[24:27], 0 offen nt
    v_maximum3_f32 v98, |v80|, |v81|, |v82|
    v_maximum3_f32 v98, v98, |v83|, |v84|
    v_maximum3_f32 v98, v98, |v85|, |v86|
    v_maximum3_f32 v98, v98, |v87|, |v88|
    v_maximum3_f32 v98, v98, |v89|, |v90|
    v_maximum3_f32 v98, v98, |v91|, |v92|
    v_mul_f32 v99, 0x53800000, v96
    v_maximum3_f32 v98, v98, v99, v99
    v_cmp_ngt_f32 vcc, s48, v98
    s_nop 0
    s_cbranch_vccnz REDO
    s_waitcnt vmcnt(0)
    s_mov_b64 exec, 1
    buffer_store_dword v14, v15, s[24:27], s12 offen
O_DONEL:
OUTPROJ:
    s_mov_b64 exec, -1
    s_mov_b64 exec, -1
    s_and_b32 s33, s4, 3
    s_lshr_b32 s34, s4, 2
    s_lshl_b32 s35, s33, 1
    s_lshr_b32 s36, s7, 1
    s_add_u32 s35, s35, s36
    s_lshl_b32 s36, s3, 5
    s_add_u32 s36, s36, s35
    s_mul_i32 s36, s36, 512
    s_add_u32 s36, s36, 12583168
    v_and_b32 v1, 31, v0
    v_lshl_add_u32 v176, v1, 2, s36
    buffer_load_dword v177, v176, s[24:27], 0 offen sc1
    v_and_b32 v1, 15, v0
    v_lshrrev_b32 v2, 4, v0
    v_and_b32 v3, 1, v2
    v_lshrrev_b32 v4, 1, v2
    s_and_b32 s37, s7, 1
    v_mul_u32_u24 v5, 5, v4
    v_lshl_add_u32 v5, v3, 1, v5
    s_movk_i32 s38, 16640
    v_lshlrev_b32 v6, 4, v1
    v_mad_u32_u24 v8, v5, s38, v6
    v_lshl_add_u32 v6, v2, 1, v3
    v_xor_b32 v14, 1, v6
    s_mov_b32 s38, 83200
    v_lshlrev_b32 v7, 3, v1
    v_mad_u32_u24 v9, v6, s38, v7
    v_mad_u32_u24 v10, v14, s38, v7
    s_lshl_b32 s40, s3, 11
    s_lshl_b32 s41, s35, 8
    s_add_u32 s40, s40, s41
    s_lshl_b32 s41, s37, 7
    s_add_u32 s41, s41, s40
    s_add_u32 s41, s41, 66560
    s_mul_i32 s42, s37, 16640
    s_add_u32 s40, s40, s42
    v_add_u32 v11, 59904, v253
    v_add_u32 v12, 111104, v253
    s_lshl_b32 s42, s3, 8
    s_lshl_b32 s43, s35, 5
    s_add_u32 s42, s42, s43
    s_lshl_b32 s43, s37, 0
    s_add_u32 s42, s42, s43
    v_lshl_add_u32 v5, v1, 1, s42
    s_movk_i32 s38, 2560
    v_mul_u32_u24 v5, s38, v5
    v_lshl_add_u32 v7, v2, 3, v5
    v_lshl_add_u32 v5, v2, 4, v5
    s_mul_i32 s42, s34, 160
    s_add_u32 s42, s42, 1280
    s_and_b32 s34, s34, 1
    s_cselect_b32 s43, 0, 0x80
    s_add_u32 s43, s43, s42
    s_lshl_b32 s34, s34, 5
    s_add_u32 s42, s42, s34
    v_mov_b32 v178, 59808
    s_mov_b32 s50, 200000
WO_WAIT:
    ds_read_b32 v179, v178
    s_sub_u32 s50, s50, 1
    s_waitcnt lgkmcnt(0)
    v_cmp_ne_u32 vcc, 4, v179
    s_cbranch_scc1 WO_OK
    s_cbranch_vccnz WO_WAIT
WO_OK:
    ds_read_b128 v[96:99], v11 offset:0
    ds_read_b128 v[100:103], v11 offset:1024
    ds_read_b128 v[104:107], v11 offset:2048
    ds_read_b128 v[108:111], v11 offset:3072
    ds_read_b128 v[112:115], v11 offset:4096
    ds_read_b128 v[116:119], v11 offset:5120
    ds_read_b128 v[120:123], v11 offset:6144
    ds_read_b128 v[124:127], v11 offset:7168
    ds_read_b128 v[128:131], v11 offset:8192
    ds_read_b128 v[132:135], v11 offset:9216
    ds_read_b128 v[136:139], v11 offset:10240
    ds_read_b128 v[140:143], v11 offset:11264
    ds_read_b128 v[144:147], v11 offset:12288
    ds_read_b128 v[148:151], v11 offset:13312
    ds_read_b128 v[152:155], v11 offset:14336
    s_mov_b32 s50, 200000
    s_waitcnt vmcnt(0)
    s_branch SC_29
SP_28:
    buffer_load_dword v177, v176, s[24:27], 0 offen sc1
    s_waitcnt vmcnt(0)
SC_29:
    v_cmp_ne_u32 vcc, s96, v177
    s_sub_u32 s50, s50, 1
    s_cbranch_scc1 SD_30
    s_cbranch_vccnz SP_28
SD_30:
    buffer_load_dwordx4 v[16:19], v8, s[24:27], s40 offen sc1
    s_add_u32 s40, s40, 166400
    buffer_load_dwordx4 v[20:23], v8, s[24:27], s40 offen sc1
    s_add_u32 s40, s40, 166400
    buffer_load_dwordx4 v[24:27], v8, s[24:27], s40 offen sc1
    s_add_u32 s40, s40, 166400
    buffer_load_dwordx4 v[28:31], v8, s[24:27], s40 offen sc1
    s_add_u32 s40, s40, 166400
    buffer_load_dwordx2 v[32:33], v9, s[24:27], s41 offen sc1
    buffer_load_dwordx2 v[34:35], v10, s[24:27], s41 offen sc1
    s_add_u32 s41, s41, 665600
    buffer_load_dwordx4 v[36:39], v8, s[24:27], s40 offen sc1
    s_add_u32 s40, s40, 166400
    s_waitcnt vmcnt(6) lgkmcnt(10)
    v_mfma_f32_16x16x32_bf16 v[216:219], v[96:99], v[16:19], 0
    ds_read_b128 v[156:159], v11 offset:15360
    buffer_load_dwordx4 v[40:43], v8, s[24:27], s40 offen sc1
    s_add_u32 s40, s40, 166400
    v_mfma_f32_16x16x32_bf16 v[220:223], v[100:103], v[16:19], 0
    ds_read_b128 v[160:163], v11 offset:16384
    v_mfma_f32_16x16x32_bf16 v[224:227], v[104:107], v[16:19], 0
    ds_read_b128 v[164:167], v11 offset:17408
    v_mfma_f32_16x16x32_bf16 v[228:231], v[108:111], v[16:19], 0
    ds_read_b128 v[168:171], v11 offset:18432
    v_mfma_f32_16x16x32_bf16 v[232:235], v[112:115], v[16:19], 0
    ds_read_b128 v[172:175], v11 offset:19456
    s_waitcnt vmcnt(6) lgkmcnt(10)
    v_mfma_f32_16x16x32_bf16 v[216:219], v[116:119], v[20:23], v[216:219]
    ds_read_b128 v[96:99], v11 offset:20480
    buffer_load_dwordx4 v[44:47], v8, s[24:27], s40 offen sc1
    s_add_u32 s40, s40, 166400
    v_mfma_f32_16x16x32_bf16 v[220:223], v[120:123], v[20:23], v[220:223]
    ds_read_b128 v[100:103], v11 offset:21504
    v_mfma_f32_16x16x32_bf16 v[224:227], v[124:127], v[20:23], v[224:227]
    ds_read_b128 v[104:107], v11 offset:22528
    v_mfma_f32_16x16x32_bf16 v[228:231], v[128:131], v[20:23], v[228:231]
    ds_read_b128 v[108:111], v11 offset:23552
    v_mfma_f32_16x16x32_bf16 v[232:235], v[132:135], v[20:23], v[232:235]
    ds_read_b128 v[112:115], v11 offset:24576
    s_waitcnt vmcnt(6) lgkmcnt(10)
    v_mfma_f32_16x16x32_bf16 v[216:219], v[136:139], v[24:27], v[216:219]
    ds_read_b128 v[116:119], v11 offset:25600
    buffer_load_dwordx4 v[48:51], v8, s[24:27], s40 offen sc1
    s_add_u32 s40, s40, 166400
    v_mfma_f32_16x16x32_bf16 v[220:223], v[140:143], v[24:27], v[220:223]
    ds_read_b128 v[120:123], v11 offset:26624
    v_mfma_f32_16x16x32_bf16 v[224:227], v[144:147], v[24:27], v[224:227]
    ds_read_b128 v[124:127], v11 offset:27648
    v_mfma_f32_16x16x32_bf16 v[228:231], v[148:151], v[24:27], v[228:231]
    ds_read_b128 v[128:131], v11 offset:28672
    v_mfma_f32_16x16x32_bf16 v[232:235], v[152:155], v[24:27], v[232:235]
    ds_read_b128 v[132:135], v11 offset:29696
    s_waitcnt vmcnt(6) lgkmcnt(10)
    v_mfma_f32_16x16x32_bf16 v[216:219], v[156:159], v[28:31], v[216:219]
    ds_read_b128 v[136:139], v11 offset:30720
    buffer_load_dwordx2 v[52:53], v9, s[24:27], s41 offen sc1
    buffer_load_dwordx2 v[54:55], v10, s[24:27], s41 offen sc1
    s_add_u32 s41, s41, 665600
    v_mfma_f32_16x16x32_bf16 v[220:223], v[160:163], v[28:31], v[220:223]
    ds_read_b128 v[140:143], v11 offset:31744
    v_mfma_f32_16x16x32_bf16 v[224:227], v[164:167], v[28:31], v[224:227]
    ds_read_b128 v[144:147], v11 offset:32768
    v_mfma_f32_16x16x32_bf16 v[228:231], v[168:171], v[28:31], v[228:231]
    ds_read_b128 v[148:151], v11 offset:33792
    v_mfma_f32_16x16x32_bf16 v[232:235], v[172:175], v[28:31], v[232:235]
    ds_read_b128 v[152:155], v11 offset:34816
    s_waitcnt vmcnt(6) lgkmcnt(10)
    v_mfma_f32_16x16x32_bf16 v[216:219], v[96:99], v[32:35], v[216:219]
    ds_read_b128 v[156:159], v11 offset:35840
    buffer_load_dwordx4 v[56:59], v8, s[24:27], s40 offen sc1
    s_add_u32 s40, s40, 166400
    v_mfma_f32_16x16x32_bf16 v[220:223], v[100:103], v[32:35], v[220:223]
    ds_read_b128 v[160:163], v11 offset:36864
    v_mfma_f32_16x16x32_bf16 v[224:227], v[104:107], v[32:35], v[224:227]
    ds_read_b128 v[164:167], v11 offset:37888
    v_mfma_f32_16x16x32_bf16 v[228:231], v[108:111], v[32:35], v[228:231]
    ds_read_b128 v[168:171], v11 offset:38912
    v_mfma_f32_16x16x32_bf16 v[232:235], v[112:115], v[32:35], v[232:235]
    ds_read_b128 v[172:175], v11 offset:39936
    s_waitcnt vmcnt(6) lgkmcnt(10)
    v_mfma_f32_16x16x32_bf16 v[216:219], v[116:119], v[36:39], v[216:219]
    ds_read_b128 v[96:99], v11 offset:40960
    buffer_load_dwordx4 v[60:63], v8, s[24:27], s40 offen sc1
    s_add_u32 s40, s40, 166400
    v_mfma_f32_16x16x32_bf16 v[220:223], v[120:123], v[36:39], v[220:223]
    ds_read_b128 v[100:103], v11 offset:41984
    v_mfma_f32_16x16x32_bf16 v[224:227], v[124:127], v[36:39], v[224:227]
    ds_read_b128 v[104:107], v11 offset:43008
    v_mfma_f32_16x16x32_bf16 v[228:231], v[128:131], v[36:39], v[228:231]
    ds_read_b128 v[108:111], v11 offset:44032
    v_mfma_f32_16x16x32_bf16 v[232:235], v[132:135], v[36:39], v[232:235]
    ds_read_b128 v[112:115], v11 offset:45056
    s_waitcnt vmcnt(6) lgkmcnt(10)
    v_mfma_f32_16x16x32_bf16 v[216:219], v[136:139], v[40:43], v[216:219]
    ds_read_b128 v[116:119], v11 offset:46080
    buffer_load_dwordx4 v[64:67], v8, s[24:27], s40 offen sc1
    s_add_u32 s40, s40, 166400
    v_mfma_f32_16x16x32_bf16 v[220:223], v[140:143], v[40:43], v[220:223]
    ds_read_b128 v[120:123], v11 offset:47104
    v_mfma_f32_16x16x32_bf16 v[224:227], v[144:147], v[40:43], v[224:227]
    ds_read_b128 v[124:127], v11 offset:48128
    v_mfma_f32_16x16x32_bf16 v[228:231], v[148:151], v[40:43], v[228:231]
    ds_read_b128 v[128:131], v11 offset:49152
    v_mfma_f32_16x16x32_bf16 v[232:235], v[152:155], v[40:43], v[232:235]
    ds_read_b128 v[132:135], v11 offset:50176
    s_waitcnt vmcnt(6) lgkmcnt(10)
    v_mfma_f32_16x16x32_bf16 v[216:219], v[156:159], v[44:47], v[216:219]
    ds_read_b128 v[136:139], v12 offset:0
    buffer_load_dwordx4 v[68:71], v8, s[24:27], s40 offen sc1
    s_add_u32 s40, s40, 166400
    v_mfma_f32_16x16x32_bf16 v[220:223], v[160:163], v[44:47], v[220:223]
    ds_read_b128 v[140:143], v12 offset:1024
    v_mfma_f32_16x16x32_bf16 v[224:227], v[164:167], v[44:47], v[224:227]
    ds_read_b128 v[144:147], v12 offset:2048
    v_mfma_f32_16x16x32_bf16 v[228:231], v[168:171], v[44:47], v[228:231]
    ds_read_b128 v[148:151], v12 offset:3072
    v_mfma_f32_16x16x32_bf16 v[232:235], v[172:175], v[44:47], v[232:235]
    ds_read_b128 v[152:155], v12 offset:4096
    s_waitcnt vmcnt(6) lgkmcnt(10)
    v_mfma_f32_16x16x32_bf16 v[216:219], v[96:99], v[48:51], v[216:219]
    ds_read_b128 v[156:159], v12 offset:5120
    buffer_load_dwordx2 v[72:73], v9, s[24:27], s41 offen sc1
    buffer_load_dwordx2 v[74:75], v10, s[24:27], s41 offen sc1
    s_add_u32 s41, s41, 665600
    v_mfma_f32_16x16x32_bf16 v[220:223], v[100:103], v[48:51], v[220:223]
    ds_read_b128 v[160:163], v12 offset:6144
    v_mfma_f32_16x16x32_bf16 v[224:227], v[104:107], v[48:51], v[224:227]
    ds_read_b128 v[164:167], v12 offset:7168
    v_mfma_f32_16x16x32_bf16 v[228:231], v[108:111], v[48:51], v[228:231]
    ds_read_b128 v[168:171], v12 offset:8192
    v_mfma_f32_16x16x32_bf16 v[232:235], v[112:115], v[48:51], v[232:235]
    ds_read_b128 v[172:175], v12 offset:9216
    s_waitcnt vmcnt(6) lgkmcnt(10)
    v_mfma_f32_16x16x32_bf16 v[216:219], v[116:119], v[52:55], v[216:219]
    ds_read_b128 v[96:99], v12 offset:10240
    buffer_load_dwordx4 v[76:79], v8, s[24:27], s40 offen sc1
    s_add_u32 s40, s40, 166400
    v_mfma_f32_16x16x32_bf16 v[220:223], v[120:123], v[52:55], v[220:223]
    ds_read_b128 v[100:103], v12 offset:11264
    v_mfma_f32_16x16x32_bf16 v[224:227], v[124:127], v[52:55], v[224:227]
    ds_read_b128 v[104:107], v12 offset:12288
    v_mfma_f32_16x16x32_bf16 v[228:231], v[128:131], v[52:55], v[228:231]
    ds_read_b128 v[108:111], v12 offset:13312
    v_mfma_f32_16x16x32_bf16 v[232:235], v[132:135], v[52:55], v[232:235]
    ds_read_b128 v[112:115], v12 offset:14336
    s_waitcnt vmcnt(6) lgkmcnt(10)
    v_mfma_f32_16x16x32_bf16 v[216:219], v[136:139], v[56:59], v[216:219]
    ds_read_b128 v[116:119], v12 offset:15360
    buffer_load_dwordx4 v[80:83], v8, s[24:27], s40 offen sc1
    s_add_u32 s40, s40, 166400
    v_mfma_f32_16x16x32_bf16 v[220:223], v[140:143], v[56:59], v[220:223]
    ds_read_b128 v[120:123], v12 offset:16384
    v_mfma_f32_16x16x32_bf16 v[224:227], v[144:147], v[56:59], v[224:227]
    ds_read_b128 v[124:127], v12 offset:17408
    v_mfma_f32_16x16x32_bf16 v[228:231], v[148:151], v[56:59], v[228:231]
    ds_read_b128 v[128:131], v12 offset:18432
    v_mfma_f32_16x16x32_bf16 v[232:235], v[152:155], v[56:59], v[232:235]
    ds_read_b128 v[132:135], v12 offset:19456
    s_waitcnt vmcnt(6) lgkmcnt(10)
    v_mfma_f32_16x16x32_bf16 v[216:219], v[156:159], v[60:63], v[216:219]
    ds_read_b128 v[136:139], v12 offset:20480
    buffer_load_dwordx4 v[84:87], v8, s[24:27], s40 offen sc1
    s_add_u32 s40, s40, 166400
    v_mfma_f32_16x16x32_bf16 v[220:223], v[160:163], v[60:63], v[220:223]
    ds_read_b128 v[140:143], v12 offset:21504
    v_mfma_f32_16x16x32_bf16 v[224:227], v[164:167], v[60:63], v[224:227]
    ds_read_b128 v[144:147], v12 offset:22528
    v_mfma_f32_16x16x32_bf16 v[228:231], v[168:171], v[60:63], v[228:231]
    ds_read_b128 v[148:151], v12 offset:23552
    v_mfma_f32_16x16x32_bf16 v[232:235], v[172:175], v[60:63], v[232:235]
    ds_read_b128 v[152:155], v12 offset:24576
    s_waitcnt vmcnt(6) lgkmcnt(10)
    v_mfma_f32_16x16x32_bf16 v[216:219], v[96:99], v[64:67], v[216:219]
    ds_read_b128 v[156:159], v12 offset:25600
    buffer_load_dwordx4 v[88:91], v8, s[24:27], s40 offen sc1
    s_add_u32 s40, s40, 166400
    v_mfma_f32_16x16x32_bf16 v[220:223], v[100:103], v[64:67], v[220:223]
    ds_read_b128 v[160:163], v12 offset:26624
    v_mfma_f32_16x16x32_bf16 v[224:227], v[104:107], v[64:67], v[224:227]
    ds_read_b128 v[164:167], v12 offset:27648
    v_mfma_f32_16x16x32_bf16 v[228:231], v[108:111], v[64:67], v[228:231]
    ds_read_b128 v[168:171], v12 offset:28672
    v_mfma_f32_16x16x32_bf16 v[232:235], v[112:115], v[64:67], v[232:235]
    ds_read_b128 v[172:175], v12 offset:29696
    s_waitcnt vmcnt(6) lgkmcnt(10)
    v_mfma_f32_16x16x32_bf16 v[216:219], v[116:119], v[68:71], v[216:219]
    ds_read_b128 v[96:99], v12 offset:30720
    buffer_load_dwordx2 v[92:93], v9, s[24:27], s41 offen sc1
    buffer_load_dwordx2 v[94:95], v10, s[24:27], s41 offen sc1
    s_add_u32 s41, s41, 665600
    v_mfma_f32_16x16x32_bf16 v[220:223], v[120:123], v[68:71], v[220:223]
    ds_read_b128 v[100:103], v12 offset:31744
    v_mfma_f32_16x16x32_bf16 v[224:227], v[124:127], v[68:71], v[224:227]
    ds_read_b128 v[104:107], v12 offset:32768
    v_mfma_f32_16x16x32_bf16 v[228:231], v[128:131], v[68:71], v[228:231]
    ds_read_b128 v[108:111], v12 offset:33792
    v_mfma_f32_16x16x32_bf16 v[232:235], v[132:135], v[68:71], v[232:235]
    ds_read_b128 v[112:115], v12 offset:34816
    s_waitcnt vmcnt(6) lgkmcnt(10)
    v_mfma_f32_16x16x32_bf16 v[216:219], v[136:139], v[72:75], v[216:219]
    ds_read_b128 v[116:119], v12 offset:35840
    v_mfma_f32_16x16x32_bf16 v[220:223], v[140:143], v[72:75], v[220:223]
    ds_read_b128 v[120:123], v12 offset:36864
    v_mfma_f32_16x16x32_bf16 v[224:227], v[144:147], v[72:75], v[224:227]
    ds_read_b128 v[124:127], v12 offset:37888
    v_mfma_f32_16x16x32_bf16 v[228:231], v[148:151], v[72:75], v[228:231]
    ds_read_b128 v[128:131], v12 offset:38912
    v_mfma_f32_16x16x32_bf16 v[232:235], v[152:155], v[72:75], v[232:235]
    ds_read_b128 v[132:135], v12 offset:39936
    s_waitcnt vmcnt(5) lgkmcnt(10)
    v_mfma_f32_16x16x32_bf16 v[216:219], v[156:159], v[76:79], v[216:219]
    ds_read_b128 v[136:139], v12 offset:40960
    v_mfma_f32_16x16x32_bf16 v[220:223], v[160:163], v[76:79], v[220:223]
    ds_read_b128 v[140:143], v12 offset:41984
    v_mfma_f32_16x16x32_bf16 v[224:227], v[164:167], v[76:79], v[224:227]
    ds_read_b128 v[144:147], v12 offset:43008
    v_mfma_f32_16x16x32_bf16 v[228:231], v[168:171], v[76:79], v[228:231]
    ds_read_b128 v[148:151], v12 offset:44032
    v_mfma_f32_16x16x32_bf16 v[232:235], v[172:175], v[76:79], v[232:235]
    ds_read_b128 v[152:155], v12 offset:45056
    s_waitcnt vmcnt(4) lgkmcnt(10)
    v_mfma_f32_16x16x32_bf16 v[216:219], v[96:99], v[80:83], v[216:219]
    ds_read_b128 v[156:159], v12 offset:46080
    v_mfma_f32_16x16x32_bf16 v[220:223], v[100:103], v[80:83], v[220:223]
    ds_read_b128 v[160:163], v12 offset:47104
    v_mfma_f32_16x16x32_bf16 v[224:227], v[104:107], v[80:83], v[224:227]
    ds_read_b128 v[164:167], v12 offset:48128
    v_mfma_f32_16x16x32_bf16 v[228:231], v[108:111], v[80:83], v[228:231]
    ds_read_b128 v[168:171], v12 offset:49152
    v_mfma_f32_16x16x32_bf16 v[232:235], v[112:115], v[80:83], v[232:235]
    ds_read_b128 v[172:175], v12 offset:50176
    s_waitcnt vmcnt(3) lgkmcnt(10)
    v_mfma_f32_16x16x32_bf16 v[216:219], v[116:119], v[84:87], v[216:219]
    v_mfma_f32_16x16x32_bf16 v[220:223], v[120:123], v[84:87], v[220:223]
    v_mfma_f32_16x16x32_bf16 v[224:227], v[124:127], v[84:87], v[224:227]
    v_mfma_f32_16x16x32_bf16 v[228:231], v[128:131], v[84:87], v[228:231]
    v_mfma_f32_16x16x32_bf16 v[232:235], v[132:135], v[84:87], v[232:235]
    s_waitcnt vmcnt(0) lgkmcnt(0)
    v_mfma_f32_16x16x32_bf16 v[216:219], v[136:139], v[88:91], v[216:219]
    v_mfma_f32_16x16x32_bf16 v[220:223], v[140:143], v[88:91], v[220:223]
    v_mfma_f32_16x16x32_bf16 v[216:219], v[156:159], v[92:95], v[216:219]
    v_mfma_f32_16x16x32_bf16 v[220:223], v[160:163], v[92:95], v[220:223]
    v_mfma_f32_16x16x32_bf16 v[224:227], v[144:147], v[88:91], v[224:227]
    v_mfma_f32_16x16x32_bf16 v[228:231], v[148:151], v[88:91], v[228:231]
    v_mfma_f32_16x16x32_bf16 v[224:227], v[164:167], v[92:95], v[224:227]
    v_mfma_f32_16x16x32_bf16 v[228:231], v[168:171], v[92:95], v[228:231]
    s_nop 2
    v_cvt_pk_bf16_f32 v16, v216, v217
    v_cvt_pk_bf16_f32 v17, v218, v219
    v_cvt_pk_bf16_f32 v18, v220, v221
    v_cvt_pk_bf16_f32 v19, v222, v223
    buffer_store_dwordx4 v[16:19], v5, s[28:31], s42 offen nt
    v_mfma_f32_16x16x32_bf16 v[232:235], v[152:155], v[88:91], v[232:235]
    v_mfma_f32_16x16x32_bf16 v[232:235], v[172:175], v[92:95], v[232:235]
    v_cvt_pk_bf16_f32 v20, v224, v225
    v_cvt_pk_bf16_f32 v21, v226, v227
    v_cvt_pk_bf16_f32 v22, v228, v229
    v_cvt_pk_bf16_f32 v23, v230, v231
    buffer_store_dwordx4 v[20:23], v5, s[28:31], s42 offen offset:64 nt
    s_nop 2
    v_cvt_pk_bf16_f32 v24, v232, v233
    v_cvt_pk_bf16_f32 v25, v234, v235
    buffer_store_dwordx2 v[24:25], v7, s[28:31], s43 offen
    s_or_b32 s48, s5, s7
    s_cbranch_scc0 BUMP
BUMP_RET:
    s_endpgm
REDO:
    s_mov_b32 s45, 1
    s_mov_b32 s46, 0x07060302
    v_mov_b32 v222, 0
    v_mov_b32 v223, 0
    ds_read_b64 v[224:225], v248 offset:2048
    ds_read_b64 v[226:227], v248 offset:6144
    ds_read_b64 v[228:229], v249 offset:2048
    ds_read_b64 v[232:233], v248 offset:0
    ds_read_b64 v[234:235], v248 offset:4096
    ds_read_b64 v[236:237], v249 offset:0
    s_waitcnt lgkmcnt(0)
    v_mfma_f32_32x32x16_bf16 v[48:63], v[224:227], v[216:219], 0
    v_mfma_f32_32x32x16_bf16 v[48:63], v[228:231], v[220:223], v[48:63]
    v_mfma_f32_32x32x16_bf16 v[64:79], v[232:235], v[216:219], 0
    v_mfma_f32_32x32x16_bf16 v[64:79], v[236:239], v[220:223], v[64:79]
    ds_read_b64 v[224:225], v248 offset:1792
    ds_read_b64 v[226:227], v248 offset:5888
    ds_read_b64 v[228:229], v249 offset:1792
    s_nop 9
    s_cmp_eq_u32 s13, 0
    s_cbranch_scc1 T0OK
    v_mov_b32 v64, 0xff800000
    v_mov_b32 v65, 0xff800000
    v_mov_b32 v66, 0xff800000
    v_mov_b32 v67, 0xff800000
    v_mov_b32 v68, 0xff800000
    v_mov_b32 v69, 0xff800000
    v_mov_b32 v70, 0xff800000
    v_mov_b32 v71, 0xff800000
    v_mov_b32 v72, 0xff800000
    v_mov_b32 v73, 0xff800000
    v_mov_b32 v74, 0xff800000
    v_mov_b32 v75, 0xff800000
    v_mov_b32 v76, 0xff800000
    v_mov_b32 v77, 0xff800000
    v_mov_b32 v78, 0xff800000
    v_mov_b32 v79, 0xff800000
T0OK:
    v_cndmask_b32 v48, v64, v48, s[64:65]
    v_cndmask_b32 v49, v65, v49, s[66:67]
    v_cndmask_b32 v50, v66, v50, s[68:69]
    v_cndmask_b32 v51, v67, v51, s[70:71]
    v_cndmask_b32 v52, v68, v52, s[72:73]
    v_cndmask_b32 v53, v69, v53, s[74:75]
    v_cndmask_b32 v54, v70, v54, s[76:77]
    v_cndmask_b32 v55, v71, v55, s[78:79]
    v_cndmask_b32 v56, v72, v56, s[80:81]
    v_cndmask_b32 v57, v73, v57, s[82:83]
    v_cndmask_b32 v58, v74, v58, s[84:85]
    v_cndmask_b32 v59, v75, v59, s[86:87]
    v_cndmask_b32 v60, v76, v60, s[88:89]
    v_cndmask_b32 v61, v77, v61, s[90:91]
    v_cndmask_b32 v62, v78, v62, s[92:93]
    v_cndmask_b32 v63, v79, v63, s[94:95]
    v_max3_f32 v96, v48, v49, v50
    v_max3_f32 v97, v51, v52, v53
    v_max3_f32 v96, v96, v54, v55
    v_max3_f32 v97, v97, v56, v57
    v_max3_f32 v96, v96, v58, v59
    v_max3_f32 v97, v97, v60, v61
    v_max3_f32 v96, v96, v62, v63
    v_max_f32 v96, v96, v97
    s_mov_b32 s51, 0x42000000
    s_cmp_eq_u32 s45, 0
    s_cselect_b32 s51, s51, 0
    s_cselect_b32 s48, 7, 1
    s_max_u32 s48, s48, s13
    s_mov_b32 s49, 7
    v_add_u32 v98, 1792, v248
    v_add_u32 v99, 1792, v249
PASSA:
    s_cmp_lt_u32 s49, s48
    s_cbranch_scc1 HAVEMAX
    ds_read_b64 v[232:233], v98
    ds_read_b64 v[234:235], v98 offset:4096
    ds_read_b64 v[236:237], v99
    v_subrev_u32 v98, 256, v98
    v_subrev_u32 v99, 256, v99
    s_sub_u32 s49, s49, 1
    s_waitcnt lgkmcnt(0)
    v_mfma_f32_32x32x16_bf16 v[64:79], v[232:235], v[216:219], 0
    v_mfma_f32_32x32x16_bf16 v[64:79], v[236:239], v[220:223], v[64:79]
    s_nop 11
    v_max3_f32 v96, v96, v64, v65
    v_max3_f32 v96, v96, v66, v67
    v_max3_f32 v96, v96, v68, v69
    v_max3_f32 v96, v96, v70, v71
    v_max3_f32 v96, v96, v72, v73
    v_max3_f32 v96, v96, v74, v75
    v_max3_f32 v96, v96, v76, v77
    v_max3_f32 v96, v96, v78, v79
    s_branch PASSA
HAVEMAX:
    v_mov_b32 v97, v96
    s_nop 1
    v_permlane32_swap_b32 v96, v97
    v_max_f32 v96, v96, v97
    v_sub_f32 v96, -v96, s51
    v_and_b32 v98, 0xffff0000, v96
    v_sub_f32 v98, v96, v98
    v_perm_b32 v222, v98, v96, s46
    v_and_b32 v99, 0xffff0000, v98
    v_sub_f32 v98, v98, v99
    v_lshrrev_b32 v223, 16, v98
    s_waitcnt lgkmcnt(0)
    v_mfma_f32_32x32x16_bf16 v[64:79], v[224:227], v[216:219], 0
    v_pk_add_f32 v[48:49], v[48:49], v[96:97] op_sel_hi:[1,0]
    v_pk_add_f32 v[50:51], v[50:51], v[96:97] op_sel_hi:[1,0]
    v_pk_add_f32 v[52:53], v[52:53], v[96:97] op_sel_hi:[1,0]
    v_pk_add_f32 v[54:55], v[54:55], v[96:97] op_sel_hi:[1,0]
    v_pk_add_f32 v[56:57], v[56:57], v[96:97] op_sel_hi:[1,0]
    v_pk_add_f32 v[58:59], v[58:59], v[96:97] op_sel_hi:[1,0]
    v_pk_add_f32 v[60:61], v[60:61], v[96:97] op_sel_hi:[1,0]
    v_pk_add_f32 v[62:63], v[62:63], v[96:97] op_sel_hi:[1,0]
    v_mfma_f32_32x32x16_bf16 v[64:79], v[228:231], v[220:223], v[64:79]
    ds_read_b64 v[224:225], v248 offset:1536
    ds_read_b64 v[226:227], v248 offset:5632
    ds_read_b64 v[228:229], v249 offset:1536
    v_exp_f32 v48, v48
    v_exp_f32 v49, v49
    v_exp_f32 v50, v50
    v_exp_f32 v51, v51
    v_exp_f32 v52, v52
    v_exp_f32 v53, v53
    v_exp_f32 v54, v54
    v_exp_f32 v55, v55
    v_exp_f32 v56, v56
    v_exp_f32 v57, v57
    v_exp_f32 v58, v58
    v_exp_f32 v59, v59
    v_exp_f32 v60, v60
    v_exp_f32 v61, v61
    v_exp_f32 v62, v62
    v_exp_f32 v63, v63
    v_cvt_pk_bf16_f32 v108, v48, v49
    v_cvt_pk_bf16_f32 v109, v50, v51
    v_cvt_pk_bf16_f32 v110, v52, v53
    v_cvt_pk_bf16_f32 v111, v54, v55
    v_cvt_pk_bf16_f32 v112, v56, v57
    v_cvt_pk_bf16_f32 v113, v58, v59
    v_cvt_pk_bf16_f32 v114, v60, v61
    v_cvt_pk_bf16_f32 v115, v62, v63
    v_and_b32 v100, v108, v240
    v_and_b32 v101, v109, v241
    v_and_b32 v102, v110, v242
    v_and_b32 v103, v111, v243
    v_and_b32 v104, v112, v244
    v_and_b32 v105, v113, v245
    v_and_b32 v106, v114, v246
    v_and_b32 v107, v115, v247
    v_xor_b32 v108, v108, v100
    v_xor_b32 v109, v109, v101
    v_xor_b32 v110, v110, v102
    v_xor_b32 v111, v111, v103
    v_xor_b32 v112, v112, v104
    v_xor_b32 v113, v113, v105
    v_xor_b32 v114, v114, v106
    v_xor_b32 v115, v115, v107
    ds_read_b64_tr_b16 v[32:33], v250 offset:2048
    ds_read_b64_tr_b16 v[34:35], v250 offset:2080
    ds_read_b64_tr_b16 v[36:37], v250 offset:2176
    ds_read_b64_tr_b16 v[38:39], v250 offset:2208
    ds_read_b64_tr_b16 v[40:41], v250 offset:0
    ds_read_b64_tr_b16 v[42:43], v250 offset:32
    ds_read_b64_tr_b16 v[44:45], v250 offset:128
    ds_read_b64_tr_b16 v[46:47], v250 offset:160
    s_waitcnt lgkmcnt(6)
    v_mfma_f32_32x32x16_bf16 v[80:95], v[32:35], v[100:103], 0
    ds_read_b64_tr_b16 v[32:33], v250 offset:1792
    ds_read_b64_tr_b16 v[34:35], v250 offset:1824
    s_waitcnt lgkmcnt(6)
    v_mfma_f32_32x32x16_bf16 v[80:95], v[36:39], v[104:107], v[80:95]
    ds_read_b64_tr_b16 v[36:37], v250 offset:1920
    ds_read_b64_tr_b16 v[38:39], v250 offset:1952
    s_waitcnt lgkmcnt(6)
    v_mfma_f32_32x32x16_bf16 v[80:95], v[40:43], v[108:111], v[80:95]
    ds_read_b64_tr_b16 v[40:41], v250 offset:1536
    ds_read_b64_tr_b16 v[42:43], v250 offset:1568
    s_waitcnt lgkmcnt(6)
    v_mfma_f32_32x32x16_bf16 v[80:95], v[44:47], v[112:115], v[80:95]
    ds_read_b64_tr_b16 v[44:45], v250 offset:1664
    ds_read_b64_tr_b16 v[46:47], v250 offset:1696
    s_cmp_gt_u32 s13, 7
    s_cbranch_scc1 G_FIN
    s_waitcnt lgkmcnt(0)
    v_mfma_f32_32x32x16_bf16 v[48:63], v[224:227], v[216:219], 0
    v_exp_f32 v64, v64
    v_exp_f32 v65, v65
    v_exp_f32 v66, v66
    v_exp_f32 v67, v67
    v_exp_f32 v68, v68
    v_exp_f32 v69, v69
    v_exp_f32 v70, v70
    v_exp_f32 v71, v71
    v_mfma_f32_32x32x16_bf16 v[48:63], v[228:231], v[220:223], v[48:63]
    ds_read_b64 v[224:225], v248 offset:1280
    ds_read_b64 v[226:227], v248 offset:5376
    ds_read_b64 v[228:229], v249 offset:1280
    v_cvt_pk_bf16_f32 v116, v64, v65
    v_cvt_pk_bf16_f32 v117, v66, v67
    v_cvt_pk_bf16_f32 v118, v68, v69
    v_cvt_pk_bf16_f32 v119, v70, v71
    v_exp_f32 v72, v72
    v_exp_f32 v73, v73
    v_exp_f32 v74, v74
    v_exp_f32 v75, v75
    v_mfma_f32_32x32x16_bf16 v[80:95], v[32:35], v[116:119], v[80:95]
    ds_read_b64_tr_b16 v[32:33], v250 offset:1280
    ds_read_b64_tr_b16 v[34:35], v250 offset:1312
    v_exp_f32 v76, v76
    v_exp_f32 v77, v77
    v_exp_f32 v78, v78
    v_exp_f32 v79, v79
    v_cvt_pk_bf16_f32 v120, v72, v73
    v_cvt_pk_bf16_f32 v121, v74, v75
    v_cvt_pk_bf16_f32 v122, v76, v77
    v_cvt_pk_bf16_f32 v123, v78, v79
    s_nop 1
    v_mfma_f32_32x32x16_bf16 v[80:95], v[36:39], v[120:123], v[80:95]
    ds_read_b64_tr_b16 v[36:37], v250 offset:1408
    ds_read_b64_tr_b16 v[38:39], v250 offset:1440
    s_cmp_gt_u32 s13, 6
    s_cbranch_scc1 G_FIN
    s_waitcnt lgkmcnt(0)
    v_mfma_f32_32x32x16_bf16 v[64:79], v[224:227], v[216:219], 0
    v_exp_f32 v48, v48
    v_exp_f32 v49, v49
    v_exp_f32 v50, v50
    v_exp_f32 v51, v51
    v_exp_f32 v52, v52
    v_exp_f32 v53, v53
    v_exp_f32 v54, v54
    v_exp_f32 v55, v55
    v_mfma_f32_32x32x16_bf16 v[64:79], v[228:231], v[220:223], v[64:79]
    ds_read_b64 v[224:225], v248 offset:1024
    ds_read_b64 v[226:227], v248 offset:5120
    ds_read_b64 v[228:229], v249 offset:1024
    v_cvt_pk_bf16_f32 v124, v48, v49
    v_cvt_pk_bf16_f32 v125, v50, v51
    v_cvt_pk_bf16_f32 v126, v52, v53
    v_cvt_pk_bf16_f32 v127, v54, v55
    v_exp_f32 v56, v56
    v_exp_f32 v57, v57
    v_exp_f32 v58, v58
    v_exp_f32 v59, v59
    v_mfma_f32_32x32x16_bf16 v[80:95], v[40:43], v[124:127], v[80:95]
    ds_read_b64_tr_b16 v[40:41], v250 offset:1024
    ds_read_b64_tr_b16 v[42:43], v250 offset:1056
    v_exp_f32 v60, v60
    v_exp_f32 v61, v61
    v_exp_f32 v62, v62
    v_exp_f32 v63, v63
    v_cvt_pk_bf16_f32 v128, v56, v57
    v_cvt_pk_bf16_f32 v129, v58, v59
    v_cvt_pk_bf16_f32 v130, v60, v61
    v_cvt_pk_bf16_f32 v131, v62, v63
    s_nop 1
    v_mfma_f32_32x32x16_bf16 v[80:95], v[44:47], v[128:131], v[80:95]
    ds_read_b64_tr_b16 v[44:45], v250 offset:1152
    ds_read_b64_tr_b16 v[46:47], v250 offset:1184
    s_cmp_gt_u32 s13, 5
    s_cbranch_scc1 G_FIN
    s_waitcnt lgkmcnt(0)
    v_mfma_f32_32x32x16_bf16 v[48:63], v[224:227], v[216:219], 0
    v_exp_f32 v64, v64
    v_exp_f32 v65, v65
    v_exp_f32 v66, v66
    v_exp_f32 v67, v67
    v_exp_f32 v68, v68
    v_exp_f32 v69, v69
    v_exp_f32 v70, v70
    v_exp_f32 v71, v71
    v_mfma_f32_32x32x16_bf16 v[48:63], v[228:231], v[220:223], v[48:63]
    ds_read_b64 v[224:225], v248 offset:768
    ds_read_b64 v[226:227], v248 offset:4864
    ds_read_b64 v[228:229], v249 offset:768
    v_cvt_pk_bf16_f32 v132, v64, v65
    v_cvt_pk_bf16_f32 v133, v66, v67
    v_cvt_pk_bf16_f32 v134, v68, v69
    v_cvt_pk_bf16_f32 v135, v70, v71
    v_exp_f32 v72, v72
    v_exp_f32 v73, v73
    v_exp_f32 v74, v74
    v_exp_f32 v75, v75
    v_mfma_f32_32x32x16_bf16 v[80:95], v[32:35], v[132:135], v[80:95]
    ds_read_b64_tr_b16 v[32:33], v250 offset:768
    ds_read_b64_tr_b16 v[34:35], v250 offset:800
    v_exp_f32 v76, v76
    v_exp_f32 v77, v77
    v_exp_f32 v78, v78
    v_exp_f32 v79, v79
    v_cvt_pk_bf16_f32 v136, v72, v73
    v_cvt_pk_bf16_f32 v137, v74, v75
    v_cvt_pk_bf16_f32 v138, v76, v77
    v_cvt_pk_bf16_f32 v139, v78, v79
    s_nop 1
    v_mfma_f32_32x32x16_bf16 v[80:95], v[36:39], v[136:139], v[80:95]
    ds_read_b64_tr_b16 v[36:37], v250 offset:896
    ds_read_b64_tr_b16 v[38:39], v250 offset:928
    s_cmp_gt_u32 s13, 4
    s_cbranch_scc1 G_FIN
    s_waitcnt lgkmcnt(0)
    v_mfma_f32_32x32x16_bf16 v[64:79], v[224:227], v[216:219], 0
    v_exp_f32 v48, v48
    v_exp_f32 v49, v49
    v_exp_f32 v50, v50
    v_exp_f32 v51, v51
    v_exp_f32 v52, v52
    v_exp_f32 v53, v53
    v_exp_f32 v54, v54
    v_exp_f32 v55, v55
    v_mfma_f32_32x32x16_bf16 v[64:79], v[228:231], v[220:223], v[64:79]
    ds_read_b64 v[224:225], v248 offset:512
    ds_read_b64 v[226:227], v248 offset:4608
    ds_read_b64 v[228:229], v249 offset:512
    v_cvt_pk_bf16_f32 v140, v48, v49
    v_cvt_pk_bf16_f32 v141, v50, v51
    v_cvt_pk_bf16_f32 v142, v52, v53
    v_cvt_pk_bf16_f32 v143, v54, v55
    v_exp_f32 v56, v56
    v_exp_f32 v57, v57
    v_exp_f32 v58, v58
    v_exp_f32 v59, v59
    v_mfma_f32_32x32x16_bf16 v[80:95], v[40:43], v[140:143], v[80:95]
    ds_read_b64_tr_b16 v[40:41], v250 offset:512
    ds_read_b64_tr_b16 v[42:43], v250 offset:544
    v_exp_f32 v60, v60
    v_exp_f32 v61, v61
    v_exp_f32 v62, v62
    v_exp_f32 v63, v63
    v_cvt_pk_bf16_f32 v144, v56, v57
    v_cvt_pk_bf16_f32 v145, v58, v59
    v_cvt_pk_bf16_f32 v146, v60, v61
    v_cvt_pk_bf16_f32 v147, v62, v63
    s_nop 1
    v_mfma_f32_32x32x16_bf16 v[80:95], v[44:47], v[144:147], v[80:95]
    ds_read_b64_tr_b16 v[44:45], v250 offset:640
    ds_read_b64_tr_b16 v[46:47], v250 offset:672
    s_cmp_gt_u32 s13, 3
    s_cbranch_scc1 G_FIN
    s_waitcnt lgkmcnt(0)
    v_mfma_f32_32x32x16_bf16 v[48:63], v[224:227], v[216:219], 0
    v_exp_f32 v64, v64
    v_exp_f32 v65, v65
    v_exp_f32 v66, v66
    v_exp_f32 v67, v67
    v_exp_f32 v68, v68
    v_exp_f32 v69, v69
    v_exp_f32 v70, v70
    v_exp_f32 v71, v71
    v_mfma_f32_32x32x16_bf16 v[48:63], v[228:231], v[220:223], v[48:63]
    ds_read_b64 v[224:225], v248 offset:256
    ds_read_b64 v[226:227], v248 offset:4352
    ds_read_b64 v[228:229], v249 offset:256
    v_cvt_pk_bf16_f32 v148, v64, v65
    v_cvt_pk_bf16_f32 v149, v66, v67
    v_cvt_pk_bf16_f32 v150, v68, v69
    v_cvt_pk_bf16_f32 v151, v70, v71
    v_exp_f32 v72, v72
    v_exp_f32 v73, v73
    v_exp_f32 v74, v74
    v_exp_f32 v75, v75
    v_mfma_f32_32x32x16_bf16 v[80:95], v[32:35], v[148:151], v[80:95]
    ds_read_b64_tr_b16 v[32:33], v250 offset:256
    ds_read_b64_tr_b16 v[34:35], v250 offset:288
    v_exp_f32 v76, v76
    v_exp_f32 v77, v77
    v_exp_f32 v78, v78
    v_exp_f32 v79, v79
    v_cvt_pk_bf16_f32 v152, v72, v73
    v_cvt_pk_bf16_f32 v153, v74, v75
    v_cvt_pk_bf16_f32 v154, v76, v77
    v_cvt_pk_bf16_f32 v155, v78, v79
    s_nop 1
    v_mfma_f32_32x32x16_bf16 v[80:95], v[36:39], v[152:155], v[80:95]
    ds_read_b64_tr_b16 v[36:37], v250 offset:384
    ds_read_b64_tr_b16 v[38:39], v250 offset:416
    s_cmp_gt_u32 s13, 2
    s_cbranch_scc1 G_FIN
    s_waitcnt lgkmcnt(0)
    v_mfma_f32_32x32x16_bf16 v[64:79], v[224:227], v[216:219], 0
    v_exp_f32 v48, v48
    v_exp_f32 v49, v49
    v_exp_f32 v50, v50
    v_exp_f32 v51, v51
    v_exp_f32 v52, v52
    v_exp_f32 v53, v53
    v_exp_f32 v54, v54
    v_exp_f32 v55, v55
    v_mfma_f32_32x32x16_bf16 v[64:79], v[228:231], v[220:223], v[64:79]
    v_cvt_pk_bf16_f32 v156, v48, v49
    v_cvt_pk_bf16_f32 v157, v50, v51
    v_cvt_pk_bf16_f32 v158, v52, v53
    v_cvt_pk_bf16_f32 v159, v54, v55
    v_exp_f32 v56, v56
    v_exp_f32 v57, v57
    v_exp_f32 v58, v58
    v_exp_f32 v59, v59
    v_mfma_f32_32x32x16_bf16 v[80:95], v[40:43], v[156:159], v[80:95]
    v_exp_f32 v60, v60
    v_exp_f32 v61, v61
    v_exp_f32 v62, v62
    v_exp_f32 v63, v63
    v_cvt_pk_bf16_f32 v160, v56, v57
    v_cvt_pk_bf16_f32 v161, v58, v59
    v_cvt_pk_bf16_f32 v162, v60, v61
    v_cvt_pk_bf16_f32 v163, v62, v63
    s_nop 1
    v_mfma_f32_32x32x16_bf16 v[80:95], v[44:47], v[160:163], v[80:95]
    s_cmp_gt_u32 s13, 1
    s_cbranch_scc1 G_FIN
    s_waitcnt lgkmcnt(0)
    v_exp_f32 v64, v64
    v_exp_f32 v65, v65
    v_exp_f32 v66, v66
    v_exp_f32 v67, v67
    v_exp_f32 v68, v68
    v_exp_f32 v69, v69
    v_exp_f32 v70, v70
    v_exp_f32 v71, v71
    v_cvt_pk_bf16_f32 v164, v64, v65
    v_cvt_pk_bf16_f32 v165, v66, v67
    v_cvt_pk_bf16_f32 v166, v68, v69
    v_cvt_pk_bf16_f32 v167, v70, v71
    v_exp_f32 v72, v72
    v_exp_f32 v73, v73
    v_exp_f32 v74, v74
    v_exp_f32 v75, v75
    v_mfma_f32_32x32x16_bf16 v[80:95], v[32:35], v[164:167], v[80:95]
    v_exp_f32 v76, v76
    v_exp_f32 v77, v77
    v_exp_f32 v78, v78
    v_exp_f32 v79, v79
    v_cvt_pk_bf16_f32 v168, v72, v73
    v_cvt_pk_bf16_f32 v169, v74, v75
    v_cvt_pk_bf16_f32 v170, v76, v77
    v_cvt_pk_bf16_f32 v171, v78, v79
    s_nop 1
    v_mfma_f32_32x32x16_bf16 v[80:95], v[36:39], v[168:171], v[80:95]
G_FIN:
    s_waitcnt lgkmcnt(0)
    s_nop 12
    v_mov_b32 v14, s96
    v_mov_b32 v15, 0
    s_mov_b32 s48, 0x7b800000
    s_cmp_eq_u32 s32, 0
    v_rcp_f32 v96, v92
    s_nop 0
    v_pk_mul_f32 v[80:81], v[80:81], v[96:97] op_sel_hi:[1,0]
    v_pk_mul_f32 v[82:83], v[82:83], v[96:97] op_sel_hi:[1,0]
    v_pk_mul_f32 v[84:85], v[84:85], v[96:97] op_sel_hi:[1,0]
    v_pk_mul_f32 v[86:87], v[86:87], v[96:97] op_sel_hi:[1,0]
    v_pk_mul_f32 v[88:89], v[88:89], v[96:97] op_sel_hi:[1,0]
    v_pk_mul_f32 v[90:91], v[90:91], v[96:97] op_sel_hi:[1,0]
    v_cvt_pk_bf16_f32 v100, v80, v81
    v_cvt_pk_bf16_f32 v101, v82, v83
    v_cvt_pk_bf16_f32 v102, v84, v85
    v_cvt_pk_bf16_f32 v103, v86, v87
    v_cvt_pk_bf16_f32 v104, v88, v89
    v_cvt_pk_bf16_f32 v105, v90, v91
    s_cbranch_scc1 O_SC1G
    buffer_store_dwordx4 v[100:103], v251, s[24:27], 0 offen nt
    buffer_store_dwordx2 v[104:105], v252, s[24:27], 0 offen nt
    v_maximum3_f32 v98, |v80|, |v81|, |v82|
    v_maximum3_f32 v98, v98, |v83|, |v84|
    v_maximum3_f32 v98, v98, |v85|, |v86|
    v_maximum3_f32 v98, v98, |v87|, |v88|
    v_maximum3_f32 v98, v98, |v89|, |v90|
    v_maximum3_f32 v98, v98, |v91|, |v92|
    v_mul_f32 v99, 0x53800000, v96
    v_maximum3_f32 v98, v98, v99, v99
    v_cmp_ngt_f32 vcc, s48, v98
    s_cmp_lg_u32 s45, 0
    s_cselect_b64 vcc, 0, vcc
    s_nop 0
    s_cbranch_vccnz REDO
    s_waitcnt vmcnt(0)
    s_mov_b64 exec, 1
    buffer_store_dword v14, v15, s[24:27], s12 offen
O_DONEG:
    s_cmp_lt_u32 s6, 4
    s_cbranch_scc1 C_END
    s_branch OUTPROJ
SPEC_1:
    v_mov_b32 v236, v154
    v_mov_b32 v237, v155
    v_xor_b32 v238, v162, v152
    v_xor_b32 v239, v162, v153
    s_mov_b32 exec_lo, 0x00800080
    s_mov_b32 exec_hi, 0x00800080
    v_mov_b32 v154, 0
    v_mov_b32 v155, 0
    v_mov_b32 v238, 0
    v_mov_b32 v239, 0
    s_mov_b32 exec_lo, 0x80008000
    s_mov_b32 exec_hi, 0x80008000
    v_mov_b32 v152, 0
    v_mov_b32 v153, 0
    v_mov_b32 v236, 0
    v_mov_b32 v237, 0
    s_mov_b64 exec, -1
    s_nop 0
    v_mfma_f32_16x16x32_bf16 v[240:243], v[158:161], v[236:239], 0
    s_nop 7
    v_mov_b32_dpp v244, v240 row_ror:8 row_mask:0xf bank_mask:0xf
    v_mov_b32_dpp v245, v241 row_ror:8 row_mask:0xf bank_mask:0xf
    v_mov_b32_dpp v246, v242 row_ror:8 row_mask:0xf bank_mask:0xf
    v_mov_b32_dpp v247, v243 row_ror:8 row_mask:0xf bank_mask:0xf
    v_cvt_pk_bf16_f32 v244, v240, v244
    v_cvt_pk_bf16_f32 v245, v241, v245
    v_cvt_pk_bf16_f32 v246, v242, v246
    v_cvt_pk_bf16_f32 v247, v243, v247
    s_mov_b32 exec_lo, 0x00800080
    s_mov_b32 exec_hi, 0x00800080
    ds_write_b128 v169, v[244:247] offset:28752
    s_mov_b64 exec, -1
    s_waitcnt lgkmcnt(0)
    s_branch SPEC_1R
C_STB_SC1:
    s_waitcnt lgkmcnt(6)
    v_mfma_f32_16x16x32_bf16 v[172:175], v[204:207], v[140:143], v[172:175]
    ds_read_b64_tr_b16 v[220:221], v7 offset:32768
    v_mfma_f32_16x16x32_bf16 v[176:179], v[204:207], v[144:147], v[176:179]
    ds_read_b64_tr_b16 v[222:223], v7 offset:33280
    s_waitcnt lgkmcnt(6)
    v_mfma_f32_16x16x32_bf16 v[172:175], v[208:211], v[148:151], v[172:175]
    ds_read_b64_tr_b16 v[224:225], v7 offset:36864
    v_mfma_f32_16x16x32_bf16 v[176:179], v[208:211], v[152:155], v[176:179]
    ds_read_b64_tr_b16 v[226:227], v7 offset:37376
    s_waitcnt lgkmcnt(6)
    v_mfma_f32_16x16x32_bf16 v[172:175], v[212:215], v[156:159], v[172:175]
    ds_read_b64_tr_b16 v[228:229], v7 offset:40960
    v_mfma_f32_16x16x32_bf16 v[176:179], v[212:215], v[160:163], v[176:179]
    ds_read_b64_tr_b16 v[230:231], v7 offset:41472
    s_waitcnt lgkmcnt(6)
    v_mfma_f32_16x16x32_bf16 v[172:175], v[216:219], v[164:167], v[172:175]
    ds_read_b64_tr_b16 v[232:233], v7 offset:45056
    v_mfma_f32_16x16x32_bf16 v[176:179], v[216:219], v[168:171], v[176:179]
    ds_read_b64_tr_b16 v[234:235], v7 offset:45568
    s_waitcnt lgkmcnt(6)
    v_mfma_f32_16x16x32_bf16 v[180:183], v[220:223], v[140:143], v[180:183]
    ds_read_b64_tr_b16 v[204:205], v8 offset:32768
    v_mfma_f32_16x16x32_bf16 v[184:187], v[220:223], v[144:147], v[184:187]
    ds_read_b64_tr_b16 v[206:207], v8 offset:33280
    s_waitcnt lgkmcnt(6)
    v_mfma_f32_16x16x32_bf16 v[180:183], v[224:227], v[148:151], v[180:183]
    ds_read_b64_tr_b16 v[208:209], v8 offset:36864
    v_mfma_f32_16x16x32_bf16 v[184:187], v[224:227], v[152:155], v[184:187]
    ds_read_b64_tr_b16 v[210:211], v8 offset:37376
    v_cvt_pk_bf16_f32 v236, v172, v173
    v_cvt_pk_bf16_f32 v237, v174, v175
    s_waitcnt lgkmcnt(6)
    v_mfma_f32_16x16x32_bf16 v[180:183], v[228:231], v[156:159], v[180:183]
    ds_read_b64_tr_b16 v[212:213], v8 offset:40960
    v_cvt_pk_bf16_f32 v238, v176, v177
    v_cvt_pk_bf16_f32 v239, v178, v179
    v_mfma_f32_16x16x32_bf16 v[184:187], v[228:231], v[160:163], v[184:187]
    ds_read_b64_tr_b16 v[214:215], v8 offset:41472
    buffer_store_dwordx4 v[236:239], v10, s[24:27], s46 offen sc1
    s_add_u32 s46, s46, 66560
    s_waitcnt lgkmcnt(6)
    v_mfma_f32_16x16x32_bf16 v[180:183], v[232:235], v[164:167], v[180:183]
    ds_read_b64_tr_b16 v[216:217], v8 offset:45056
    v_mfma_f32_16x16x32_bf16 v[184:187], v[232:235], v[168:171], v[184:187]
    ds_read_b64_tr_b16 v[218:219], v8 offset:45568
    s_waitcnt lgkmcnt(6)
    v_mfma_f32_16x16x32_bf16 v[188:191], v[204:207], v[140:143], v[188:191]
    ds_read_b64_tr_b16 v[220:221], v9 offset:32768
    v_mfma_f32_16x16x32_bf16 v[192:195], v[204:207], v[144:147], v[192:195]
    ds_read_b64_tr_b16 v[222:223], v9 offset:33280
    s_waitcnt lgkmcnt(6)
    v_mfma_f32_16x16x32_bf16 v[188:191], v[208:211], v[148:151], v[188:191]
    ds_read_b64_tr_b16 v[224:225], v9 offset:36864
    v_mfma_f32_16x16x32_bf16 v[192:195], v[208:211], v[152:155], v[192:195]
    ds_read_b64_tr_b16 v[226:227], v9 offset:37376
    v_cvt_pk_bf16_f32 v240, v180, v181
    v_cvt_pk_bf16_f32 v241, v182, v183
    s_waitcnt lgkmcnt(6)
    v_mfma_f32_16x16x32_bf16 v[188:191], v[212:215], v[156:159], v[188:191]
    ds_read_b64_tr_b16 v[228:229], v9 offset:40960
    v_cvt_pk_bf16_f32 v242, v184, v185
    v_cvt_pk_bf16_f32 v243, v186, v187
    v_mfma_f32_16x16x32_bf16 v[192:195], v[212:215], v[160:163], v[192:195]
    ds_read_b64_tr_b16 v[230:231], v9 offset:41472
    buffer_store_dwordx4 v[240:243], v10, s[24:27], s46 offen sc1
    s_add_u32 s46, s46, 66560
    s_waitcnt lgkmcnt(6)
    v_mfma_f32_16x16x32_bf16 v[188:191], v[216:219], v[164:167], v[188:191]
    ds_read_b64_tr_b16 v[232:233], v9 offset:45056
    v_mfma_f32_16x16x32_bf16 v[192:195], v[216:219], v[168:171], v[192:195]
    ds_read_b64_tr_b16 v[234:235], v9 offset:45568
    s_waitcnt lgkmcnt(6)
    v_mfma_f32_16x16x32_bf16 v[196:199], v[220:223], v[140:143], v[196:199]
    v_mfma_f32_16x16x32_bf16 v[200:203], v[220:223], v[144:147], v[200:203]
    s_waitcnt lgkmcnt(4)
    v_mfma_f32_16x16x32_bf16 v[196:199], v[224:227], v[148:151], v[196:199]
    v_mfma_f32_16x16x32_bf16 v[200:203], v[224:227], v[152:155], v[200:203]
    v_cvt_pk_bf16_f32 v244, v188, v189
    v_cvt_pk_bf16_f32 v245, v190, v191
    s_waitcnt lgkmcnt(2)
    v_mfma_f32_16x16x32_bf16 v[196:199], v[228:231], v[156:159], v[196:199]
    v_cvt_pk_bf16_f32 v246, v192, v193
    v_cvt_pk_bf16_f32 v247, v194, v195
    v_mfma_f32_16x16x32_bf16 v[200:203], v[228:231], v[160:163], v[200:203]
    buffer_store_dwordx4 v[244:247], v10, s[24:27], s46 offen sc1
    s_add_u32 s46, s46, 66560
    s_waitcnt lgkmcnt(0)
    v_mfma_f32_16x16x32_bf16 v[196:199], v[232:235], v[164:167], v[196:199]
    v_mfma_f32_16x16x32_bf16 v[200:203], v[232:235], v[168:171], v[200:203]
    s_nop 6
    v_cvt_pk_bf16_f32 v248, v196, v197
    v_cvt_pk_bf16_f32 v249, v198, v199
    v_cvt_pk_bf16_f32 v250, v200, v201
    v_cvt_pk_bf16_f32 v251, v202, v203
    buffer_store_dwordx4 v[248:251], v10, s[24:27], s46 offen sc1
    s_branch C_STB_DONE
SPEC_2:
    v_mov_b32 v236, v154
    v_mov_b32 v237, v155
    v_xor_b32 v238, v162, v152
    v_xor_b32 v239, v162, v153
    s_mov_b32 exec_lo, 0x00800080
    s_mov_b32 exec_hi, 0x00800080
    v_mov_b32 v154, 0
    v_mov_b32 v155, 0
    v_mov_b32 v238, 0
    v_mov_b32 v239, 0
    s_mov_b32 exec_lo, 0x80008000
    s_mov_b32 exec_hi, 0x80008000
    v_mov_b32 v152, 0
    v_mov_b32 v153, 0
    v_mov_b32 v236, 0
    v_mov_b32 v237, 0
    s_mov_b64 exec, -1
    s_nop 0
    v_mfma_f32_16x16x32_bf16 v[240:243], v[158:161], v[236:239], 0
    s_nop 7
    v_mov_b32_dpp v244, v240 row_ror:8 row_mask:0xf bank_mask:0xf
    v_mov_b32_dpp v245, v241 row_ror:8 row_mask:0xf bank_mask:0xf
    v_mov_b32_dpp v246, v242 row_ror:8 row_mask:0xf bank_mask:0xf
    v_mov_b32_dpp v247, v243 row_ror:8 row_mask:0xf bank_mask:0xf
    v_cvt_pk_bf16_f32 v244, v240, v244
    v_cvt_pk_bf16_f32 v245, v241, v245
    v_cvt_pk_bf16_f32 v246, v242, v246
    v_cvt_pk_bf16_f32 v247, v243, v247
    s_mov_b32 exec_lo, 0x00800080
    s_mov_b32 exec_hi, 0x00800080
    ds_write_b128 v169, v[244:247] offset:28752
    s_mov_b64 exec, -1
    s_waitcnt lgkmcnt(0)
    s_branch SPEC_2R
SPUBC:
    buffer_load_dword v2, v11, s[24:27], 0 offen sc1
    s_waitcnt vmcnt(0)
    v_cmp_ne_u32 vcc, s97, v2
    s_nop 1
    s_cmp_eq_u64 vcc, 0
    s_cselect_b32 s32, 1, 0
    s_branch SPUBRC
G0MAXC:
    s_waitcnt lgkmcnt(0)
    v_mfma_f32_32x32x16_bf16 v[64:79], v[224:227], v[216:219], 0
    v_mfma_f32_32x32x16_bf16 v[64:79], v[228:231], v[220:223], v[64:79]
    s_nop 11
    v_max3_f32 v96, v96, v64, v65
    v_max3_f32 v96, v96, v66, v67
    v_max3_f32 v96, v96, v68, v69
    v_max3_f32 v96, v96, v70, v71
    v_max3_f32 v96, v96, v72, v73
    v_max3_f32 v96, v96, v74, v75
    v_max3_f32 v96, v96, v76, v77
    v_max3_f32 v96, v96, v78, v79
    s_branch G0RETC
O_SC1C:
    buffer_store_dwordx4 v[100:103], v251, s[24:27], 0 offen sc1
    buffer_store_dwordx2 v[104:105], v252, s[24:27], 0 offen sc1
    v_maximum3_f32 v98, |v80|, |v81|, |v82|
    v_maximum3_f32 v98, v98, |v83|, |v84|
    v_maximum3_f32 v98, v98, |v85|, |v86|
    v_maximum3_f32 v98, v98, |v87|, |v88|
    v_maximum3_f32 v98, v98, |v89|, |v90|
    v_maximum3_f32 v98, v98, |v91|, |v92|
    v_mul_f32 v99, 0x53800000, v96
    v_maximum3_f32 v98, v98, v99, v99
    v_cmp_ngt_f32 vcc, s48, v98
    s_nop 0
    s_cbranch_vccnz REDO
    s_waitcnt vmcnt(0)
    s_mov_b64 exec, 1
    buffer_store_dword v14, v15, s[24:27], s12 offen sc1
    s_branch O_DONEC
SPUBL:
    buffer_load_dword v2, v13, s[24:27], 0 offen sc1
    s_waitcnt vmcnt(0)
    v_cmp_ne_u32 vcc, s97, v2
    s_nop 1
    s_cmp_eq_u64 vcc, 0
    s_cselect_b32 s32, 1, 0
    s_branch SPUBRL
V_EARLY:
    s_lshl_b32 s48, s7, 10
    s_add_u32 m0, s48, 20480
    s_nop 0
    buffer_load_dwordx4 v253, s[24:27], s61 offen sc1 lds
    s_add_u32 s61, s61, 16640
    s_add_u32 m0, s48, 24608
    s_nop 0
    buffer_load_dwordx4 v253, s[24:27], s61 offen sc1 lds
    s_add_u32 s61, s61, 16640
    s_add_u32 m0, s48, 28736
    s_nop 0
    buffer_load_dwordx4 v253, s[24:27], s61 offen sc1 lds
    s_add_u32 s61, s61, 16640
    s_add_u32 m0, s48, 32864
    s_nop 0
    buffer_load_dwordx4 v253, s[24:27], s61 offen sc1 lds
    s_add_u32 s61, s61, 16640
    s_add_u32 m0, s48, 36992
    s_nop 0
    buffer_load_dwordx4 v253, s[24:27], s61 offen sc1 lds
    s_branch V_EARLY_RET
G0MAXL:
    s_waitcnt lgkmcnt(0)
    v_mfma_f32_32x32x16_bf16 v[64:79], v[224:227], v[216:219], 0
    v_mfma_f32_32x32x16_bf16 v[64:79], v[228:231], v[220:223], v[64:79]
    s_nop 11
    v_max3_f32 v96, v96, v64, v65
    v_max3_f32 v96, v96, v66, v67
    v_max3_f32 v96, v96, v68, v69
    v_max3_f32 v96, v96, v70, v71
    v_max3_f32 v96, v96, v72, v73
    v_max3_f32 v96, v96, v74, v75
    v_max3_f32 v96, v96, v76, v77
    v_max3_f32 v96, v96, v78, v79
    s_branch G0RETL
V_LATE:
    s_mov_b32 s50, 200000
    s_waitcnt vmcnt(1)
    s_branch SC_32
SP_31:
    buffer_load_dword v14, v15, s[24:27], 0 offen sc1
    s_waitcnt vmcnt(0)
SC_32:
    v_cmp_ne_u32 vcc, s96, v14
    s_sub_u32 s50, s50, 1
    s_cbranch_scc1 SD_33
    s_cbranch_vccnz SP_31
SD_33:
    s_lshl_b32 s48, s7, 10
    s_add_u32 m0, s48, 20480
    s_nop 0
    buffer_load_dwordx4 v253, s[24:27], s61 offen sc1 lds
    s_add_u32 s61, s61, 16640
    s_add_u32 m0, s48, 24608
    s_nop 0
    buffer_load_dwordx4 v253, s[24:27], s61 offen sc1 lds
    s_add_u32 s61, s61, 16640
    s_add_u32 m0, s48, 28736
    s_nop 0
    buffer_load_dwordx4 v253, s[24:27], s61 offen sc1 lds
    s_add_u32 s61, s61, 16640
    s_add_u32 m0, s48, 32864
    s_nop 0
    buffer_load_dwordx4 v253, s[24:27], s61 offen sc1 lds
    s_add_u32 s61, s61, 16640
    s_add_u32 m0, s48, 36992
    s_nop 0
    buffer_load_dwordx4 v253, s[24:27], s61 offen sc1 lds
    s_branch V_LATE_RET
O_SC1L:
    buffer_store_dwordx4 v[100:103], v251, s[24:27], 0 offen sc1
    buffer_store_dwordx2 v[104:105], v252, s[24:27], 0 offen sc1
    v_maximum3_f32 v98, |v80|, |v81|, |v82|
    v_maximum3_f32 v98, v98, |v83|, |v84|
    v_maximum3_f32 v98, v98, |v85|, |v86|
    v_maximum3_f32 v98, v98, |v87|, |v88|
    v_maximum3_f32 v98, v98, |v89|, |v90|
    v_maximum3_f32 v98, v98, |v91|, |v92|
    v_mul_f32 v99, 0x53800000, v96
    v_maximum3_f32 v98, v98, v99, v99
    v_cmp_ngt_f32 vcc, s48, v98
    s_nop 0
    s_cbranch_vccnz REDO
    s_waitcnt vmcnt(0)
    s_mov_b64 exec, 1
    buffer_store_dword v14, v15, s[24:27], s12 offen sc1
    s_branch O_DONEL
BUMP:
    v_mov_b32 v30, s96
    v_mov_b32 v31, 12588800
    s_mov_b64 exec, 1
    buffer_store_dword v30, v31, s[24:27], 0 offen sc1
    s_mov_b64 exec, -1
    s_branch BUMP_RET
O_SC1G:
    buffer_store_dwordx4 v[100:103], v251, s[24:27], 0 offen sc1
    buffer_store_dwordx2 v[104:105], v252, s[24:27], 0 offen sc1
    v_maximum3_f32 v98, |v80|, |v81|, |v82|
    v_maximum3_f32 v98, v98, |v83|, |v84|
    v_maximum3_f32 v98, v98, |v85|, |v86|
    v_maximum3_f32 v98, v98, |v87|, |v88|
    v_maximum3_f32 v98, v98, |v89|, |v90|
    v_maximum3_f32 v98, v98, |v91|, |v92|
    v_mul_f32 v99, 0x53800000, v96
    v_maximum3_f32 v98, v98, v99, v99
    v_cmp_ngt_f32 vcc, s48, v98
    s_cmp_lg_u32 s45, 0
    s_cselect_b64 vcc, 0, vcc
    s_nop 0
    s_cbranch_vccnz REDO
    s_waitcnt vmcnt(0)
    s_mov_b64 exec, 1
    buffer_store_dword v14, v15, s[24:27], s12 offen sc1
    s_branch O_DONEG
END:
    s_endpgm
.p2align 7
.type TAB,@object
TAB:
.long 0xffff,0x0,0x0,0x0,0xffffffff,0xffff,0x0,0x0
.long 0xffffffff,0xffffffff,0xffff,0x0,0xffffffff,0xffffffff,0xffffffff,0xffff
.long 0xffffffff,0xffffffff,0xffffffff,0xffffffff,0xffffffff,0xffffffff,0xffffffff,0xffffffff
.long 0xffffffff,0xffffffff,0xffffffff,0xffffffff,0xffffffff,0xffffffff,0xffffffff,0xffffffff
.long 0xffffffff,0xffffffff,0xffffffff,0xffffffff,0xffffffff,0xffffffff,0xffffffff,0xffffffff
.long 0xffffffff,0xffffffff,0xffffffff,0xffffffff,0xffffffff,0xffffffff,0xffffffff,0xffffffff
.long 0xffffffff,0xffffffff,0xffffffff,0xffffffff,0xffffffff,0xffffffff,0xffffffff,0xffffffff
.long 0xffffffff,0xffffffff,0xffffffff,0xffffffff,0xffffffff,0xffffffff,0xffffffff,0xffffffff
.long 0xffffffff,0x0,0x0,0x0,0xffffffff,0xffffffff,0x0,0x0
.long 0xffffffff,0xffffffff,0xffffffff,0x0,0xffffffff,0xffffffff,0xffffffff,0xffffffff
.long 0xffffffff,0xffffffff,0xffffffff,0xffffffff,0xffffffff,0xffffffff,0xffffffff,0xffffffff
.long 0xffffffff,0xffffffff,0xffffffff,0xffffffff,0xffffffff,0xffffffff,0xffffffff,0xffffffff
.long 0xffffffff,0xffffffff,0xffffffff,0xffffffff,0xffffffff,0xffffffff,0xffffffff,0xffffffff
.long 0xffffffff,0xffffffff,0xffffffff,0xffffffff,0xffffffff,0xffffffff,0xffffffff,0xffffffff
.long 0xffffffff,0xffffffff,0xffffffff,0xffffffff,0xffffffff,0xffffffff,0xffffffff,0xffffffff
.long 0xffffffff,0xffffffff,0xffffffff,0xffffffff,0xffffffff,0xffffffff,0xffffffff,0xffffffff
.long 0x0,0x0,0x0,0x0,0x0,0x0,0x0,0x0
.long 0x0,0x0,0x0,0x0,0x0,0x0,0x0,0x0
.long 0xffff,0x0,0x0,0x0,0xffffffff,0xffff,0x0,0x0
.long 0xffffffff,0xffffffff,0xffff,0x0,0xffffffff,0xffffffff,0xffffffff,0xffff
.long 0xffffffff,0xffffffff,0xffffffff,0xffffffff,0xffffffff,0xffffffff,0xffffffff,0xffffffff
.long 0xffffffff,0xffffffff,0xffffffff,0xffffffff,0xffffffff,0xffffffff,0xffffffff,0xffffffff
.long 0xffffffff,0xffffffff,0xffffffff,0xffffffff,0xffffffff,0xffffffff,0xffffffff,0xffffffff
.long 0xffffffff,0xffffffff,0xffffffff,0xffffffff,0xffffffff,0xffffffff,0xffffffff,0xffffffff
.long 0x0,0x0,0x0,0x0,0x0,0x0,0x0,0x0
.long 0x0,0x0,0x0,0x0,0x0,0x0,0x0,0x0
.long 0xffffffff,0x0,0x0,0x0,0xffffffff,0xffffffff,0x0,0x0
.long 0xffffffff,0xffffffff,0xffffffff,0x0,0xffffffff,0xffffffff,0xffffffff,0xffffffff
.long 0xffffffff,0xffffffff,0xffffffff,0xffffffff,0xffffffff,0xffffffff,0xffffffff,0xffffffff
.long 0xffffffff,0xffffffff,0xffffffff,0xffffffff,0xffffffff,0xffffffff,0xffffffff,0xffffffff
.long 0xffffffff,0xffffffff,0xffffffff,0xffffffff,0xffffffff,0xffffffff,0xffffffff,0xffffffff
.long 0xffffffff,0xffffffff,0xffffffff,0xffffffff,0xffffffff,0xffffffff,0xffffffff,0xffffffff
.long 0x0,0x0,0x0,0x0,0x0,0x0,0x0,0x0
.long 0x0,0x0,0x0,0x0,0x0,0x0,0x0,0x0
.long 0x0,0x0,0x0,0x0,0x0,0x0,0x0,0x0
.long 0x0,0x0,0x0,0x0,0x0,0x0,0x0,0x0
.long 0xffff,0x0,0x0,0x0,0xffffffff,0xffff,0x0,0x0
.long 0xffffffff,0xffffffff,0xffff,0x0,0xffffffff,0xffffffff,0xffffffff,0xffff
.long 0xffffffff,0xffffffff,0xffffffff,0xffffffff,0xffffffff,0xffffffff,0xffffffff,0xffffffff
.long 0xffffffff,0xffffffff,0xffffffff,0xffffffff,0xffffffff,0xffffffff,0xffffffff,0xffffffff
.long 0x0,0x0,0x0,0x0,0x0,0x0,0x0,0x0
.long 0x0,0x0,0x0,0x0,0x0,0x0,0x0,0x0
.long 0x0,0x0,0x0,0x0,0x0,0x0,0x0,0x0
.long 0x0,0x0,0x0,0x0,0x0,0x0,0x0,0x0
.long 0xffffffff,0x0,0x0,0x0,0xffffffff,0xffffffff,0x0,0x0
.long 0xffffffff,0xffffffff,0xffffffff,0x0,0xffffffff,0xffffffff,0xffffffff,0xffffffff
.long 0xffffffff,0xffffffff,0xffffffff,0xffffffff,0xffffffff,0xffffffff,0xffffffff,0xffffffff
.long 0xffffffff,0xffffffff,0xffffffff,0xffffffff,0xffffffff,0xffffffff,0xffffffff,0xffffffff
.long 0x0,0x0,0x0,0x0,0x0,0x0,0x0,0x0
.long 0x0,0x0,0x0,0x0,0x0,0x0,0x0,0x0
.long 0x0,0x0,0x0,0x0,0x0,0x0,0x0,0x0
.long 0x0,0x0,0x0,0x0,0x0,0x0,0x0,0x0
.long 0x0,0x0,0x0,0x0,0x0,0x0,0x0,0x0
.long 0x0,0x0,0x0,0x0,0x0,0x0,0x0,0x0
.long 0xffff,0x0,0x0,0x0,0xffffffff,0xffff,0x0,0x0
.long 0xffffffff,0xffffffff,0xffff,0x0,0xffffffff,0xffffffff,0xffffffff,0xffff
.long 0x0,0x0,0x0,0x0,0x0,0x0,0x0,0x0
.long 0x0,0x0,0x0,0x0,0x0,0x0,0x0,0x0
.long 0x0,0x0,0x0,0x0,0x0,0x0,0x0,0x0
.long 0x0,0x0,0x0,0x0,0x0,0x0,0x0,0x0
.long 0x0,0x0,0x0,0x0,0x0,0x0,0x0,0x0
.long 0x0,0x0,0x0,0x0,0x0,0x0,0x0,0x0
.long 0xffffffff,0x0,0x0,0x0,0xffffffff,0xffffffff,0x0,0x0
.long 0xffffffff,0xffffffff,0xffffffff,0x0,0xffffffff,0xffffffff,0xffffffff,0xffffffff
.long 0x0,0x4000,0x5000,0x0,0x8,0x4008,0x8060,0x10
.long 0x10,0x4010,0x6020,0x20,0x18,0x4018,0x7040,0x30
.long 0x40,0x4040,0x5008,0x40,0x48,0x4048,0x8068,0x50
.long 0x50,0x4050,0x6028,0x60,0x58,0x4058,0x7048,0x70
.long 0x20,0x4020,0x5010,0x80,0x28,0x4028,0x8070,0x90
.long 0x30,0x4030,0x6030,0xa0,0x38,0x4038,0x7050,0xb0
.long 0x60,0x4060,0x5018,0xc0,0x68,0x4068,0x8078,0xd0
.long 0x70,0x4070,0x6038,0xe0,0x78,0x4078,0x7058,0xf0
.long 0x80,0x4080,0x9080,0x4100,0x88,0x4088,0xa0a0,0x4110
.long 0x90,0x4090,0xa0a0,0x4120,0x98,0x4098,0xa0a0,0x4130
.long 0xc0,0x40c0,0x9088,0x4140,0xc8,0x40c8,0xa0a8,0x4150
.long 0xd0,0x40d0,0xa0a8,0x4160,0xd8,0x40d8,0xa0a8,0x4170
.long 0xa0,0x40a0,0x9090,0x4180,0xa8,0x40a8,0xa0b0,0x4190
.long 0xb0,0x40b0,0xa0b0,0x41a0,0xb8,0x40b8,0xa0b0,0x41b0
.long 0xe0,0x40e0,0x9098,0x41c0,0xe8,0x40e8,0xa0b8,0x41d0
.long 0xf0,0x40f0,0xa0b8,0x41e0,0xf8,0x40f8,0xa0b8,0x41f0
.long 0x2000,0x4000,0x5040,0x8200,0x2008,0x4008,0x80a0,0x8210
.long 0x2010,0x4010,0x6060,0x8220,0x2018,0x4018,0x7080,0x8230
.long 0x2040,0x4040,0x5048,0x8240,0x2048,0x4048,0x80a8,0x8250
.long 0x2050,0x4050,0x6068,0x8260,0x2058,0x4058,0x7088,0x8270
.long 0x2020,0x4020,0x5050,0x8280,0x2028,0x4028,0x80b0,0x8290
.long 0x2030,0x4030,0x6070,0x82a0,0x2038,0x4038,0x7090,0x82b0
.long 0x2060,0x4060,0x5058,0x82c0,0x2068,0x4068,0x80b8,0x82d0
.long 0x2070,0x4070,0x6078,0x82e0,0x2078,0x4078,0x7098,0x82f0
.long 0x2080,0x4080,0x90c0,0xc300,0x2088,0x4088,0xa0e0,0xc310
.long 0x2090,0x4090,0xa0e0,0xc320,0x2098,0x4098,0xa0e0,0xc330
.long 0x20c0,0x40c0,0x90c8,0xc340,0x20c8,0x40c8,0xa0e8,0xc350
.long 0x20d0,0x40d0,0xa0e8,0xc360,0x20d8,0x40d8,0xa0e8,0xc370
.long 0x20a0,0x40a0,0x90d0,0xc380,0x20a8,0x40a8,0xa0f0,0xc390
.long 0x20b0,0x40b0,0xa0f0,0xc3a0,0x20b8,0x40b8,0xa0f0,0xc3b0
.long 0x20e0,0x40e0,0x90d8,0xc3c0,0x20e8,0x40e8,0xa0f8,0xc3d0
.long 0x20f0,0x40f0,0xa0f8,0xc3e0,0x20f8,0x40f8,0xa0f8,0xc3f0
.long 0x10400,0x100,0x10400,0x0,0x10408,0x100,0x10410,0x0
.long 0x10410,0x100,0x10420,0x0,0x10418,0x100,0x10430,0x0
.long 0x10420,0x100,0x10440,0x0,0x10428,0x100,0x10450,0x0
.long 0x10430,0x100,0x10460,0x0,0x10438,0x100,0x10470,0x0
.long 0x10440,0x100,0x10480,0x0,0x10448,0x100,0x10490,0x0
.long 0x10450,0x100,0x104a0,0x0,0x10458,0x100,0x104b0,0x0
.long 0x10460,0x100,0x104c0,0x0,0x10468,0x100,0x104d0,0x0
.long 0x10470,0x100,0x104e0,0x0,0x10478,0x100,0x104f0,0x0
.long 0x10480,0x100,0x10408,0x0,0x10488,0x0,0x10418,0x0
.long 0x10490,0x0,0x10428,0x0,0x10498,0x0,0x10438,0x0
.long 0x104a0,0x100,0x10448,0x0,0x104a8,0x0,0x10458,0x0
.long 0x104b0,0x0,0x10468,0x0,0x104b8,0x0,0x10478,0x0
.long 0x104c0,0x100,0x10488,0x0,0x104c8,0x0,0x10498,0x0
.long 0x104d0,0x0,0x104a8,0x0,0x104d8,0x0,0x104b8,0x0
.long 0x104e0,0x100,0x104c8,0x0,0x104e8,0x0,0x104d8,0x0
.long 0x104f0,0x0,0x104e8,0x0,0x104f8,0x0,0x104f8,0x0
.long 0x40010400,0x100,0x40010400,0x0,0x40010408,0x100,0x40010410,0x0
.long 0x40010410,0x100,0x40010420,0x0,0x40010418,0x100,0x40010430,0x0
.long 0x40010420,0x100,0x40010440,0x0,0x40010428,0x100,0x40010450,0x0
.long 0x40010430,0x100,0x40010460,0x0,0x40010438,0x100,0x40010470,0x0
.long 0x40010440,0x100,0x40010480,0x0,0x40010448,0x100,0x40010490,0x0
.long 0x40010450,0x100,0x400104a0,0x0,0x40010458,0x100,0x400104b0,0x0
.long 0x40010460,0x100,0x400104c0,0x0,0x40010468,0x100,0x400104d0,0x0
.long 0x40010470,0x100,0x400104e0,0x0,0x40010478,0x100,0x400104f0,0x0
.long 0x40010480,0x100,0x40010408,0x0,0x40010488,0x0,0x40010418,0x0
.long 0x40010490,0x0,0x40010428,0x0,0x40010498,0x0,0x40010438,0x0
.long 0x400104a0,0x100,0x40010448,0x0,0x400104a8,0x0,0x40010458,0x0
.long 0x400104b0,0x0,0x40010468,0x0,0x400104b8,0x0,0x40010478,0x0
.long 0x400104c0,0x100,0x40010488,0x0,0x400104c8,0x0,0x40010498,0x0
.long 0x400104d0,0x0,0x400104a8,0x0,0x400104d8,0x0,0x400104b8,0x0
.long 0x400104e0,0x100,0x400104c8,0x0,0x400104e8,0x0,0x400104d8,0x0
.long 0x400104f0,0x0,0x400104e8,0x0,0x400104f8,0x0,0x400104f8,0x0
.long 0x80003f80,0x80003f80,0x80003f80,0x80003f80,0x80003f80,0xbe483f7b,0xbec43f6d,0xbf0e3f55
.long 0x80003f80,0xbec43f6d,0xbf353f35,0xbf6d3ec4,0x80003f80,0xbf0e3f55,0xbf6d3ec4,0xbf7bbe48
.long 0x80003f80,0xbf353f35,0xbf80248d,0xbf35bf35,0x80003f80,0xbf553f0e,0xbf6dbec4,0xbe48bf7b
.long 0x80003f80,0xbf6d3ec4,0xbf35bf35,0x3ec4bf6d,0x80003f80,0xbf7b3e48,0xbec4bf6d,0x3f55bf0e
.long 0x80003f80,0xbf80248d,0xa50dbf80,0x3f80a554,0x80003f80,0xbf7bbe48,0x3ec4bf6d,0x3f553f0e
.long 0x80003f80,0xbf6dbec4,0x3f35bf35,0x3ec43f6d,0x80003f80,0xbf55bf0e,0x3f6dbec4,0xbe483f7b
.long 0x80003f80,0xbf35bf35,0x3f80a554,0xbf353f35,0x80003f80,0xbf0ebf55,0x3f6d3ec4,0xbf7b3e48
.long 0x80003f80,0xbec4bf6d,0x3f353f35,0xbf6dbec4,0x80003f80,0xbe48bf7b,0x3ec43f6d,0xbf0ebf55
.long 0x80003f80,0xa50dbf80,0x80003f80,0xa50dbf80,0x80003f80,0x3e48bf7b,0xbec43f6d,0x3f0ebf55
.long 0x80003f80,0x3ec4bf6d,0xbf353f35,0x3f6dbec4,0x80003f80,0x3f0ebf55,0xbf6d3ec4,0x3f7b3e48
.long 0x80003f80,0x3f35bf35,0xbf80248d,0x3f353f35,0x80003f80,0x3f55bf0e,0xbf6dbec4,0x3e483f7b
.long 0x80003f80,0x3f6dbec4,0xbf35bf35,0xbec43f6d,0x80003f80,0x3f7bbe48,0xbec4bf6d,0xbf553f0e
.long 0x80003f80,0x3f80a554,0xa50dbf80,0xbf80248d,0x80003f80,0x3f7b3e48,0x3ec4bf6d,0xbf55bf0e
.long 0x80003f80,0x3f6d3ec4,0x3f35bf35,0xbec4bf6d,0x80003f80,0x3f553f0e,0x3f6dbec4,0x3e48bf7b
.long 0x80003f80,0x3f353f35,0x3f80a554,0x3f35bf35,0x80003f80,0x3f0e3f55,0x3f6d3ec4,0x3f7bbe48
.long 0x80003f80,0x3ec43f6d,0x3f353f35,0x3f6d3ec4,0x80003f80,0x3e483f7b,0x3ec43f6d,0x3f0e3f55
.long 0x80003f80,0x80003f80,0x80003f80,0x80003f80,0xbf353f35,0xbf553f0e,0xbf6d3ec4,0xbf7b3e48
.long 0xbf80248d,0xbf6dbec4,0xbf35bf35,0xbec4bf6d,0xbf35bf35,0xbe48bf7b,0x3ec4bf6d,0x3f55bf0e
.long 0xa50dbf80,0x3f35bf35,0x3f80a554,0x3f353f35,0x3f35bf35,0x3f7b3e48,0x3ec43f6d,0xbf0e3f55
.long 0x3f80a554,0x3ec43f6d,0xbf353f35,0xbf6dbec4,0x3f353f35,0xbf0e3f55,0xbf6dbec4,0x3e48bf7b
.long 0x80003f80,0xbf80248d,0xa50dbf80,0x3f80a554,0xbf353f35,0xbf0ebf55,0x3f6dbec4,0x3e483f7b
.long 0xbf80248d,0x3ec4bf6d,0x3f353f35,0xbf6d3ec4,0xbf35bf35,0x3f7bbe48,0xbec43f6d,0xbf0ebf55
.long 0xa50dbf80,0x3f353f35,0xbf80248d,0x3f35bf35,0x3f35bf35,0xbe483f7b,0xbec4bf6d,0x3f553f0e
.long 0x3f80a554,0xbf6d3ec4,0x3f35bf35,0xbec43f6d,0x3f353f35,0xbf55bf0e,0x3f6d3ec4,0xbf7bbe48
.long 0x80003f80,0xa50dbf80,0x80003f80,0xa50dbf80,0xbf353f35,0x3f55bf0e,0xbf6d3ec4,0x3f7bbe48
.long 0xbf80248d,0x3f6d3ec4,0xbf35bf35,0x3ec43f6d,0xbf35bf35,0x3e483f7b,0x3ec4bf6d,0xbf553f0e
.long 0xa50dbf80,0xbf353f35,0x3f80a554,0xbf35bf35,0x3f35bf35,0xbf7bbe48,0x3ec43f6d,0x3f0ebf55
.long 0x3f80a554,0xbec4bf6d,0xbf353f35,0x3f6d3ec4,0x3f353f35,0x3f0ebf55,0xbf6dbec4,0xbe483f7b
.long 0x80003f80,0x3f80a554,0xa50dbf80,0xbf80248d,0xbf353f35,0x3f0e3f55,0x3f6dbec4,0xbe48bf7b
.long 0xbf80248d,0xbec43f6d,0x3f353f35,0x3f6dbec4,0xbf35bf35,0xbf7b3e48,0xbec43f6d,0x3f0e3f55
.long 0xa50dbf80,0xbf35bf35,0xbf80248d,0xbf353f35,0x3f35bf35,0x3e48bf7b,0xbec4bf6d,0xbf55bf0e
.long 0x3f80a554,0x3f6dbec4,0x3f35bf35,0x3ec4bf6d,0x3f353f35,0x3f553f0e,0x3f6d3ec4,0x3f7b3e48
.long 0x80003f80,0x80003f80,0x80003f80,0x80003f80,0xbf80248d,0xbf7bbe48,0xbf6dbec4,0xbf55bf0e
.long 0xa50dbf80,0x3ec4bf6d,0x3f35bf35,0x3f6dbec4,0x3f80a554,0x3f553f0e,0x3ec43f6d,0xbe483f7b
.long 0x80003f80,0xbf353f35,0xbf80248d,0xbf35bf35,0xbf80248d,0xbf0ebf55,0x3ec4bf6d,0x3f7bbe48
.long 0xa50dbf80,0x3f6dbec4,0x3f353f35,0xbec43f6d,0x3f80a554,0x3e483f7b,0xbf6d3ec4,0xbf0ebf55
.long 0x80003f80,0xbf80248d,0xa50dbf80,0x3f80a554,0xbf80248d,0x3e48bf7b,0x3f6d3ec4,0xbf0e3f55
.long 0xa50dbf80,0x3f6d3ec4,0xbf353f35,0xbec4bf6d,0x3f80a554,0xbf0e3f55,0xbec4bf6d,0x3f7b3e48
.long 0x80003f80,0xbf35bf35,0x3f80a554,0xbf353f35,0xbf80248d,0x3f55bf0e,0xbec43f6d,0xbe48bf7b
.long 0xa50dbf80,0x3ec43f6d,0xbf35bf35,0x3f6d3ec4,0x3f80a554,0xbf7b3e48,0x3f6dbec4,0xbf553f0e
.long 0x80003f80,0xa50dbf80,0x80003f80,0xa50dbf80,0xbf80248d,0x3f7b3e48,0xbf6dbec4,0x3f553f0e
.long 0xa50dbf80,0xbec43f6d,0x3f35bf35,0xbf6d3ec4,0x3f80a554,0xbf55bf0e,0x3ec43f6d,0x3e48bf7b
.long 0x80003f80,0x3f35bf35,0xbf80248d,0x3f353f35,0xbf80248d,0x3f0e3f55,0x3ec4bf6d,0xbf7b3e48
.long 0xa50dbf80,0xbf6d3ec4,0x3f353f35,0x3ec4bf6d,0x3f80a554,0xbe48bf7b,0xbf6d3ec4,0x3f0e3f55
.long 0x80003f80,0x3f80a554,0xa50dbf80,0xbf80248d,0xbf80248d,0xbe483f7b,0x3f6d3ec4,0x3f0ebf55
.long 0xa50dbf80,0xbf6dbec4,0xbf353f35,0x3ec43f6d,0x3f80a554,0x3f0ebf55,0xbec4bf6d,0xbf7bbe48
.long 0x80003f80,0x3f353f35,0x3f80a554,0x3f35bf35,0xbf80248d,0xbf553f0e,0xbec43f6d,0x3e483f7b
.long 0xa50dbf80,0xbec4bf6d,0xbf35bf35,0xbf6dbec4,0x3f80a554,0x3f7bbe48,0x3f6dbec4,0x3f55bf0e
.long 0x80003f80,0x80003f80,0x80003f80,0x80003f80,0xbf35bf35,0xbf0ebf55,0xbec4bf6d,0xbe48bf7b
.long 0x3f80a554,0x3f6d3ec4,0x3f353f35,0x3ec43f6d,0xbf353f35,0xbf7b3e48,0xbf6dbec4,0xbf0ebf55
.long 0xa50dbf80,0x3f35bf35,0x3f80a554,0x3f353f35,0x3f353f35,0xbe483f7b,0xbf6d3ec4,0xbf55bf0e
.long 0xbf80248d,0xbec4bf6d,0x3f35bf35,0x3f6d3ec4,0x3f35bf35,0x3f553f0e,0xbec43f6d,0xbf7bbe48
.long 0x80003f80,0xbf80248d,0xa50dbf80,0x3f80a554,0xbf35bf35,0x3f55bf0e,0x3ec43f6d,0xbf7b3e48
.long 0x3f80a554,0xbec43f6d,0xbf35bf35,0x3f6dbec4,0xbf353f35,0xbe48bf7b,0x3f6d3ec4,0xbf553f0e
.long 0xa50dbf80,0x3f353f35,0xbf80248d,0x3f35bf35,0x3f353f35,0xbf7bbe48,0x3f6dbec4,0xbf0e3f55
.long 0xbf80248d,0x3f6dbec4,0xbf353f35,0x3ec4bf6d,0x3f35bf35,0xbf0e3f55,0x3ec4bf6d,0xbe483f7b
.long 0x80003f80,0xa50dbf80,0x80003f80,0xa50dbf80,0xbf35bf35,0x3f0e3f55,0xbec4bf6d,0x3e483f7b
.long 0x3f80a554,0xbf6dbec4,0x3f353f35,0xbec4bf6d,0xbf353f35,0x3f7bbe48,0xbf6dbec4,0x3f0e3f55
.long 0xa50dbf80,0xbf353f35,0x3f80a554,0xbf35bf35,0x3f353f35,0x3e48bf7b,0xbf6d3ec4,0x3f553f0e
.long 0xbf80248d,0x3ec43f6d,0x3f35bf35,0xbf6dbec4,0x3f35bf35,0xbf55bf0e,0xbec43f6d,0x3f7b3e48
.long 0x80003f80,0x3f80a554,0xa50dbf80,0xbf80248d,0xbf35bf35,0xbf553f0e,0x3ec43f6d,0x3f7bbe48
.long 0x3f80a554,0x3ec4bf6d,0xbf35bf35,0xbf6d3ec4,0xbf353f35,0x3e483f7b,0x3f6d3ec4,0x3f55bf0e
.long 0xa50dbf80,0xbf35bf35,0xbf80248d,0xbf353f35,0x3f353f35,0x3f7b3e48,0x3f6dbec4,0x3f0ebf55
.long 0xbf80248d,0xbf6d3ec4,0xbf353f35,0xbec43f6d,0x3f35bf35,0x3f0ebf55,0x3ec4bf6d,0x3e48bf7b
.long 0x80003f80,0x80003f80,0x80003f80,0x80003f80,0xa50dbf80,0x3e48bf7b,0x3ec4bf6d,0x3f0ebf55
.long 0x80003f80,0xbec43f6d,0xbf353f35,0xbf6d3ec4,0xa50dbf80,0x3f0ebf55,0x3f6dbec4,0x3f7b3e48
.long 0x80003f80,0xbf353f35,0xbf80248d,0xbf35bf35,0xa50dbf80,0x3f55bf0e,0x3f6d3ec4,0x3e483f7b
.long 0x80003f80,0xbf6d3ec4,0xbf35bf35,0x3ec4bf6d,0xa50dbf80,0x3f7bbe48,0x3ec43f6d,0xbf553f0e
.long 0x80003f80,0xbf80248d,0xa50dbf80,0x3f80a554,0xa50dbf80,0x3f7b3e48,0xbec43f6d,0xbf55bf0e
.long 0x80003f80,0xbf6dbec4,0x3f35bf35,0x3ec43f6d,0xa50dbf80,0x3f553f0e,0xbf6d3ec4,0x3e48bf7b
.long 0x80003f80,0xbf35bf35,0x3f80a554,0xbf353f35,0xa50dbf80,0x3f0e3f55,0xbf6dbec4,0x3f7bbe48
.long 0x80003f80,0xbec4bf6d,0x3f353f35,0xbf6dbec4,0xa50dbf80,0x3e483f7b,0xbec4bf6d,0x3f0e3f55
.long 0x80003f80,0xa50dbf80,0x80003f80,0xa50dbf80,0xa50dbf80,0xbe483f7b,0x3ec4bf6d,0xbf0e3f55
.long 0x80003f80,0x3ec4bf6d,0xbf353f35,0x3f6dbec4,0xa50dbf80,0xbf0e3f55,0x3f6dbec4,0xbf7bbe48
.long 0x80003f80,0x3f35bf35,0xbf80248d,0x3f353f35,0xa50dbf80,0xbf553f0e,0x3f6d3ec4,0xbe48bf7b
.long 0x80003f80,0x3f6dbec4,0xbf35bf35,0xbec43f6d,0xa50dbf80,0xbf7b3e48,0x3ec43f6d,0x3f55bf0e
.long 0x80003f80,0x3f80a554,0xa50dbf80,0xbf80248d,0xa50dbf80,0xbf7bbe48,0xbec43f6d,0x3f553f0e
.long 0x80003f80,0x3f6d3ec4,0x3f35bf35,0xbec4bf6d,0xa50dbf80,0xbf55bf0e,0xbf6d3ec4,0xbe483f7b
.long 0x80003f80,0x3f353f35,0x3f80a554,0x3f35bf35,0xa50dbf80,0xbf0ebf55,0xbf6dbec4,0xbf7b3e48
.long 0x80003f80,0x3ec43f6d,0x3f353f35,0x3f6d3ec4,0xa50dbf80,0xbe48bf7b,0xbec4bf6d,0xbf0ebf55
.long 0x80003f80,0x80003f80,0x80003f80,0x80003f80,0x3f35bf35,0x3f55bf0e,0x3f6dbec4,0x3f7bbe48
.long 0xbf80248d,0xbf6dbec4,0xbf35bf35,0xbec4bf6d,0x3f353f35,0x3e483f7b,0xbec43f6d,0xbf553f0e
.long 0xa50dbf80,0x3f35bf35,0x3f80a554,0x3f353f35,0xbf353f35,0xbf7bbe48,0xbec4bf6d,0x3f0ebf55
.long 0x3f80a554,0x3ec43f6d,0xbf353f35,0xbf6dbec4,0xbf35bf35,0x3f0ebf55,0x3f6d3ec4,0xbe483f7b
.long 0x80003f80,0xbf80248d,0xa50dbf80,0x3f80a554,0x3f35bf35,0x3f0e3f55,0xbf6d3ec4,0xbe48bf7b
.long 0xbf80248d,0x3ec4bf6d,0x3f353f35,0xbf6d3ec4,0x3f353f35,0xbf7b3e48,0x3ec4bf6d,0x3f0e3f55
.long 0xa50dbf80,0x3f353f35,0xbf80248d,0x3f35bf35,0xbf353f35,0x3e48bf7b,0x3ec43f6d,0xbf55bf0e
.long 0x3f80a554,0xbf6d3ec4,0x3f35bf35,0xbec43f6d,0xbf35bf35,0x3f553f0e,0xbf6dbec4,0x3f7b3e48
.long 0x80003f80,0xa50dbf80,0x80003f80,0xa50dbf80,0x3f35bf35,0xbf553f0e,0x3f6dbec4,0xbf7b3e48
.long 0xbf80248d,0x3f6d3ec4,0xbf35bf35,0x3ec43f6d,0x3f353f35,0xbe48bf7b,0xbec43f6d,0x3f55bf0e
.long 0xa50dbf80,0xbf353f35,0x3f80a554,0xbf35bf35,0xbf353f35,0x3f7b3e48,0xbec4bf6d,0xbf0e3f55
.long 0x3f80a554,0xbec4bf6d,0xbf353f35,0x3f6d3ec4,0xbf35bf35,0xbf0e3f55,0x3f6d3ec4,0x3e48bf7b
.long 0x80003f80,0x3f80a554,0xa50dbf80,0xbf80248d,0x3f35bf35,0xbf0ebf55,0xbf6d3ec4,0x3e483f7b
.long 0xbf80248d,0xbec43f6d,0x3f353f35,0x3f6dbec4,0x3f353f35,0x3f7bbe48,0x3ec4bf6d,0xbf0ebf55
.long 0xa50dbf80,0xbf35bf35,0xbf80248d,0xbf353f35,0xbf353f35,0xbe483f7b,0x3ec43f6d,0x3f553f0e
.long 0x3f80a554,0x3f6dbec4,0x3f35bf35,0x3ec4bf6d,0xbf35bf35,0xbf55bf0e,0xbf6dbec4,0xbf7bbe48
.long 0x80003f80,0x80003f80,0x80003f80,0x80003f80,0x3f80a554,0x3f7b3e48,0x3f6d3ec4,0x3f553f0e
.long 0xa50dbf80,0x3ec4bf6d,0x3f35bf35,0x3f6dbec4,0xbf80248d,0xbf55bf0e,0xbec4bf6d,0x3e48bf7b
.long 0x80003f80,0xbf353f35,0xbf80248d,0xbf35bf35,0x3f80a554,0x3f0e3f55,0xbec43f6d,0xbf7b3e48
.long 0xa50dbf80,0x3f6dbec4,0x3f353f35,0xbec43f6d,0xbf80248d,0xbe48bf7b,0x3f6dbec4,0x3f0e3f55
.long 0x80003f80,0xbf80248d,0xa50dbf80,0x3f80a554,0x3f80a554,0xbe483f7b,0xbf6dbec4,0x3f0ebf55
.long 0xa50dbf80,0x3f6d3ec4,0xbf353f35,0xbec4bf6d,0xbf80248d,0x3f0ebf55,0x3ec43f6d,0xbf7bbe48
.long 0x80003f80,0xbf35bf35,0x3f80a554,0xbf353f35,0x3f80a554,0xbf553f0e,0x3ec4bf6d,0x3e483f7b
.long 0xa50dbf80,0x3ec43f6d,0xbf35bf35,0x3f6d3ec4,0xbf80248d,0x3f7bbe48,0xbf6d3ec4,0x3f55bf0e
.long 0x80003f80,0xa50dbf80,0x80003f80,0xa50dbf80,0x3f80a554,0xbf7bbe48,0x3f6d3ec4,0xbf55bf0e
.long 0xa50dbf80,0xbec43f6d,0x3f35bf35,0xbf6d3ec4,0xbf80248d,0x3f553f0e,0xbec4bf6d,0xbe483f7b
.long 0x80003f80,0x3f35bf35,0xbf80248d,0x3f353f35,0x3f80a554,0xbf0ebf55,0xbec43f6d,0x3f7bbe48
.long 0xa50dbf80,0xbf6d3ec4,0x3f353f35,0x3ec4bf6d,0xbf80248d,0x3e483f7b,0x3f6dbec4,0xbf0ebf55
.long 0x80003f80,0x3f80a554,0xa50dbf80,0xbf80248d,0x3f80a554,0x3e48bf7b,0xbf6dbec4,0xbf0e3f55
.long 0xa50dbf80,0xbf6dbec4,0xbf353f35,0x3ec43f6d,0xbf80248d,0xbf0e3f55,0x3ec43f6d,0x3f7b3e48
.long 0x80003f80,0x3f353f35,0x3f80a554,0x3f35bf35,0x3f80a554,0x3f55bf0e,0x3ec4bf6d,0xbe48bf7b
.long 0xa50dbf80,0xbec4bf6d,0xbf35bf35,0xbf6dbec4,0xbf80248d,0xbf7b3e48,0xbf6d3ec4,0xbf553f0e
.long 0x80003f80,0x80003f80,0x80003f80,0x80003f80,0x3f353f35,0x3f0e3f55,0x3ec43f6d,0x3e483f7b
.long 0x3f80a554,0x3f6d3ec4,0x3f353f35,0x3ec43f6d,0x3f35bf35,0x3f7bbe48,0x3f6d3ec4,0x3f0e3f55
.long 0xa50dbf80,0x3f35bf35,0x3f80a554,0x3f353f35,0xbf35bf35,0x3e48bf7b,0x3f6dbec4,0x3f553f0e
.long 0xbf80248d,0xbec4bf6d,0x3f35bf35,0x3f6d3ec4,0xbf353f35,0xbf55bf0e,0x3ec4bf6d,0x3f7b3e48
.long 0x80003f80,0xbf80248d,0xa50dbf80,0x3f80a554,0x3f353f35,0xbf553f0e,0xbec4bf6d,0x3f7bbe48
.long 0x3f80a554,0xbec43f6d,0xbf35bf35,0x3f6dbec4,0x3f35bf35,0x3e483f7b,0xbf6dbec4,0x3f55bf0e
.long 0xa50dbf80,0x3f353f35,0xbf80248d,0x3f35bf35,0xbf35bf35,0x3f7b3e48,0xbf6d3ec4,0x3f0ebf55
.long 0xbf80248d,0x3f6dbec4,0xbf353f35,0x3ec4bf6d,0xbf353f35,0x3f0ebf55,0xbec43f6d,0x3e48bf7b
.long 0x80003f80,0xa50dbf80,0x80003f80,0xa50dbf80,0x3f353f35,0xbf0ebf55,0x3ec43f6d,0xbe48bf7b
.long 0x3f80a554,0xbf6dbec4,0x3f353f35,0xbec4bf6d,0x3f35bf35,0xbf7b3e48,0x3f6d3ec4,0xbf0ebf55
.long 0xa50dbf80,0xbf353f35,0x3f80a554,0xbf35bf35,0xbf35bf35,0xbe483f7b,0x3f6dbec4,0xbf55bf0e
.long 0xbf80248d,0x3ec43f6d,0x3f35bf35,0xbf6dbec4,0xbf353f35,0x3f553f0e,0x3ec4bf6d,0xbf7bbe48
.long 0x80003f80,0x3f80a554,0xa50dbf80,0xbf80248d,0x3f353f35,0x3f55bf0e,0xbec4bf6d,0xbf7b3e48
.long 0x3f80a554,0x3ec4bf6d,0xbf35bf35,0xbf6d3ec4,0x3f35bf35,0xbe48bf7b,0xbf6dbec4,0xbf553f0e
.long 0xa50dbf80,0xbf35bf35,0xbf80248d,0xbf353f35,0xbf35bf35,0xbf7bbe48,0xbf6d3ec4,0xbf0e3f55
.long 0xbf80248d,0xbf6d3ec4,0xbf353f35,0xbec43f6d,0xbf353f35,0xbf0e3f55,0xbec43f6d,0xbe483f7b
.long 0x80003f80,0x80003f80,0x80003f80,0x80003f80,0xbd493f80,0xbe793f78,0xbedb3f67,0xbf183f4e
.long 0xbdc93f7f,0xbef13f62,0xbf463f22,0xbf753e95,0xbe163f7d,0xbf2c3f3e,0xbf783e79,0xbf71beac
.long 0xbe483f7b,0xbf553f0e,0xbf7bbe48,0xbf0ebf55,0xbe793f78,0xbf713eac,0xbf4ebf18,0x3d49bf80
.long 0xbe953f75,0xbf7f3dc9,0xbef1bf62,0x3f22bf46,0xbeac3f71,0xbf7dbe16,0xbd49bf80,0x3f78be79
.long 0xbec43f6d,0xbf6dbec4,0x3ec4bf6d,0x3f6d3ec4,0xbedb3f67,0xbf4ebf18,0x3f3ebf2c,0x3f043f5c
.long 0xbef13f62,0xbf22bf46,0x3f75be95,0xbdc93f7f,0xbf043f5c,0xbedbbf67,0x3f7d3e16,0xbf2c3f3e
.long 0xbf0e3f55,0xbe48bf7b,0x3f553f0e,0xbf7b3e48,0xbf183f4e,0x3d49bf80,0x3f043f5c,0xbf67bedb
.long 0xbf223f46,0x3e95bf75,0x3dc93f7f,0xbef1bf62,0xbf2c3f3e,0x3f04bf5c,0xbeac3f71,0x3e16bf7d
.long 0xbf353f35,0x3f35bf35,0xbf353f35,0x3f35bf35,0xbf3e3f2c,0x3f5cbf04,0xbf713eac,0x3f7dbe16
.long 0xbf463f22,0x3f75be95,0xbf7fbdc9,0x3f623ef1,0xbf4e3f18,0x3f80bd49,0xbf5cbf04,0x3edb3f67
.long 0xbf553f0e,0x3f7b3e48,0xbf0ebf55,0xbe483f7b,0xbf5c3f04,0x3f673edb,0xbe16bf7d,0xbf3e3f2c
.long 0xbf623ef1,0x3f463f22,0x3e95bf75,0xbf7f3dc9,0xbf673edb,0x3f183f4e,0x3f2cbf3e,0xbf5cbf04
.long 0xbf6d3ec4,0x3ec43f6d,0x3f6dbec4,0xbec4bf6d,0xbf713eac,0x3e163f7d,0x3f803d49,0x3e79bf78
.long 0xbf753e95,0xbdc93f7f,0x3f623ef1,0x3f46bf22,0xbf783e79,0xbeac3f71,0x3f183f4e,0x3f80bd49
.long 0xbf7b3e48,0xbf0e3f55,0x3e483f7b,0x3f553f0e,0xbf7d3e16,0xbf3e3f2c,0xbe793f78,0x3eac3f71
.long 0xbf7f3dc9,0xbf623ef1,0xbf223f46,0xbe953f75,0xbf803d49,0xbf783e79,0xbf673edb,0xbf4e3f18
.long 0x80003f80,0x80003f80,0x80003f80,0x80003f80,0xbf3e3f2c,0xbf5c3f04,0xbf713eac,0xbf7d3e16
.long 0xbf7fbdc9,0xbf62bef1,0xbf22bf46,0xbe95bf75,0xbf18bf4e,0xbd49bf80,0x3f04bf5c,0x3f67bedb
.long 0x3e48bf7b,0x3f55bf0e,0x3f7b3e48,0x3f0e3f55,0x3f5cbf04,0x3f673edb,0x3e163f7d,0xbf3e3f2c
.long 0x3f753e95,0x3dc93f7f,0xbf623ef1,0xbf46bf22,0x3edb3f67,0xbf4e3f18,0xbf3ebf2c,0x3f04bf5c
.long 0xbec43f6d,0xbf6dbec4,0x3ec4bf6d,0x3f6d3ec4,0xbf713eac,0xbe16bf7d,0x3f803d49,0xbe793f78
.long 0xbf62bef1,0x3f46bf22,0x3e953f75,0xbf7fbdc9,0xbe79bf78,0x3f713eac,0xbf4e3f18,0xbd49bf80
.long 0x3f0ebf55,0x3e483f7b,0xbf55bf0e,0x3f7bbe48,0x3f7dbe16,0xbf3e3f2c,0x3e79bf78,0x3eac3f71
.long 0x3f463f22,0xbf75be95,0x3f7fbdc9,0xbf623ef1,0x3d493f80,0xbe79bf78,0x3edb3f67,0xbf18bf4e
.long 0xbf353f35,0x3f35bf35,0xbf353f35,0x3f35bf35,0xbf80bd49,0x3f783e79,0xbf67bedb,0x3f4e3f18
.long 0xbf22bf46,0x3e953f75,0x3dc9bf7f,0xbef13f62,0x3e16bf7d,0xbf2c3f3e,0x3f78be79,0xbf71beac
.long 0x3f55bf0e,0xbf7bbe48,0x3f0e3f55,0x3e48bf7b,0x3f783e79,0xbeacbf71,0xbf183f4e,0x3f803d49
.long 0x3ef13f62,0x3f22bf46,0xbf75be95,0x3dc93f7f,0xbeac3f71,0x3f7d3e16,0xbd49bf80,0xbf783e79
.long 0xbf6d3ec4,0x3ec43f6d,0x3f6dbec4,0xbec4bf6d,0xbf67bedb,0xbf183f4e,0x3f2c3f3e,0x3f5cbf04
.long 0xbe95bf75,0xbf7fbdc9,0xbef13f62,0x3f223f46,0x3f04bf5c,0xbedbbf67,0xbf7dbe16,0xbf2c3f3e
.long 0x3f7bbe48,0x3f0ebf55,0xbe48bf7b,0xbf55bf0e,0x3f4e3f18,0x3f803d49,0x3f5cbf04,0x3edbbf67
.long 0x3dc93f7f,0x3ef13f62,0x3f463f22,0x3f753e95,0xbf2c3f3e,0xbf043f5c,0xbeac3f71,0xbe163f7d
.long 0x80003f80,0x80003f80,0x80003f80,0x80003f80,0xbf80bd49,0xbf78be79,0xbf67bedb,0xbf4ebf18
.long 0x3dc9bf7f,0x3ef1bf62,0x3f46bf22,0x3f75be95,0x3f7d3e16,0x3f3e3f2c,0x3e793f78,0xbeac3f71
.long 0xbe483f7b,0xbf553f0e,0xbf7bbe48,0xbf0ebf55,0xbf78be79,0xbeacbf71,0x3f18bf4e,0x3f803d49
.long 0x3e95bf75,0x3f7fbdc9,0x3ef13f62,0xbf223f46,0x3f713eac,0xbe163f7d,0xbf803d49,0xbe79bf78
.long 0xbec43f6d,0xbf6dbec4,0x3ec4bf6d,0x3f6d3ec4,0xbf67bedb,0x3f18bf4e,0x3f2c3f3e,0xbf5c3f04
.long 0x3ef1bf62,0x3f223f46,0xbf753e95,0x3dc9bf7f,0x3f5c3f04,0xbf673edb,0x3e16bf7d,0x3f3e3f2c
.long 0xbf0e3f55,0xbe48bf7b,0x3f553f0e,0xbf7b3e48,0xbf4ebf18,0x3f803d49,0xbf5c3f04,0x3edbbf67
.long 0x3f22bf46,0xbe953f75,0xbdc9bf7f,0x3ef13f62,0x3f3e3f2c,0xbf5cbf04,0x3f713eac,0xbf7dbe16
.long 0xbf353f35,0x3f35bf35,0xbf353f35,0x3f35bf35,0xbf2cbf3e,0x3f043f5c,0xbeacbf71,0x3e163f7d
.long 0x3f46bf22,0xbf753e95,0x3f7f3dc9,0xbf62bef1,0x3f183f4e,0xbd49bf80,0xbf043f5c,0x3f67bedb
.long 0xbf553f0e,0x3f7b3e48,0xbf0ebf55,0xbe483f7b,0xbf04bf5c,0xbedb3f67,0x3f7dbe16,0xbf2cbf3e
.long 0x3f62bef1,0xbf46bf22,0xbe953f75,0x3f7fbdc9,0x3edb3f67,0x3f4ebf18,0xbf3ebf2c,0xbf043f5c
.long 0xbf6d3ec4,0x3ec43f6d,0x3f6dbec4,0xbec4bf6d,0xbeacbf71,0xbf7d3e16,0xbd493f80,0x3f783e79
.long 0x3f75be95,0x3dc9bf7f,0xbf62bef1,0xbf463f22,0x3e793f78,0x3f713eac,0x3f4ebf18,0xbd49bf80
.long 0xbf7b3e48,0xbf0e3f55,0x3e483f7b,0x3f553f0e,0xbe16bf7d,0xbf2cbf3e,0xbf78be79,0xbf713eac
.long 0x3f7fbdc9,0x3f62bef1,0x3f22bf46,0x3e95bf75,0x3d493f80,0x3e793f78,0x3edb3f67,0x3f183f4e
.long 0x80003f80,0x80003f80,0x80003f80,0x80003f80,0xbf2cbf3e,0xbf04bf5c,0xbeacbf71,0xbe16bf7d
.long 0x3f7f3dc9,0x3f623ef1,0x3f223f46,0x3e953f75,0xbf4e3f18,0xbf803d49,0xbf5cbf04,0xbedbbf67
.long 0x3e48bf7b,0x3f55bf0e,0x3f7b3e48,0x3f0e3f55,0x3f043f5c,0xbedb3f67,0xbf7d3e16,0xbf2cbf3e
.long 0xbf75be95,0xbdc9bf7f,0x3f62bef1,0x3f463f22,0x3f67bedb,0x3f183f4e,0xbf2c3f3e,0xbf5cbf04
.long 0xbec43f6d,0xbf6dbec4,0x3ec4bf6d,0x3f6d3ec4,0xbeacbf71,0x3f7dbe16,0xbd493f80,0xbf78be79
.long 0x3f623ef1,0xbf463f22,0xbe95bf75,0x3f7f3dc9,0xbf783e79,0x3eacbf71,0x3f183f4e,0xbf803d49
.long 0x3f0ebf55,0x3e483f7b,0xbf55bf0e,0x3f7bbe48,0x3e163f7d,0xbf2cbf3e,0x3f783e79,0xbf713eac
.long 0xbf46bf22,0x3f753e95,0xbf7f3dc9,0x3f62bef1,0x3f80bd49,0xbf783e79,0x3f67bedb,0xbf4e3f18
.long 0xbf353f35,0x3f35bf35,0xbf353f35,0x3f35bf35,0x3d49bf80,0xbe793f78,0x3edbbf67,0xbf183f4e
.long 0x3f223f46,0xbe95bf75,0xbdc93f7f,0x3ef1bf62,0xbf7dbe16,0x3f3e3f2c,0xbe79bf78,0xbeac3f71
.long 0x3f55bf0e,0xbf7bbe48,0x3f0e3f55,0x3e48bf7b,0xbe793f78,0x3f71beac,0xbf4ebf18,0xbd493f80
.long 0xbef1bf62,0xbf223f46,0x3f753e95,0xbdc9bf7f,0x3f713eac,0x3e16bf7d,0xbf803d49,0x3e793f78
.long 0xbf6d3ec4,0x3ec43f6d,0x3f6dbec4,0xbec4bf6d,0x3edbbf67,0xbf4ebf18,0xbf3e3f2c,0x3f043f5c
.long 0x3e953f75,0x3f7f3dc9,0x3ef1bf62,0xbf22bf46,0xbf5cbf04,0xbf673edb,0xbe163f7d,0x3f3e3f2c
.long 0x3f7bbe48,0x3f0ebf55,0xbe48bf7b,0xbf55bf0e,0xbf183f4e,0xbd493f80,0x3f043f5c,0x3f673edb
.long 0xbdc9bf7f,0xbef1bf62,0xbf46bf22,0xbf75be95,0x3f3e3f2c,0x3f5c3f04,0x3f713eac,0x3f7d3e16
.long 0x80003f80,0x80003f80,0x80003f80,0x80003f80,0x3d49bf80,0x3e79bf78,0x3edbbf67,0x3f18bf4e
.long 0xbdc93f7f,0xbef13f62,0xbf463f22,0xbf753e95,0x3e16bf7d,0x3f2cbf3e,0x3f78be79,0x3f713eac
.long 0xbe483f7b,0xbf553f0e,0xbf7bbe48,0xbf0ebf55,0x3e79bf78,0x3f71beac,0x3f4e3f18,0xbd493f80
.long 0xbe953f75,0xbf7f3dc9,0xbef1bf62,0x3f22bf46,0x3eacbf71,0x3f7d3e16,0x3d493f80,0xbf783e79
.long 0xbec43f6d,0xbf6dbec4,0x3ec4bf6d,0x3f6d3ec4,0x3edbbf67,0x3f4e3f18,0xbf3e3f2c,0xbf04bf5c
.long 0xbef13f62,0xbf22bf46,0x3f75be95,0xbdc93f7f,0x3f04bf5c,0x3edb3f67,0xbf7dbe16,0x3f2cbf3e
.long 0xbf0e3f55,0xbe48bf7b,0x3f553f0e,0xbf7b3e48,0x3f18bf4e,0xbd493f80,0xbf04bf5c,0x3f673edb
.long 0xbf223f46,0x3e95bf75,0x3dc93f7f,0xbef1bf62,0x3f2cbf3e,0xbf043f5c,0x3eacbf71,0xbe163f7d
.long 0xbf353f35,0x3f35bf35,0xbf353f35,0x3f35bf35,0x3f3ebf2c,0xbf5c3f04,0x3f71beac,0xbf7d3e16
.long 0xbf463f22,0x3f75be95,0xbf7fbdc9,0x3f623ef1,0x3f4ebf18,0xbf803d49,0x3f5c3f04,0xbedbbf67
.long 0xbf553f0e,0x3f7b3e48,0xbf0ebf55,0xbe483f7b,0x3f5cbf04,0xbf67bedb,0x3e163f7d,0x3f3ebf2c
.long 0xbf623ef1,0x3f463f22,0x3e95bf75,0xbf7f3dc9,0x3f67bedb,0xbf18bf4e,0xbf2c3f3e,0x3f5c3f04
.long 0xbf6d3ec4,0x3ec43f6d,0x3f6dbec4,0xbec4bf6d,0x3f71beac,0xbe16bf7d,0xbf80bd49,0xbe793f78
.long 0xbf753e95,0xbdc93f7f,0x3f623ef1,0x3f46bf22,0x3f78be79,0x3eacbf71,0xbf18bf4e,0xbf803d49
.long 0xbf7b3e48,0xbf0e3f55,0x3e483f7b,0x3f553f0e,0x3f7dbe16,0x3f3ebf2c,0x3e79bf78,0xbeacbf71
.long 0xbf7f3dc9,0xbf623ef1,0xbf223f46,0xbe953f75,0x3f80bd49,0x3f78be79,0x3f67bedb,0x3f4ebf18
.long 0x80003f80,0x80003f80,0x80003f80,0x80003f80,0x3f3ebf2c,0x3f5cbf04,0x3f71beac,0x3f7dbe16
.long 0xbf7fbdc9,0xbf62bef1,0xbf22bf46,0xbe95bf75,0x3f183f4e,0x3d493f80,0xbf043f5c,0xbf673edb
.long 0x3e48bf7b,0x3f55bf0e,0x3f7b3e48,0x3f0e3f55,0xbf5c3f04,0xbf67bedb,0xbe16bf7d,0x3f3ebf2c
.long 0x3f753e95,0x3dc93f7f,0xbf623ef1,0xbf46bf22,0xbedbbf67,0x3f4ebf18,0x3f3e3f2c,0xbf043f5c
.long 0xbec43f6d,0xbf6dbec4,0x3ec4bf6d,0x3f6d3ec4,0x3f71beac,0x3e163f7d,0xbf80bd49,0x3e79bf78
.long 0xbf62bef1,0x3f46bf22,0x3e953f75,0xbf7fbdc9,0x3e793f78,0xbf71beac,0x3f4ebf18,0x3d493f80
.long 0x3f0ebf55,0x3e483f7b,0xbf55bf0e,0x3f7bbe48,0xbf7d3e16,0x3f3ebf2c,0xbe793f78,0xbeacbf71
.long 0x3f463f22,0xbf75be95,0x3f7fbdc9,0xbf623ef1,0xbd49bf80,0x3e793f78,0xbedbbf67,0x3f183f4e
.long 0xbf353f35,0x3f35bf35,0xbf353f35,0x3f35bf35,0x3f803d49,0xbf78be79,0x3f673edb,0xbf4ebf18
.long 0xbf22bf46,0x3e953f75,0x3dc9bf7f,0xbef13f62,0xbe163f7d,0x3f2cbf3e,0xbf783e79,0x3f713eac
.long 0x3f55bf0e,0xbf7bbe48,0x3f0e3f55,0x3e48bf7b,0xbf78be79,0x3eac3f71,0x3f18bf4e,0xbf80bd49
.long 0x3ef13f62,0x3f22bf46,0xbf75be95,0x3dc93f7f,0x3eacbf71,0xbf7dbe16,0x3d493f80,0x3f78be79
.long 0xbf6d3ec4,0x3ec43f6d,0x3f6dbec4,0xbec4bf6d,0x3f673edb,0x3f18bf4e,0xbf2cbf3e,0xbf5c3f04
.long 0xbe95bf75,0xbf7fbdc9,0xbef13f62,0x3f223f46,0xbf043f5c,0x3edb3f67,0x3f7d3e16,0x3f2cbf3e
.long 0x3f7bbe48,0x3f0ebf55,0xbe48bf7b,0xbf55bf0e,0xbf4ebf18,0xbf80bd49,0xbf5c3f04,0xbedb3f67
.long 0x3dc93f7f,0x3ef13f62,0x3f463f22,0x3f753e95,0x3f2cbf3e,0x3f04bf5c,0x3eacbf71,0x3e16bf7d
.long 0x80003f80,0x80003f80,0x80003f80,0x80003f80,0x3f803d49,0x3f783e79,0x3f673edb,0x3f4e3f18
.long 0x3dc9bf7f,0x3ef1bf62,0x3f46bf22,0x3f75be95,0xbf7dbe16,0xbf3ebf2c,0xbe79bf78,0x3eacbf71
.long 0xbe483f7b,0xbf553f0e,0xbf7bbe48,0xbf0ebf55,0x3f783e79,0x3eac3f71,0xbf183f4e,0xbf80bd49
.long 0x3e95bf75,0x3f7fbdc9,0x3ef13f62,0xbf223f46,0xbf71beac,0x3e16bf7d,0x3f80bd49,0x3e793f78
.long 0xbec43f6d,0xbf6dbec4,0x3ec4bf6d,0x3f6d3ec4,0x3f673edb,0xbf183f4e,0xbf2cbf3e,0x3f5cbf04
.long 0x3ef1bf62,0x3f223f46,0xbf753e95,0x3dc9bf7f,0xbf5cbf04,0x3f67bedb,0xbe163f7d,0xbf3ebf2c
.long 0xbf0e3f55,0xbe48bf7b,0x3f553f0e,0xbf7b3e48,0x3f4e3f18,0xbf80bd49,0x3f5cbf04,0xbedb3f67
.long 0x3f22bf46,0xbe953f75,0xbdc9bf7f,0x3ef13f62,0xbf3ebf2c,0x3f5c3f04,0xbf71beac,0x3f7d3e16
.long 0xbf353f35,0x3f35bf35,0xbf353f35,0x3f35bf35,0x3f2c3f3e,0xbf04bf5c,0x3eac3f71,0xbe16bf7d
.long 0x3f46bf22,0xbf753e95,0x3f7f3dc9,0xbf62bef1,0xbf18bf4e,0x3d493f80,0x3f04bf5c,0xbf673edb
.long 0xbf553f0e,0x3f7b3e48,0xbf0ebf55,0xbe483f7b,0x3f043f5c,0x3edbbf67,0xbf7d3e16,0x3f2c3f3e
.long 0x3f62bef1,0xbf46bf22,0xbe953f75,0x3f7fbdc9,0xbedbbf67,0xbf4e3f18,0x3f3e3f2c,0x3f04bf5c
.long 0xbf6d3ec4,0x3ec43f6d,0x3f6dbec4,0xbec4bf6d,0x3eac3f71,0x3f7dbe16,0x3d49bf80,0xbf78be79
.long 0x3f75be95,0x3dc9bf7f,0xbf62bef1,0xbf463f22,0xbe79bf78,0xbf71beac,0xbf4e3f18,0x3d493f80
.long 0xbf7b3e48,0xbf0e3f55,0x3e483f7b,0x3f553f0e,0x3e163f7d,0x3f2c3f3e,0x3f783e79,0x3f71beac
.long 0x3f7fbdc9,0x3f62bef1,0x3f22bf46,0x3e95bf75,0xbd49bf80,0xbe79bf78,0xbedbbf67,0xbf18bf4e
.long 0x80003f80,0x80003f80,0x80003f80,0x80003f80,0x3f2c3f3e,0x3f043f5c,0x3eac3f71,0x3e163f7d
.long 0x3f7f3dc9,0x3f623ef1,0x3f223f46,0x3e953f75,0x3f4ebf18,0x3f80bd49,0x3f5c3f04,0x3edb3f67
.long 0x3e48bf7b,0x3f55bf0e,0x3f7b3e48,0x3f0e3f55,0xbf04bf5c,0x3edbbf67,0x3f7dbe16,0x3f2c3f3e
.long 0xbf75be95,0xbdc9bf7f,0x3f62bef1,0x3f463f22,0xbf673edb,0xbf18bf4e,0x3f2cbf3e,0x3f5c3f04
.long 0xbec43f6d,0xbf6dbec4,0x3ec4bf6d,0x3f6d3ec4,0x3eac3f71,0xbf7d3e16,0x3d49bf80,0x3f783e79
.long 0x3f623ef1,0xbf463f22,0xbe95bf75,0x3f7f3dc9,0x3f78be79,0xbeac3f71,0xbf18bf4e,0x3f80bd49
.long 0x3f0ebf55,0x3e483f7b,0xbf55bf0e,0x3f7bbe48,0xbe16bf7d,0x3f2c3f3e,0xbf78be79,0x3f71beac
.long 0xbf46bf22,0x3f753e95,0xbf7f3dc9,0x3f62bef1,0xbf803d49,0x3f78be79,0xbf673edb,0x3f4ebf18
.long 0xbf353f35,0x3f35bf35,0xbf353f35,0x3f35bf35,0xbd493f80,0x3e79bf78,0xbedb3f67,0x3f18bf4e
.long 0x3f223f46,0xbe95bf75,0xbdc93f7f,0x3ef1bf62,0x3f7d3e16,0xbf3ebf2c,0x3e793f78,0x3eacbf71
.long 0x3f55bf0e,0xbf7bbe48,0x3f0e3f55,0x3e48bf7b,0x3e79bf78,0xbf713eac,0x3f4e3f18,0x3d49bf80
.long 0xbef1bf62,0xbf223f46,0x3f753e95,0xbdc9bf7f,0xbf71beac,0xbe163f7d,0x3f80bd49,0xbe79bf78
.long 0xbf6d3ec4,0x3ec43f6d,0x3f6dbec4,0xbec4bf6d,0xbedb3f67,0x3f4e3f18,0x3f3ebf2c,0xbf04bf5c
.long 0x3e953f75,0x3f7f3dc9,0x3ef1bf62,0xbf22bf46,0x3f5c3f04,0x3f67bedb,0x3e16bf7d,0xbf3ebf2c
.long 0x3f7bbe48,0x3f0ebf55,0xbe48bf7b,0xbf55bf0e,0x3f18bf4e,0x3d49bf80,0xbf04bf5c,0xbf67bedb
.long 0xbdc9bf7f,0xbef1bf62,0xbf46bf22,0xbf75be95,0xbf3ebf2c,0xbf5cbf04,0xbf71beac,0xbf7dbe16
.long 0x80003f80,0x80003f80,0x80003f80,0x80003f80,0xbdc93f7f,0xbe953f75,0xbef13f62,0xbf223f46
.long 0xbe483f7b,0xbf0e3f55,0xbf553f0e,0xbf7b3e48,0xbe953f75,0xbf463f22,0xbf7f3dc9,0xbf62bef1
.long 0xbec43f6d,0xbf6d3ec4,0xbf6dbec4,0xbec4bf6d,0xbef13f62,0xbf7f3dc9,0xbf22bf46,0x3e95bf75
.long 0xbf0e3f55,0xbf7bbe48,0xbe48bf7b,0x3f55bf0e,0xbf223f46,0xbf62bef1,0x3e95bf75,0x3f7f3dc9
.long 0xbf353f35,0xbf35bf35,0x3f35bf35,0x3f353f35,0xbf463f22,0xbef1bf62,0x3f75be95,0x3dc93f7f
.long 0xbf553f0e,0xbe48bf7b,0x3f7b3e48,0xbf0e3f55,0xbf623ef1,0x3dc9bf7f,0x3f463f22,0xbf753e95
.long 0xbf6d3ec4,0x3ec4bf6d,0x3ec43f6d,0xbf6dbec4,0xbf753e95,0x3f22bf46,0xbdc93f7f,0xbef1bf62
.long 0xbf7b3e48,0x3f55bf0e,0xbf0e3f55,0x3e48bf7b,0xbf7f3dc9,0x3f75be95,0xbf623ef1,0x3f46bf22
.long 0xbf80248d,0x3f80a554,0xbf80248d,0x3f80a554,0xbf7fbdc9,0x3f753e95,0xbf62bef1,0x3f463f22
.long 0xbf7bbe48,0x3f553f0e,0xbf0ebf55,0x3e483f7b,0xbf75be95,0x3f223f46,0xbdc9bf7f,0xbef13f62
.long 0xbf6dbec4,0x3ec43f6d,0x3ec4bf6d,0xbf6d3ec4,0xbf62bef1,0x3dc93f7f,0x3f46bf22,0xbf75be95
.long 0xbf55bf0e,0xbe483f7b,0x3f7bbe48,0xbf0ebf55,0xbf46bf22,0xbef13f62,0x3f753e95,0x3dc9bf7f
.long 0xbf35bf35,0xbf353f35,0x3f353f35,0x3f35bf35,0xbf22bf46,0xbf623ef1,0x3e953f75,0x3f7fbdc9
.long 0xbf0ebf55,0xbf7b3e48,0xbe483f7b,0x3f553f0e,0xbef1bf62,0xbf7fbdc9,0xbf223f46,0x3e953f75
.long 0xbec4bf6d,0xbf6dbec4,0xbf6d3ec4,0xbec43f6d,0xbe95bf75,0xbf46bf22,0xbf7fbdc9,0xbf623ef1
.long 0xbe48bf7b,0xbf0ebf55,0xbf55bf0e,0xbf7bbe48,0xbdc9bf7f,0xbe95bf75,0xbef1bf62,0xbf22bf46
.long 0x80003f80,0x80003f80,0x80003f80,0x80003f80,0xbf463f22,0xbf623ef1,0xbf753e95,0xbf7f3dc9
.long 0xbf7bbe48,0xbf55bf0e,0xbf0ebf55,0xbe48bf7b,0xbef1bf62,0x3dc9bf7f,0x3f22bf46,0x3f75be95
.long 0x3ec4bf6d,0x3f6dbec4,0x3f6d3ec4,0x3ec43f6d,0x3f75be95,0x3f463f22,0xbdc93f7f,0xbf623ef1
.long 0x3f553f0e,0xbe483f7b,0xbf7b3e48,0xbf0ebf55,0x3dc93f7f,0xbf753e95,0xbef1bf62,0x3f46bf22
.long 0xbf353f35,0xbf35bf35,0x3f35bf35,0x3f353f35,0xbf7fbdc9,0x3e95bf75,0x3f623ef1,0xbf223f46
.long 0xbf0ebf55,0x3f7bbe48,0xbe483f7b,0xbf55bf0e,0x3e95bf75,0x3f223f46,0xbf7f3dc9,0x3ef1bf62
.long 0x3f6dbec4,0xbec43f6d,0xbec4bf6d,0x3f6d3ec4,0x3f623ef1,0xbf7f3dc9,0x3f46bf22,0xbe953f75
.long 0x3e483f7b,0xbf0ebf55,0x3f553f0e,0xbf7bbe48,0xbf223f46,0x3ef1bf62,0xbe953f75,0x3dc9bf7f
.long 0xbf80248d,0x3f80a554,0xbf80248d,0x3f80a554,0xbf22bf46,0x3ef13f62,0xbe95bf75,0x3dc93f7f
.long 0x3e48bf7b,0xbf0e3f55,0x3f55bf0e,0xbf7b3e48,0x3f62bef1,0xbf7fbdc9,0x3f463f22,0xbe95bf75
.long 0x3f6d3ec4,0xbec4bf6d,0xbec43f6d,0x3f6dbec4,0x3e953f75,0x3f22bf46,0xbf7fbdc9,0x3ef13f62
.long 0xbf0e3f55,0x3f7b3e48,0xbe48bf7b,0xbf553f0e,0xbf7f3dc9,0x3e953f75,0x3f62bef1,0xbf22bf46
.long 0xbf35bf35,0xbf353f35,0x3f353f35,0x3f35bf35,0x3dc9bf7f,0xbf75be95,0xbef13f62,0x3f463f22
.long 0x3f55bf0e,0xbe48bf7b,0xbf7bbe48,0xbf0e3f55,0x3f753e95,0x3f46bf22,0xbdc9bf7f,0xbf62bef1
.long 0x3ec43f6d,0x3f6d3ec4,0x3f6dbec4,0x3ec4bf6d,0xbef13f62,0x3dc93f7f,0x3f223f46,0x3f753e95
.long 0xbf7b3e48,0xbf553f0e,0xbf0e3f55,0xbe483f7b,0xbf46bf22,0xbf62bef1,0xbf75be95,0xbf7fbdc9
.long 0x80003f80,0x80003f80,0x80003f80,0x80003f80,0xbf7fbdc9,0xbf75be95,0xbf62bef1,0xbf46bf22
.long 0x3e48bf7b,0x3f0ebf55,0x3f55bf0e,0x3f7bbe48,0x3f753e95,0x3f223f46,0x3dc93f7f,0xbef13f62
.long 0xbec43f6d,0xbf6d3ec4,0xbf6dbec4,0xbec4bf6d,0xbf62bef1,0xbdc9bf7f,0x3f46bf22,0x3f753e95
.long 0x3f0ebf55,0x3f7b3e48,0x3e483f7b,0xbf553f0e,0x3f463f22,0xbef13f62,0xbf75be95,0x3dc9bf7f
.long 0xbf353f35,0xbf35bf35,0x3f35bf35,0x3f353f35,0xbf22bf46,0x3f62bef1,0x3e953f75,0xbf7f3dc9
.long 0x3f55bf0e,0x3e483f7b,0xbf7bbe48,0x3f0ebf55,0x3ef13f62,0xbf7fbdc9,0x3f22bf46,0x3e953f75
.long 0xbf6d3ec4,0x3ec4bf6d,0x3ec43f6d,0xbf6dbec4,0xbe95bf75,0x3f463f22,0xbf7fbdc9,0x3f62bef1
.long 0x3f7bbe48,0xbf553f0e,0x3f0ebf55,0xbe483f7b,0x3dc93f7f,0xbe95bf75,0x3ef13f62,0xbf22bf46
.long 0xbf80248d,0x3f80a554,0xbf80248d,0x3f80a554,0x3dc9bf7f,0xbe953f75,0x3ef1bf62,0xbf223f46
.long 0x3f7b3e48,0xbf55bf0e,0x3f0e3f55,0xbe48bf7b,0xbe953f75,0x3f46bf22,0xbf7f3dc9,0x3f623ef1
.long 0xbf6dbec4,0x3ec43f6d,0x3ec4bf6d,0xbf6d3ec4,0x3ef1bf62,0xbf7f3dc9,0x3f223f46,0x3e95bf75
.long 0x3f553f0e,0x3e48bf7b,0xbf7b3e48,0x3f0e3f55,0xbf223f46,0x3f623ef1,0x3e95bf75,0xbf7fbdc9
.long 0xbf35bf35,0xbf353f35,0x3f353f35,0x3f35bf35,0x3f46bf22,0xbef1bf62,0xbf753e95,0x3dc93f7f
.long 0x3f0e3f55,0x3f7bbe48,0x3e48bf7b,0xbf55bf0e,0xbf623ef1,0xbdc93f7f,0x3f463f22,0x3f75be95
.long 0xbec4bf6d,0xbf6dbec4,0xbf6d3ec4,0xbec43f6d,0x3f75be95,0x3f22bf46,0x3dc9bf7f,0xbef1bf62
.long 0x3e483f7b,0x3f0e3f55,0x3f553f0e,0x3f7b3e48,0xbf7f3dc9,0xbf753e95,0xbf623ef1,0xbf463f22
.long 0x80003f80,0x80003f80,0x80003f80,0x80003f80,0xbf22bf46,0xbef1bf62,0xbe95bf75,0xbdc9bf7f
.long 0x3f7b3e48,0x3f553f0e,0x3f0e3f55,0x3e483f7b,0xbf623ef1,0xbf7fbdc9,0xbf46bf22,0xbe95bf75
.long 0x3ec4bf6d,0x3f6dbec4,0x3f6d3ec4,0x3ec43f6d,0x3e953f75,0xbf223f46,0xbf7fbdc9,0xbef1bf62
.long 0xbf55bf0e,0x3e48bf7b,0x3f7bbe48,0x3f0e3f55,0x3f7fbdc9,0x3e953f75,0xbf623ef1,0xbf22bf46
.long 0xbf353f35,0xbf35bf35,0x3f35bf35,0x3f353f35,0x3dc9bf7f,0x3f753e95,0xbef13f62,0xbf46bf22
.long 0x3f0e3f55,0xbf7b3e48,0x3e48bf7b,0x3f553f0e,0xbf75be95,0x3f46bf22,0x3dc93f7f,0xbf62bef1
.long 0x3f6dbec4,0xbec43f6d,0xbec4bf6d,0x3f6d3ec4,0xbef13f62,0xbdc9bf7f,0x3f223f46,0xbf75be95
.long 0xbe48bf7b,0x3f0e3f55,0xbf55bf0e,0x3f7b3e48,0x3f463f22,0xbf62bef1,0x3f753e95,0xbf7fbdc9
.long 0xbf80248d,0x3f80a554,0xbf80248d,0x3f80a554,0x3f46bf22,0xbf623ef1,0x3f75be95,0xbf7f3dc9
.long 0xbe483f7b,0x3f0ebf55,0xbf553f0e,0x3f7bbe48,0xbef1bf62,0xbdc93f7f,0x3f22bf46,0xbf753e95
.long 0x3f6d3ec4,0xbec4bf6d,0xbec43f6d,0x3f6dbec4,0xbf753e95,0x3f463f22,0x3dc9bf7f,0xbf623ef1
.long 0x3f0ebf55,0xbf7bbe48,0x3e483f7b,0x3f55bf0e,0x3dc93f7f,0x3f75be95,0xbef1bf62,0xbf463f22
.long 0xbf35bf35,0xbf353f35,0x3f353f35,0x3f35bf35,0x3f7f3dc9,0x3e95bf75,0xbf62bef1,0xbf223f46
.long 0xbf553f0e,0x3e483f7b,0x3f7b3e48,0x3f0ebf55,0x3e95bf75,0xbf22bf46,0xbf7f3dc9,0xbef13f62
.long 0x3ec43f6d,0x3f6d3ec4,0x3f6dbec4,0x3ec4bf6d,0xbf62bef1,0xbf7f3dc9,0xbf463f22,0xbe953f75
.long 0x3f7bbe48,0x3f55bf0e,0x3f0ebf55,0x3e48bf7b,0xbf223f46,0xbef13f62,0xbe953f75,0xbdc93f7f
.long 0x80003f80,0x80003f80,0x80003f80,0x80003f80,0x3dc9bf7f,0x3e95bf75,0x3ef1bf62,0x3f22bf46
.long 0xbe483f7b,0xbf0e3f55,0xbf553f0e,0xbf7b3e48,0x3e95bf75,0x3f46bf22,0x3f7fbdc9,0x3f623ef1
.long 0xbec43f6d,0xbf6d3ec4,0xbf6dbec4,0xbec4bf6d,0x3ef1bf62,0x3f7fbdc9,0x3f223f46,0xbe953f75
.long 0xbf0e3f55,0xbf7bbe48,0xbe48bf7b,0x3f55bf0e,0x3f22bf46,0x3f623ef1,0xbe953f75,0xbf7fbdc9
.long 0xbf353f35,0xbf35bf35,0x3f35bf35,0x3f353f35,0x3f46bf22,0x3ef13f62,0xbf753e95,0xbdc9bf7f
.long 0xbf553f0e,0xbe48bf7b,0x3f7b3e48,0xbf0e3f55,0x3f62bef1,0xbdc93f7f,0xbf46bf22,0x3f75be95
.long 0xbf6d3ec4,0x3ec4bf6d,0x3ec43f6d,0xbf6dbec4,0x3f75be95,0xbf223f46,0x3dc9bf7f,0x3ef13f62
.long 0xbf7b3e48,0x3f55bf0e,0xbf0e3f55,0x3e48bf7b,0x3f7fbdc9,0xbf753e95,0x3f62bef1,0xbf463f22
.long 0xbf80248d,0x3f80a554,0xbf80248d,0x3f80a554,0x3f7f3dc9,0xbf75be95,0x3f623ef1,0xbf46bf22
.long 0xbf7bbe48,0x3f553f0e,0xbf0ebf55,0x3e483f7b,0x3f753e95,0xbf22bf46,0x3dc93f7f,0x3ef1bf62
.long 0xbf6dbec4,0x3ec43f6d,0x3ec4bf6d,0xbf6d3ec4,0x3f623ef1,0xbdc9bf7f,0xbf463f22,0x3f753e95
.long 0xbf55bf0e,0xbe483f7b,0x3f7bbe48,0xbf0ebf55,0x3f463f22,0x3ef1bf62,0xbf75be95,0xbdc93f7f
.long 0xbf35bf35,0xbf353f35,0x3f353f35,0x3f35bf35,0x3f223f46,0x3f62bef1,0xbe95bf75,0xbf7f3dc9
.long 0xbf0ebf55,0xbf7b3e48,0xbe483f7b,0x3f553f0e,0x3ef13f62,0x3f7f3dc9,0x3f22bf46,0xbe95bf75
.long 0xbec4bf6d,0xbf6dbec4,0xbf6d3ec4,0xbec43f6d,0x3e953f75,0x3f463f22,0x3f7f3dc9,0x3f62bef1
.long 0xbe48bf7b,0xbf0ebf55,0xbf55bf0e,0xbf7bbe48,0x3dc93f7f,0x3e953f75,0x3ef13f62,0x3f223f46
.long 0x80003f80,0x80003f80,0x80003f80,0x80003f80,0x3f46bf22,0x3f62bef1,0x3f75be95,0x3f7fbdc9
.long 0xbf7bbe48,0xbf55bf0e,0xbf0ebf55,0xbe48bf7b,0x3ef13f62,0xbdc93f7f,0xbf223f46,0xbf753e95
.long 0x3ec4bf6d,0x3f6dbec4,0x3f6d3ec4,0x3ec43f6d,0xbf753e95,0xbf46bf22,0x3dc9bf7f,0x3f62bef1
.long 0x3f553f0e,0xbe483f7b,0xbf7b3e48,0xbf0ebf55,0xbdc9bf7f,0x3f75be95,0x3ef13f62,0xbf463f22
.long 0xbf353f35,0xbf35bf35,0x3f35bf35,0x3f353f35,0x3f7f3dc9,0xbe953f75,0xbf62bef1,0x3f22bf46
.long 0xbf0ebf55,0x3f7bbe48,0xbe483f7b,0xbf55bf0e,0xbe953f75,0xbf22bf46,0x3f7fbdc9,0xbef13f62
.long 0x3f6dbec4,0xbec43f6d,0xbec4bf6d,0x3f6d3ec4,0xbf62bef1,0x3f7fbdc9,0xbf463f22,0x3e95bf75
.long 0x3e483f7b,0xbf0ebf55,0x3f553f0e,0xbf7bbe48,0x3f22bf46,0xbef13f62,0x3e95bf75,0xbdc93f7f
.long 0xbf80248d,0x3f80a554,0xbf80248d,0x3f80a554,0x3f223f46,0xbef1bf62,0x3e953f75,0xbdc9bf7f
.long 0x3e48bf7b,0xbf0e3f55,0x3f55bf0e,0xbf7b3e48,0xbf623ef1,0x3f7f3dc9,0xbf46bf22,0x3e953f75
.long 0x3f6d3ec4,0xbec4bf6d,0xbec43f6d,0x3f6dbec4,0xbe95bf75,0xbf223f46,0x3f7f3dc9,0xbef1bf62
.long 0xbf0e3f55,0x3f7b3e48,0xbe48bf7b,0xbf553f0e,0x3f7fbdc9,0xbe95bf75,0xbf623ef1,0x3f223f46
.long 0xbf35bf35,0xbf353f35,0x3f353f35,0x3f35bf35,0xbdc93f7f,0x3f753e95,0x3ef1bf62,0xbf46bf22
.long 0x3f55bf0e,0xbe48bf7b,0xbf7bbe48,0xbf0e3f55,0xbf75be95,0xbf463f22,0x3dc93f7f,0x3f623ef1
.long 0x3ec43f6d,0x3f6d3ec4,0x3f6dbec4,0x3ec4bf6d,0x3ef1bf62,0xbdc9bf7f,0xbf22bf46,0xbf75be95
.long 0xbf7b3e48,0xbf553f0e,0xbf0e3f55,0xbe483f7b,0x3f463f22,0x3f623ef1,0x3f753e95,0x3f7f3dc9
.long 0x80003f80,0x80003f80,0x80003f80,0x80003f80,0x3f7f3dc9,0x3f753e95,0x3f623ef1,0x3f463f22
.long 0x3e48bf7b,0x3f0ebf55,0x3f55bf0e,0x3f7bbe48,0xbf75be95,0xbf22bf46,0xbdc9bf7f,0x3ef1bf62
.long 0xbec43f6d,0xbf6d3ec4,0xbf6dbec4,0xbec4bf6d,0x3f623ef1,0x3dc93f7f,0xbf463f22,0xbf75be95
.long 0x3f0ebf55,0x3f7b3e48,0x3e483f7b,0xbf553f0e,0xbf46bf22,0x3ef1bf62,0x3f753e95,0xbdc93f7f
.long 0xbf353f35,0xbf35bf35,0x3f35bf35,0x3f353f35,0x3f223f46,0xbf623ef1,0xbe95bf75,0x3f7fbdc9
.long 0x3f55bf0e,0x3e483f7b,0xbf7bbe48,0x3f0ebf55,0xbef1bf62,0x3f7f3dc9,0xbf223f46,0xbe95bf75
.long 0xbf6d3ec4,0x3ec4bf6d,0x3ec43f6d,0xbf6dbec4,0x3e953f75,0xbf46bf22,0x3f7f3dc9,0xbf623ef1
.long 0x3f7bbe48,0xbf553f0e,0x3f0ebf55,0xbe483f7b,0xbdc9bf7f,0x3e953f75,0xbef1bf62,0x3f223f46
.long 0xbf80248d,0x3f80a554,0xbf80248d,0x3f80a554,0xbdc93f7f,0x3e95bf75,0xbef13f62,0x3f22bf46
.long 0x3f7b3e48,0xbf55bf0e,0x3f0e3f55,0xbe48bf7b,0x3e95bf75,0xbf463f22,0x3f7fbdc9,0xbf62bef1
.long 0xbf6dbec4,0x3ec43f6d,0x3ec4bf6d,0xbf6d3ec4,0xbef13f62,0x3f7fbdc9,0xbf22bf46,0xbe953f75
.long 0x3f553f0e,0x3e48bf7b,0xbf7b3e48,0x3f0e3f55,0x3f22bf46,0xbf62bef1,0xbe953f75,0x3f7f3dc9
.long 0xbf35bf35,0xbf353f35,0x3f353f35,0x3f35bf35,0xbf463f22,0x3ef13f62,0x3f75be95,0xbdc9bf7f
.long 0x3f0e3f55,0x3f7bbe48,0x3e48bf7b,0xbf55bf0e,0x3f62bef1,0x3dc9bf7f,0xbf46bf22,0xbf753e95
.long 0xbec4bf6d,0xbf6dbec4,0xbf6d3ec4,0xbec43f6d,0xbf753e95,0xbf223f46,0xbdc93f7f,0x3ef13f62
.long 0x3e483f7b,0x3f0e3f55,0x3f553f0e,0x3f7b3e48,0x3f7fbdc9,0x3f75be95,0x3f62bef1,0x3f46bf22
.long 0x80003f80,0x80003f80,0x80003f80,0x80003f80,0x3f223f46,0x3ef13f62,0x3e953f75,0x3dc93f7f
.long 0x3f7b3e48,0x3f553f0e,0x3f0e3f55,0x3e483f7b,0x3f62bef1,0x3f7f3dc9,0x3f463f22,0x3e953f75
.long 0x3ec4bf6d,0x3f6dbec4,0x3f6d3ec4,0x3ec43f6d,0xbe95bf75,0x3f22bf46,0x3f7f3dc9,0x3ef13f62
.long 0xbf55bf0e,0x3e48bf7b,0x3f7bbe48,0x3f0e3f55,0xbf7f3dc9,0xbe95bf75,0x3f62bef1,0x3f223f46
.long 0xbf353f35,0xbf35bf35,0x3f35bf35,0x3f353f35,0xbdc93f7f,0xbf75be95,0x3ef1bf62,0x3f463f22
.long 0x3f0e3f55,0xbf7b3e48,0x3e48bf7b,0x3f553f0e,0x3f753e95,0xbf463f22,0xbdc9bf7f,0x3f623ef1
.long 0x3f6dbec4,0xbec43f6d,0xbec4bf6d,0x3f6d3ec4,0x3ef1bf62,0x3dc93f7f,0xbf22bf46,0x3f753e95
.long 0xbe48bf7b,0x3f0e3f55,0xbf55bf0e,0x3f7b3e48,0xbf46bf22,0x3f623ef1,0xbf75be95,0x3f7f3dc9
.long 0xbf80248d,0x3f80a554,0xbf80248d,0x3f80a554,0xbf463f22,0x3f62bef1,0xbf753e95,0x3f7fbdc9
.long 0xbe483f7b,0x3f0ebf55,0xbf553f0e,0x3f7bbe48,0x3ef13f62,0x3dc9bf7f,0xbf223f46,0x3f75be95
.long 0x3f6d3ec4,0xbec4bf6d,0xbec43f6d,0x3f6dbec4,0x3f75be95,0xbf46bf22,0xbdc93f7f,0x3f62bef1
.long 0x3f0ebf55,0xbf7bbe48,0x3e483f7b,0x3f55bf0e,0xbdc9bf7f,0xbf753e95,0x3ef13f62,0x3f46bf22
.long 0xbf35bf35,0xbf353f35,0x3f353f35,0x3f35bf35,0xbf7fbdc9,0xbe953f75,0x3f623ef1,0x3f22bf46
.long 0xbf553f0e,0x3e483f7b,0x3f7b3e48,0x3f0ebf55,0xbe953f75,0x3f223f46,0x3f7fbdc9,0x3ef1bf62
.long 0x3ec43f6d,0x3f6d3ec4,0x3f6dbec4,0x3ec4bf6d,0x3f623ef1,0x3f7fbdc9,0x3f46bf22,0x3e95bf75
.long 0x3f7bbe48,0x3f55bf0e,0x3f0ebf55,0x3e48bf7b,0x3f22bf46,0x3ef1bf62,0x3e95bf75,0x3dc9bf7f
.long 0x80003f80,0x80003f80,0x80003f80,0x80003f80,0xbe163f7d,0xbeac3f71,0xbf043f5c,0xbf2c3f3e
.long 0xbe953f75,0xbf223f46,0xbf623ef1,0xbf7f3dc9,0xbedb3f67,0xbf5c3f04,0xbf80bd49,0xbf4ebf18
.long 0xbf0e3f55,0xbf7b3e48,0xbf55bf0e,0xbe48bf7b,0xbf2c3f3e,0xbf7dbe16,0xbedbbf67,0x3f04bf5c
.long 0xbf463f22,0xbf62bef1,0x3dc9bf7f,0x3f75be95,0xbf5c3f04,0xbf2cbf3e,0x3f18bf4e,0x3f673edb
.long 0xbf6d3ec4,0xbec4bf6d,0x3f6dbec4,0x3ec43f6d,0xbf783e79,0xbd49bf80,0x3f7d3e16,0xbeac3f71
.long 0xbf7f3dc9,0x3e95bf75,0x3f463f22,0xbf623ef1,0xbf80bd49,0x3f18bf4e,0x3eac3f71,0xbf78be79
.long 0xbf7bbe48,0x3f55bf0e,0xbe483f7b,0xbf0ebf55,0xbf71beac,0x3f78be79,0xbf2c3f3e,0x3e16bf7d
.long 0xbf62bef1,0x3f7f3dc9,0xbf753e95,0x3f46bf22,0xbf4ebf18,0x3f673edb,0xbf78be79,0x3f803d49
.long 0xbf35bf35,0x3f353f35,0xbf35bf35,0x3f353f35,0xbf18bf4e,0x3edb3f67,0xbe79bf78,0x3d493f80
.long 0xbef1bf62,0x3dc93f7f,0x3e95bf75,0xbf223f46,0xbeacbf71,0xbe793f78,0x3f3ebf2c,0xbf7d3e16
.long 0xbe48bf7b,0xbf0e3f55,0x3f7bbe48,0xbf55bf0e,0xbd49bf80,0xbf4e3f18,0x3f713eac,0xbe79bf78
.long 0x3dc9bf7f,0xbf753e95,0x3f223f46,0x3ef1bf62,0x3e79bf78,0xbf80bd49,0x3e163f7d,0x3f71beac
.long 0x3ec4bf6d,0xbf6dbec4,0xbec43f6d,0x3f6d3ec4,0x3f04bf5c,0xbf3ebf2c,0xbf4e3f18,0x3edb3f67
.long 0x3f22bf46,0xbef1bf62,0xbf7f3dc9,0xbe953f75,0x3f3ebf2c,0xbe16bf7d,0xbf67bedb,0xbf5c3f04
.long 0x3f55bf0e,0x3e48bf7b,0xbf0ebf55,0xbf7bbe48,0x3f67bedb,0x3f04bf5c,0xbd49bf80,0xbf18bf4e
.long 0x3f75be95,0x3f46bf22,0x3ef1bf62,0x3dc9bf7f,0x3f7dbe16,0x3f71beac,0x3f5cbf04,0x3f3ebf2c
.long 0x80003f80,0x80003f80,0x80003f80,0x80003f80,0xbf4e3f18,0xbf673edb,0xbf783e79,0xbf803d49
.long 0xbf75be95,0xbf46bf22,0xbef1bf62,0xbdc9bf7f,0xbeacbf71,0x3e79bf78,0x3f3ebf2c,0x3f7dbe16
.long 0x3f0ebf55,0x3f7bbe48,0x3f553f0e,0x3e483f7b,0x3f80bd49,0x3f183f4e,0xbeac3f71,0xbf783e79
.long 0x3f223f46,0xbef13f62,0xbf7fbdc9,0xbe95bf75,0xbe793f78,0xbf80bd49,0xbe16bf7d,0x3f71beac
.long 0xbf6d3ec4,0xbec4bf6d,0x3f6dbec4,0x3ec43f6d,0xbf5cbf04,0x3f2cbf3e,0x3f183f4e,0xbf673edb
.long 0xbdc9bf7f,0x3f753e95,0xbf223f46,0xbef1bf62,0x3f3ebf2c,0x3e163f7d,0xbf67bedb,0x3f5cbf04
.long 0x3f7b3e48,0xbf553f0e,0x3e48bf7b,0x3f0e3f55,0x3edb3f67,0xbf5cbf04,0x3f80bd49,0xbf4e3f18
.long 0xbef13f62,0x3dc9bf7f,0x3e953f75,0xbf22bf46,0xbf7d3e16,0x3f71beac,0xbf5c3f04,0x3f3ebf2c
.long 0xbf35bf35,0x3f353f35,0xbf35bf35,0x3f353f35,0x3e16bf7d,0xbeac3f71,0x3f04bf5c,0xbf2c3f3e
.long 0x3f62bef1,0xbf7f3dc9,0x3f753e95,0xbf46bf22,0x3f673edb,0xbf04bf5c,0xbd493f80,0x3f18bf4e
.long 0x3e483f7b,0x3f0ebf55,0xbf7b3e48,0x3f553f0e,0xbf2c3f3e,0x3f7d3e16,0xbedbbf67,0xbf043f5c
.long 0xbf7fbdc9,0x3e953f75,0x3f46bf22,0xbf62bef1,0xbf04bf5c,0xbf3e3f2c,0x3f4e3f18,0x3edbbf67
.long 0x3ec4bf6d,0xbf6dbec4,0xbec43f6d,0x3f6d3ec4,0x3f78be79,0xbd49bf80,0xbf7dbe16,0xbeac3f71
.long 0x3f463f22,0x3f62bef1,0xbdc9bf7f,0xbf75be95,0xbd493f80,0x3f4e3f18,0x3f71beac,0x3e79bf78
.long 0xbf553f0e,0xbe483f7b,0x3f0e3f55,0x3f7b3e48,0xbf71beac,0xbf783e79,0xbf2c3f3e,0xbe163f7d
.long 0xbe95bf75,0xbf22bf46,0xbf62bef1,0xbf7fbdc9,0x3f18bf4e,0x3edbbf67,0x3e79bf78,0x3d49bf80
.long 0x80003f80,0x80003f80,0x80003f80,0x80003f80,0xbf7dbe16,0xbf71beac,0xbf5cbf04,0xbf3ebf2c
.long 0x3e95bf75,0x3f22bf46,0x3f62bef1,0x3f7fbdc9,0x3f673edb,0x3f043f5c,0xbd493f80,0xbf183f4e
.long 0xbf0e3f55,0xbf7b3e48,0xbf55bf0e,0xbe48bf7b,0xbf3ebf2c,0x3e16bf7d,0x3f67bedb,0x3f5c3f04
.long 0x3f46bf22,0x3f623ef1,0xbdc93f7f,0xbf753e95,0x3f043f5c,0xbf3e3f2c,0xbf4ebf18,0x3edbbf67
.long 0xbf6d3ec4,0xbec4bf6d,0x3f6dbec4,0x3ec43f6d,0xbe79bf78,0x3f80bd49,0xbe163f7d,0xbf71beac
.long 0x3f7fbdc9,0xbe953f75,0xbf46bf22,0x3f62bef1,0xbd493f80,0xbf4ebf18,0x3f71beac,0xbe793f78
.long 0xbf7bbe48,0x3f55bf0e,0xbe483f7b,0xbf0ebf55,0x3eacbf71,0x3e793f78,0xbf3ebf2c,0x3f7d3e16
.long 0x3f623ef1,0xbf7fbdc9,0x3f75be95,0xbf463f22,0xbf183f4e,0x3edbbf67,0xbe793f78,0x3d49bf80
.long 0xbf35bf35,0x3f353f35,0xbf35bf35,0x3f353f35,0x3f4ebf18,0xbf673edb,0x3f78be79,0xbf803d49
.long 0x3ef13f62,0xbdc9bf7f,0xbe953f75,0x3f22bf46,0xbf713eac,0x3f783e79,0xbf2cbf3e,0x3e163f7d
.long 0xbe48bf7b,0xbf0e3f55,0x3f7bbe48,0xbf55bf0e,0x3f80bd49,0xbf18bf4e,0xbeac3f71,0x3f78be79
.long 0xbdc93f7f,0x3f75be95,0xbf22bf46,0xbef13f62,0xbf78be79,0xbd493f80,0x3f7dbe16,0xbeacbf71
.long 0x3ec4bf6d,0xbf6dbec4,0xbec43f6d,0x3f6d3ec4,0x3f5c3f04,0x3f2cbf3e,0xbf18bf4e,0xbf673edb
.long 0xbf223f46,0x3ef13f62,0x3f7fbdc9,0x3e95bf75,0xbf2cbf3e,0xbf7d3e16,0xbedb3f67,0x3f043f5c
.long 0x3f55bf0e,0x3e48bf7b,0xbf0ebf55,0xbf7bbe48,0x3edb3f67,0x3f5c3f04,0x3f80bd49,0x3f4ebf18
.long 0xbf753e95,0xbf463f22,0xbef13f62,0xbdc93f7f,0xbe16bf7d,0xbeacbf71,0xbf04bf5c,0xbf2cbf3e
.long 0x80003f80,0x80003f80,0x80003f80,0x80003f80,0xbf18bf4e,0xbedbbf67,0xbe79bf78,0xbd49bf80
.long 0x3f753e95,0x3f463f22,0x3ef13f62,0x3dc93f7f,0xbf713eac,0xbf78be79,0xbf2cbf3e,0xbe16bf7d
.long 0x3f0ebf55,0x3f7bbe48,0x3f553f0e,0x3e483f7b,0x3d493f80,0xbf4e3f18,0xbf71beac,0xbe79bf78
.long 0xbf22bf46,0x3ef1bf62,0x3f7f3dc9,0x3e953f75,0x3f783e79,0xbd493f80,0xbf7d3e16,0xbeacbf71
.long 0xbf6d3ec4,0xbec4bf6d,0x3f6dbec4,0x3ec43f6d,0x3f04bf5c,0x3f3e3f2c,0xbf4e3f18,0xbedbbf67
.long 0x3dc93f7f,0xbf75be95,0x3f22bf46,0x3ef13f62,0xbf2cbf3e,0x3f7dbe16,0xbedb3f67,0xbf04bf5c
.long 0x3f7b3e48,0xbf553f0e,0x3e48bf7b,0x3f0e3f55,0xbf673edb,0x3f04bf5c,0x3d493f80,0xbf18bf4e
.long 0x3ef1bf62,0xbdc93f7f,0xbe95bf75,0x3f223f46,0x3e163f7d,0xbeacbf71,0x3f043f5c,0xbf2cbf3e
.long 0xbf35bf35,0x3f353f35,0xbf35bf35,0x3f353f35,0x3f7d3e16,0xbf71beac,0x3f5c3f04,0xbf3ebf2c
.long 0xbf623ef1,0x3f7fbdc9,0xbf75be95,0x3f463f22,0x3edbbf67,0xbf5c3f04,0x3f803d49,0xbf4ebf18
.long 0x3e483f7b,0x3f0ebf55,0xbf7b3e48,0x3f553f0e,0xbf3ebf2c,0xbe163f7d,0x3f67bedb,0xbf5cbf04
.long 0x3f7f3dc9,0xbe95bf75,0xbf463f22,0x3f623ef1,0xbf5c3f04,0x3f2c3f3e,0x3f18bf4e,0xbf67bedb
.long 0x3ec4bf6d,0xbf6dbec4,0xbec43f6d,0x3f6d3ec4,0x3e793f78,0x3f80bd49,0x3e16bf7d,0xbf71beac
.long 0xbf46bf22,0xbf623ef1,0x3dc93f7f,0x3f753e95,0x3f803d49,0x3f18bf4e,0xbeacbf71,0xbf78be79
.long 0xbf553f0e,0xbe483f7b,0x3f0e3f55,0x3f7b3e48,0x3eacbf71,0xbe79bf78,0xbf3ebf2c,0xbf7dbe16
.long 0x3e953f75,0x3f223f46,0x3f623ef1,0x3f7f3dc9,0xbf4ebf18,0xbf67bedb,0xbf78be79,0xbf80bd49
.long 0x80003f80,0x80003f80,0x80003f80,0x80003f80,0x3e16bf7d,0x3eacbf71,0x3f04bf5c,0x3f2cbf3e
.long 0xbe953f75,0xbf223f46,0xbf623ef1,0xbf7f3dc9,0x3edbbf67,0x3f5cbf04,0x3f803d49,0x3f4e3f18
.long 0xbf0e3f55,0xbf7b3e48,0xbf55bf0e,0xbe48bf7b,0x3f2cbf3e,0x3f7d3e16,0x3edb3f67,0xbf043f5c
.long 0xbf463f22,0xbf62bef1,0x3dc9bf7f,0x3f75be95,0x3f5cbf04,0x3f2c3f3e,0xbf183f4e,0xbf67bedb
.long 0xbf6d3ec4,0xbec4bf6d,0x3f6dbec4,0x3ec43f6d,0x3f78be79,0x3d493f80,0xbf7dbe16,0x3eacbf71
.long 0xbf7f3dc9,0x3e95bf75,0x3f463f22,0xbf623ef1,0x3f803d49,0xbf183f4e,0xbeacbf71,0x3f783e79
.long 0xbf7bbe48,0x3f55bf0e,0xbe483f7b,0xbf0ebf55,0x3f713eac,0xbf783e79,0x3f2cbf3e,0xbe163f7d
.long 0xbf62bef1,0x3f7f3dc9,0xbf753e95,0x3f46bf22,0x3f4e3f18,0xbf67bedb,0x3f783e79,0xbf80bd49
.long 0xbf35bf35,0x3f353f35,0xbf35bf35,0x3f353f35,0x3f183f4e,0xbedbbf67,0x3e793f78,0xbd49bf80
.long 0xbef1bf62,0x3dc93f7f,0x3e95bf75,0xbf223f46,0x3eac3f71,0x3e79bf78,0xbf3e3f2c,0x3f7dbe16
.long 0xbe48bf7b,0xbf0e3f55,0x3f7bbe48,0xbf55bf0e,0x3d493f80,0x3f4ebf18,0xbf71beac,0x3e793f78
.long 0x3dc9bf7f,0xbf753e95,0x3f223f46,0x3ef1bf62,0xbe793f78,0x3f803d49,0xbe16bf7d,0xbf713eac
.long 0x3ec4bf6d,0xbf6dbec4,0xbec43f6d,0x3f6d3ec4,0xbf043f5c,0x3f3e3f2c,0x3f4ebf18,0xbedbbf67
.long 0x3f22bf46,0xbef1bf62,0xbf7f3dc9,0xbe953f75,0xbf3e3f2c,0x3e163f7d,0x3f673edb,0x3f5cbf04
.long 0x3f55bf0e,0x3e48bf7b,0xbf0ebf55,0xbf7bbe48,0xbf673edb,0xbf043f5c,0x3d493f80,0x3f183f4e
.long 0x3f75be95,0x3f46bf22,0x3ef1bf62,0x3dc9bf7f,0xbf7d3e16,0xbf713eac,0xbf5c3f04,0xbf3e3f2c
.long 0x80003f80,0x80003f80,0x80003f80,0x80003f80,0x3f4ebf18,0x3f67bedb,0x3f78be79,0x3f80bd49
.long 0xbf75be95,0xbf46bf22,0xbef1bf62,0xbdc9bf7f,0x3eac3f71,0xbe793f78,0xbf3e3f2c,0xbf7d3e16
.long 0x3f0ebf55,0x3f7bbe48,0x3f553f0e,0x3e483f7b,0xbf803d49,0xbf18bf4e,0x3eacbf71,0x3f78be79
.long 0x3f223f46,0xbef13f62,0xbf7fbdc9,0xbe95bf75,0x3e79bf78,0x3f803d49,0x3e163f7d,0xbf713eac
.long 0xbf6d3ec4,0xbec4bf6d,0x3f6dbec4,0x3ec43f6d,0x3f5c3f04,0xbf2c3f3e,0xbf18bf4e,0x3f67bedb
.long 0xbdc9bf7f,0x3f753e95,0xbf223f46,0xbef1bf62,0xbf3e3f2c,0xbe16bf7d,0x3f673edb,0xbf5c3f04
.long 0x3f7b3e48,0xbf553f0e,0x3e48bf7b,0x3f0e3f55,0xbedbbf67,0x3f5c3f04,0xbf803d49,0x3f4ebf18
.long 0xbef13f62,0x3dc9bf7f,0x3e953f75,0xbf22bf46,0x3f7dbe16,0xbf713eac,0x3f5cbf04,0xbf3e3f2c
.long 0xbf35bf35,0x3f353f35,0xbf35bf35,0x3f353f35,0xbe163f7d,0x3eacbf71,0xbf043f5c,0x3f2cbf3e
.long 0x3f62bef1,0xbf7f3dc9,0x3f753e95,0xbf46bf22,0xbf67bedb,0x3f043f5c,0x3d49bf80,0xbf183f4e
.long 0x3e483f7b,0x3f0ebf55,0xbf7b3e48,0x3f553f0e,0x3f2cbf3e,0xbf7dbe16,0x3edb3f67,0x3f04bf5c
.long 0xbf7fbdc9,0x3e953f75,0x3f46bf22,0xbf62bef1,0x3f043f5c,0x3f3ebf2c,0xbf4ebf18,0xbedb3f67
.long 0x3ec4bf6d,0xbf6dbec4,0xbec43f6d,0x3f6d3ec4,0xbf783e79,0x3d493f80,0x3f7d3e16,0x3eacbf71
.long 0x3f463f22,0x3f62bef1,0xbdc9bf7f,0xbf75be95,0x3d49bf80,0xbf4ebf18,0xbf713eac,0xbe793f78
.long 0xbf553f0e,0xbe483f7b,0x3f0e3f55,0x3f7b3e48,0x3f713eac,0x3f78be79,0x3f2cbf3e,0x3e16bf7d
.long 0xbe95bf75,0xbf22bf46,0xbf62bef1,0xbf7fbdc9,0xbf183f4e,0xbedb3f67,0xbe793f78,0xbd493f80
.long 0x80003f80,0x80003f80,0x80003f80,0x80003f80,0x3f7d3e16,0x3f713eac,0x3f5c3f04,0x3f3e3f2c
.long 0x3e95bf75,0x3f22bf46,0x3f62bef1,0x3f7fbdc9,0xbf67bedb,0xbf04bf5c,0x3d49bf80,0x3f18bf4e
.long 0xbf0e3f55,0xbf7b3e48,0xbf55bf0e,0xbe48bf7b,0x3f3e3f2c,0xbe163f7d,0xbf673edb,0xbf5cbf04
.long 0x3f46bf22,0x3f623ef1,0xbdc93f7f,0xbf753e95,0xbf04bf5c,0x3f3ebf2c,0x3f4e3f18,0xbedb3f67
.long 0xbf6d3ec4,0xbec4bf6d,0x3f6dbec4,0x3ec43f6d,0x3e793f78,0xbf803d49,0x3e16bf7d,0x3f713eac
.long 0x3f7fbdc9,0xbe953f75,0xbf46bf22,0x3f62bef1,0x3d49bf80,0x3f4e3f18,0xbf713eac,0x3e79bf78
.long 0xbf7bbe48,0x3f55bf0e,0xbe483f7b,0xbf0ebf55,0xbeac3f71,0xbe79bf78,0x3f3e3f2c,0xbf7dbe16
.long 0x3f623ef1,0xbf7fbdc9,0x3f75be95,0xbf463f22,0x3f18bf4e,0xbedb3f67,0x3e79bf78,0xbd493f80
.long 0xbf35bf35,0x3f353f35,0xbf35bf35,0x3f353f35,0xbf4e3f18,0x3f67bedb,0xbf783e79,0x3f80bd49
.long 0x3ef13f62,0xbdc9bf7f,0xbe953f75,0x3f22bf46,0x3f71beac,0xbf78be79,0x3f2c3f3e,0xbe16bf7d
.long 0xbe48bf7b,0xbf0e3f55,0x3f7bbe48,0xbf55bf0e,0xbf803d49,0x3f183f4e,0x3eacbf71,0xbf783e79
.long 0xbdc93f7f,0x3f75be95,0xbf22bf46,0xbef13f62,0x3f783e79,0x3d49bf80,0xbf7d3e16,0x3eac3f71
.long 0x3ec4bf6d,0xbf6dbec4,0xbec43f6d,0x3f6d3ec4,0xbf5cbf04,0xbf2c3f3e,0x3f183f4e,0x3f67bedb
.long 0xbf223f46,0x3ef13f62,0x3f7fbdc9,0x3e95bf75,0x3f2c3f3e,0x3f7dbe16,0x3edbbf67,0xbf04bf5c
.long 0x3f55bf0e,0x3e48bf7b,0xbf0ebf55,0xbf7bbe48,0xbedbbf67,0xbf5cbf04,0xbf803d49,0xbf4e3f18
.long 0xbf753e95,0xbf463f22,0xbef13f62,0xbdc93f7f,0x3e163f7d,0x3eac3f71,0x3f043f5c,0x3f2c3f3e
.long 0x80003f80,0x80003f80,0x80003f80,0x80003f80,0x3f183f4e,0x3edb3f67,0x3e793f78,0x3d493f80
.long 0x3f753e95,0x3f463f22,0x3ef13f62,0x3dc93f7f,0x3f71beac,0x3f783e79,0x3f2c3f3e,0x3e163f7d
.long 0x3f0ebf55,0x3f7bbe48,0x3f553f0e,0x3e483f7b,0xbd49bf80,0x3f4ebf18,0x3f713eac,0x3e793f78
.long 0xbf22bf46,0x3ef1bf62,0x3f7f3dc9,0x3e953f75,0xbf78be79,0x3d49bf80,0x3f7dbe16,0x3eac3f71
.long 0xbf6d3ec4,0xbec4bf6d,0x3f6dbec4,0x3ec43f6d,0xbf043f5c,0xbf3ebf2c,0x3f4ebf18,0x3edb3f67
.long 0x3dc93f7f,0xbf75be95,0x3f22bf46,0x3ef13f62,0x3f2c3f3e,0xbf7d3e16,0x3edbbf67,0x3f043f5c
.long 0x3f7b3e48,0xbf553f0e,0x3e48bf7b,0x3f0e3f55,0x3f67bedb,0xbf043f5c,0xbd49bf80,0x3f183f4e
.long 0x3ef1bf62,0xbdc93f7f,0xbe95bf75,0x3f223f46,0xbe16bf7d,0x3eac3f71,0xbf04bf5c,0x3f2c3f3e
.long 0xbf35bf35,0x3f353f35,0xbf35bf35,0x3f353f35,0xbf7dbe16,0x3f713eac,0xbf5cbf04,0x3f3e3f2c
.long 0xbf623ef1,0x3f7fbdc9,0xbf75be95,0x3f463f22,0xbedb3f67,0x3f5cbf04,0xbf80bd49,0x3f4e3f18
.long 0x3e483f7b,0x3f0ebf55,0xbf7b3e48,0x3f553f0e,0x3f3e3f2c,0x3e16bf7d,0xbf673edb,0x3f5c3f04
.long 0x3f7f3dc9,0xbe95bf75,0xbf463f22,0x3f623ef1,0x3f5cbf04,0xbf2cbf3e,0xbf183f4e,0x3f673edb
.long 0x3ec4bf6d,0xbf6dbec4,0xbec43f6d,0x3f6d3ec4,0xbe79bf78,0xbf803d49,0xbe163f7d,0x3f713eac
.long 0xbf46bf22,0xbf623ef1,0x3dc93f7f,0x3f753e95,0xbf80bd49,0xbf183f4e,0x3eac3f71,0x3f783e79
.long 0xbf553f0e,0xbe483f7b,0x3f0e3f55,0x3f7b3e48,0xbeac3f71,0x3e793f78,0x3f3e3f2c,0x3f7d3e16
.long 0x3e953f75,0x3f223f46,0x3f623ef1,0x3f7f3dc9,0x3f4e3f18,0x3f673edb,0x3f783e79,0x3f803d49
.long 0xffffffff,0xfff0fff0,0xfffffffe,0xfff0ffe0,0xfffefffe,0xffe0ffe0,0xfffefffc,0xffe0ffc0
.long 0xfffcfffc,0xffc0ffc0,0xfffcfff8,0xffc0ff80,0xfff8fff8,0xff80ff80,0xfff8fff0,0xff80ff00
.long 0xff00ff00,0xf000f000,0xff00fe00,0xf000e000,0xfe00fe00,0xe000e000,0xfe00fc00,0xe000c000
.long 0xfc00fc00,0xc000c000,0xfc00f800,0xc0008000,0xf800f800,0x80008000,0xf800f000,0x80000000
TABEND:
.size TAB, TABEND-TAB
.section .rodata,"a"
.p2align 6
.amdhsa_kernel concat_heads__spectral_fnet__sliding_block__prompt_kernel
  .amdhsa_next_free_vgpr 256
  .amdhsa_next_free_sgpr 102
  .amdhsa_accum_offset 256
  .amdhsa_group_segment_fixed_size 0
  .amdhsa_kernarg_size 88
  .amdhsa_user_sgpr_count 2
  .amdhsa_user_sgpr_kernarg_segment_ptr 1
  .amdhsa_system_sgpr_workgroup_id_x 1
.end_amdhsa_kernel
```
